```python
import torch

def _softmax(x, axis=-1):
    return torch.softmax(x, dim=axis)

def _gelu(x):
    return torch.nn.functional.gelu(x, approximate='tanh')

def _silu(x):
    return torch.nn.functional.silu(x)

def _sigmoid(x):
    return torch.sigmoid(x)

def _layernorm(x, axis=-1, eps=1e-05):
    m = x.mean(dim=axis, keepdim=True)
    v = x.var(dim=axis, keepdim=True, unbiased=False)
    return (x - m) / torch.sqrt(v + eps)

def _scatter_add(tgt, idx, src, axis=0):
    return tgt.clone().index_add_(axis, idx, src)

def _segment_sum(src, seg, n):
    out = torch.zeros((n,) + src.shape[1:], dtype=src.dtype)
    return out.index_add_(0, seg, src)

def _pad(x, pw):
    flat = tuple((v for pair in reversed(pw) for v in pair))
    return torch.nn.functional.pad(x, flat)
kernel_name = 'adaLN_cond__sliding_block__dense_activation_squared_relu__prompt'

def setup_inputs():

    _w = lambda a: (lambda t: t.to(torch.bfloat16) if t.is_floating_point() else t)(torch.as_tensor(a))

    def _A_setup():
        B, S, D = (1, 2048, 512)
        return {'x': _w((lambda *s: torch.randn(*s, dtype=torch.bfloat16) * 0.05)(B, S, D)), 'wqkv': _w((lambda *s: torch.randn(*s, dtype=torch.bfloat16) * 0.05)(D, 3 * D)), 'wo': _w((lambda *s: torch.randn(*s, dtype=torch.bfloat16) * 0.05)(D, D))}
    _A_in = _A_setup()

    def _B_setup():
        B, S, D, F = (1, 2048, 512, 1792)
        return {'x': _w((lambda *s: torch.randn(*s, dtype=torch.bfloat16) * 0.05)(B, S, D)), 'w1': _w((lambda *s: torch.randn(*s, dtype=torch.bfloat16) * 0.05)(D, F)), 'b1': _w((lambda *s: torch.randn(*s, dtype=torch.bfloat16) * 0.4)(F)), 'w2': _w((lambda *s: torch.randn(*s, dtype=torch.bfloat16) * 0.05)(F, D)), 'b2': _w((lambda *s: torch.randn(*s, dtype=torch.bfloat16) * 3.2)(D))}
    _B_in = _B_setup()
    return {'A_x': _A_in['x'], 'A_wqkv': _A_in['wqkv'], 'A_wo': _A_in['wo'], 'B_x': _B_in['x'], 'B_w1': _B_in['w1'], 'B_b1': _B_in['b1'], 'B_w2': _B_in['w2'], 'B_b2': _B_in['b2'], 'c': _w((lambda *s: torch.randn(*s, dtype=torch.bfloat16) * 0.1)(1, 512) * 8.0), 'w_mod': _w((lambda *s: torch.randn(*s, dtype=torch.bfloat16) * 0.1)(512, 6 * 512) * 512 ** (-0.5) * 8.0)}

def reference(A_x, A_wqkv, A_wo, B_x, B_w1, B_b1, B_w2, B_b2, c, w_mod):

    def _A_ref(x, wqkv, wo):
        B, S, D = x.shape
        H = 32
        Dh = D // H
        W = 256
        qkv = (lambda x, *d: x.permute(*d))((x @ wqkv).reshape(B, S, 3, H, Dh), 2, 0, 3, 1, 4)
        q, k, v = (qkv[0], qkv[1], qkv[2])
        scores = torch.einsum('bhqd,bhkd->bhqk', q, k) * Dh ** (-0.5)
        idx = torch.arange(S)
        mask = (idx[:, None] - idx[None, :] >= 0) & (idx[:, None] - idx[None, :] < W)
        scores = torch.where(mask[None, None], scores, -1000000000.0)
        p = _softmax(scores, axis=-1)
        o = torch.einsum('bhqk,bhkd->bhqd', p, v)
        return (lambda x, *d: x.permute(*d))(o, 0, 2, 1, 3).reshape(B, S, D) @ wo

    def _B_ref(x, w1, b1, w2, b2):
        h = torch.einsum('bsd,df->bsf', x, w1) + b1
        zero = torch.zeros_like(h)
        r = torch.where(h > zero, h, zero)
        h = r * r
        out = torch.einsum('bsf,fd->bsd', h, w2) + b2
        return out
    x = A_x
    mod = (_silu(c) @ w_mod).reshape(c.shape[0], 6, 1, -1)
    sa, ca, ga, sb, cb, gb = (mod[:, 0].clone(), mod[:, 1].clone(), mod[:, 2].clone(), mod[:, 3].clone(), mod[:, 4].clone(), mod[:, 5].clone())
    h = _layernorm(x, axis=-1) * (1 + ca) + sa
    x = x + ga * _A_ref(h, A_wqkv, A_wo)
    h = _layernorm(x, axis=-1) * (1 + cb) + sb
    x = x + gb * _B_ref(h, B_w1, B_b1, B_w2, B_b2)
    return x
```

```asm
; @launch grid=(256,1,1) block=(256,1,1) lds=163840
.amdgcn_target "amdgcn-amd-amdhsa--gfx950"
.text
.globl adaLN_cond__sliding_block__dense_activation_squared_relu__prompt_kernel
.p2align 8
.type adaLN_cond__sliding_block__dense_activation_squared_relu__prompt_kernel,@function
adaLN_cond__sliding_block__dense_activation_squared_relu__prompt_kernel:
s_cmp_ge_u32 s2, 256
s_cbranch_scc1 LEND
s_load_dwordx16 s[64:79], s[0:1], 0
s_load_dwordx8 s[80:87], s[0:1], 64
s_load_dwordx2 s[88:89], s[0:1], 96
v_lshrrev_b32 v2, 6, v0
s_nop 0
v_readfirstlane_b32 s51, v2
v_and_b32 v0, 63, v0
v_lshlrev_b32 v1, 4, v0
s_and_b32 s54, s2, 7
s_lshr_b32 s53, s2, 3
s_lshr_b32 s49, s54, 1
s_lshl_b32 s49, s49, 2
s_lshr_b32 s55, s53, 3
s_add_u32 s49, s49, s55
s_and_b32 s50, s54, 1
s_lshl_b32 s50, s50, 3
s_and_b32 s55, s53, 7
s_add_u32 s50, s50, s55
s_mov_b32 s52, 0x40000
s_waitcnt lgkmcnt(0)
s_mov_b32 s24, s88
s_mov_b32 s25, s89
s_mov_b32 s26, 0x1200000
s_mov_b32 s27, 0x20000
s_mov_b32 s32, s82
s_mov_b32 s33, s83
s_mov_b32 s34, 0x300000
s_mov_b32 s35, 0x20000
s_mov_b32 s36, s80
s_mov_b32 s37, s81
s_mov_b32 s38, 0x400
s_mov_b32 s39, 0x20000
s_mov_b32 s4, s64
s_mov_b32 s5, s65
s_mov_b32 s6, 0x200000
s_mov_b32 s7, 0x20000
s_mov_b32 s8, s66
s_mov_b32 s9, s67
s_mov_b32 s10, 0x180000
s_mov_b32 s11, 0x20000
s_mov_b32 s12, s68
s_mov_b32 s13, s69
s_mov_b32 s14, 0x80000
s_mov_b32 s15, 0x20000
s_mov_b32 s16, s72
s_mov_b32 s17, s73
s_mov_b32 s18, 0x1c0000
s_mov_b32 s19, 0x20000
s_mov_b32 s40, s74
s_mov_b32 s41, s75
s_mov_b32 s42, 0xe00
s_mov_b32 s43, 0x20000
s_mov_b32 s20, s76
s_mov_b32 s21, s77
s_mov_b32 s22, 0x1c0000
s_mov_b32 s23, 0x20000
s_mov_b32 s44, s78
s_mov_b32 s45, s79
s_mov_b32 s46, 0x400
s_mov_b32 s47, 0x20000
s_mov_b32 s28, s84
s_mov_b32 s29, s85
s_mov_b32 s30, 0x200000
s_mov_b32 s31, 0x20000
s_mul_i32 s73, s49, 0x4100
s_add_u32 s73, s73, 0xa0000
buffer_load_dword v9, off, s[24:27], 0 sc1
s_lshl_b32 s56, s49, 2
s_add_u32 s61, s56, s51
v_lshrrev_b32 v2, 2, v0
v_mul_u32_u24 v2, 3072, v2
v_and_b32 v3, 3, v0
v_lshl_add_u32 v13, v3, 4, v2
s_lshl_b32 s55, s50, 6
s_cmp_eq_u32 s51, 2
s_cbranch_scc1 LW2
s_cmp_lg_u32 s51, 0
s_cbranch_scc1 LW3
v_and_b32 v2, 7, v0
v_lshrrev_b32 v3, 3, v0
v_lshlrev_b32 v4, 10, v2
v_lshl_add_u32 v4, v3, 4, v4
s_lshl_b32 s56, s51, 9
v_add_u32 v4, s56, v4
v_xor_b32 v5, 512, v4
s_lshl_b32 s57, s49, 17
s_lshl_b32 s58, s50, 13
s_add_u32 s57, s57, s58
buffer_load_dwordx4 v[16:19], v4, s[4:7], s57 offen offset:0
buffer_load_dwordx4 v[20:23], v4, s[4:7], s57 offen offset:128
buffer_load_dwordx4 v[24:27], v4, s[4:7], s57 offen offset:256
buffer_load_dwordx4 v[28:31], v4, s[4:7], s57 offen offset:384
buffer_load_dwordx4 v[32:35], v5, s[4:7], s57 offen offset:0
buffer_load_dwordx4 v[36:39], v5, s[4:7], s57 offen offset:128
buffer_load_dwordx4 v[40:43], v5, s[4:7], s57 offen offset:256
buffer_load_dwordx4 v[44:47], v5, s[4:7], s57 offen offset:384
v_mov_b32 v8, 0x3f803f80
v_accvgpr_write_b32 a72, v8
v_accvgpr_write_b32 a73, v8
v_accvgpr_write_b32 a74, v8
v_accvgpr_write_b32 a75, v8
v_accvgpr_write_b32 a76, v8
v_accvgpr_write_b32 a77, v8
v_accvgpr_write_b32 a78, v8
v_accvgpr_write_b32 a79, v8
v_accvgpr_write_b32 a80, v8
v_accvgpr_write_b32 a81, v8
v_accvgpr_write_b32 a82, v8
v_accvgpr_write_b32 a83, v8
v_accvgpr_write_b32 a84, v8
v_accvgpr_write_b32 a85, v8
v_accvgpr_write_b32 a86, v8
v_accvgpr_write_b32 a87, v8
v_accvgpr_write_b32 a88, v8
v_accvgpr_write_b32 a89, v8
v_accvgpr_write_b32 a90, v8
v_accvgpr_write_b32 a91, v8
v_accvgpr_write_b32 a92, v8
v_accvgpr_write_b32 a93, v8
v_accvgpr_write_b32 a94, v8
v_accvgpr_write_b32 a95, v8
v_accvgpr_write_b32 a96, v8
v_accvgpr_write_b32 a97, v8
v_accvgpr_write_b32 a98, v8
v_accvgpr_write_b32 a99, v8
v_accvgpr_write_b32 a100, v8
v_accvgpr_write_b32 a101, v8
v_accvgpr_write_b32 a102, v8
v_accvgpr_write_b32 a103, v8
v_accvgpr_write_b32 a104, v8
v_accvgpr_write_b32 a105, v8
v_accvgpr_write_b32 a106, v8
v_accvgpr_write_b32 a107, v8
v_accvgpr_write_b32 a108, v8
v_accvgpr_write_b32 a109, v8
v_accvgpr_write_b32 a110, v8
v_accvgpr_write_b32 a111, v8
v_accvgpr_write_b32 a112, v8
v_accvgpr_write_b32 a113, v8
v_accvgpr_write_b32 a114, v8
v_accvgpr_write_b32 a115, v8
v_accvgpr_write_b32 a116, v8
v_accvgpr_write_b32 a117, v8
v_accvgpr_write_b32 a118, v8
v_accvgpr_write_b32 a119, v8
v_accvgpr_write_b32 a120, v8
v_accvgpr_write_b32 a121, v8
v_accvgpr_write_b32 a122, v8
v_accvgpr_write_b32 a123, v8
v_accvgpr_write_b32 a124, v8
v_accvgpr_write_b32 a125, v8
v_accvgpr_write_b32 a126, v8
v_accvgpr_write_b32 a127, v8
v_accvgpr_write_b32 a128, v8
v_accvgpr_write_b32 a129, v8
v_accvgpr_write_b32 a130, v8
v_accvgpr_write_b32 a131, v8
v_accvgpr_write_b32 a132, v8
v_accvgpr_write_b32 a133, v8
v_accvgpr_write_b32 a134, v8
v_accvgpr_write_b32 a135, v8
v_accvgpr_write_b32 a136, v8
v_accvgpr_write_b32 a137, v8
v_accvgpr_write_b32 a138, v8
v_accvgpr_write_b32 a139, v8
v_accvgpr_write_b32 a140, v8
v_accvgpr_write_b32 a141, v8
v_accvgpr_write_b32 a142, v8
v_accvgpr_write_b32 a143, v8
v_accvgpr_write_b32 a144, v8
v_accvgpr_write_b32 a145, v8
v_accvgpr_write_b32 a146, v8
v_accvgpr_write_b32 a147, v8
v_accvgpr_write_b32 a148, v8
v_accvgpr_write_b32 a149, v8
v_accvgpr_write_b32 a150, v8
v_accvgpr_write_b32 a151, v8
v_accvgpr_write_b32 a152, v8
v_accvgpr_write_b32 a153, v8
v_accvgpr_write_b32 a154, v8
v_accvgpr_write_b32 a155, v8
v_accvgpr_write_b32 a156, v8
v_accvgpr_write_b32 a157, v8
v_accvgpr_write_b32 a158, v8
v_accvgpr_write_b32 a159, v8
v_accvgpr_write_b32 a160, v8
v_accvgpr_write_b32 a161, v8
v_accvgpr_write_b32 a162, v8
v_accvgpr_write_b32 a163, v8
v_accvgpr_write_b32 a164, v8
v_accvgpr_write_b32 a165, v8
v_accvgpr_write_b32 a166, v8
v_accvgpr_write_b32 a167, v8
v_accvgpr_write_b32 a168, v8
v_accvgpr_write_b32 a169, v8
v_accvgpr_write_b32 a170, v8
v_accvgpr_write_b32 a171, v8
v_accvgpr_write_b32 a172, v8
v_accvgpr_write_b32 a173, v8
v_accvgpr_write_b32 a174, v8
v_accvgpr_write_b32 a175, v8
v_accvgpr_write_b32 a176, v8
v_accvgpr_write_b32 a177, v8
v_accvgpr_write_b32 a178, v8
v_accvgpr_write_b32 a179, v8
v_accvgpr_write_b32 a180, v8
v_accvgpr_write_b32 a181, v8
v_accvgpr_write_b32 a182, v8
v_accvgpr_write_b32 a183, v8
v_accvgpr_write_b32 a184, v8
v_accvgpr_write_b32 a185, v8
v_accvgpr_write_b32 a186, v8
v_accvgpr_write_b32 a187, v8
v_accvgpr_write_b32 a188, v8
v_accvgpr_write_b32 a189, v8
v_accvgpr_write_b32 a190, v8
v_accvgpr_write_b32 a191, v8
v_accvgpr_write_b32 a192, v8
v_accvgpr_write_b32 a193, v8
v_accvgpr_write_b32 a194, v8
v_accvgpr_write_b32 a195, v8
v_accvgpr_write_b32 a196, v8
v_accvgpr_write_b32 a197, v8
v_accvgpr_write_b32 a198, v8
v_accvgpr_write_b32 a199, v8
v_accvgpr_write_b32 a200, v8
v_accvgpr_write_b32 a201, v8
v_accvgpr_write_b32 a202, v8
v_accvgpr_write_b32 a203, v8
v_accvgpr_write_b32 a204, v8
v_accvgpr_write_b32 a205, v8
v_accvgpr_write_b32 a206, v8
v_accvgpr_write_b32 a207, v8
v_accvgpr_write_b32 a208, v8
v_accvgpr_write_b32 a209, v8
v_accvgpr_write_b32 a210, v8
v_accvgpr_write_b32 a211, v8
v_accvgpr_write_b32 a212, v8
v_accvgpr_write_b32 a213, v8
v_accvgpr_write_b32 a214, v8
v_accvgpr_write_b32 a215, v8
v_lshrrev_b32 v4, 1, v3
v_lshlrev_b32 v4, 10, v4
v_and_b32 v5, 1, v3
v_lshlrev_b32 v5, 9, v5
v_lshl_add_u32 v4, v2, 4, v4
v_add_u32 v4, v4, v5
s_lshl_b32 s56, s49, 2
s_lshr_b32 s57, s50, 2
s_add_u32 s56, s56, s57
s_lshl_b32 s56, s56, 15
s_and_b32 s57, s50, 3
s_lshl_b32 s57, s57, 7
s_add_u32 s56, s56, s57
s_lshl_b32 s57, s51, 14
s_add_u32 s56, s56, s57
s_add_u32 s56, s56, 0x100000
v_mov_b32 v6, 0x3f803f80
v_mov_b32 v10, 0
v_mov_b32 v11, 0
s_waitcnt vmcnt(7)
v_dot2_f32_bf16 v10, v16, v6, v10
v_dot2_f32_bf16 v11, v16, v16, v11
v_dot2_f32_bf16 v10, v17, v6, v10
v_dot2_f32_bf16 v11, v17, v17, v11
v_dot2_f32_bf16 v10, v18, v6, v10
v_dot2_f32_bf16 v11, v18, v18, v11
v_dot2_f32_bf16 v10, v19, v6, v10
v_dot2_f32_bf16 v11, v19, v19, v11
s_waitcnt vmcnt(6)
v_dot2_f32_bf16 v10, v20, v6, v10
v_dot2_f32_bf16 v11, v20, v20, v11
v_dot2_f32_bf16 v10, v21, v6, v10
v_dot2_f32_bf16 v11, v21, v21, v11
v_dot2_f32_bf16 v10, v22, v6, v10
v_dot2_f32_bf16 v11, v22, v22, v11
v_dot2_f32_bf16 v10, v23, v6, v10
v_dot2_f32_bf16 v11, v23, v23, v11
s_waitcnt vmcnt(5)
v_dot2_f32_bf16 v10, v24, v6, v10
v_dot2_f32_bf16 v11, v24, v24, v11
v_dot2_f32_bf16 v10, v25, v6, v10
v_dot2_f32_bf16 v11, v25, v25, v11
v_dot2_f32_bf16 v10, v26, v6, v10
v_dot2_f32_bf16 v11, v26, v26, v11
v_dot2_f32_bf16 v10, v27, v6, v10
v_dot2_f32_bf16 v11, v27, v27, v11
s_waitcnt vmcnt(4)
v_dot2_f32_bf16 v10, v28, v6, v10
v_dot2_f32_bf16 v11, v28, v28, v11
v_dot2_f32_bf16 v10, v29, v6, v10
v_dot2_f32_bf16 v11, v29, v29, v11
v_dot2_f32_bf16 v10, v30, v6, v10
v_dot2_f32_bf16 v11, v30, v30, v11
v_dot2_f32_bf16 v10, v31, v6, v10
v_dot2_f32_bf16 v11, v31, v31, v11
s_waitcnt vmcnt(3)
v_dot2_f32_bf16 v10, v32, v6, v10
v_dot2_f32_bf16 v11, v32, v32, v11
v_dot2_f32_bf16 v10, v33, v6, v10
v_dot2_f32_bf16 v11, v33, v33, v11
v_dot2_f32_bf16 v10, v34, v6, v10
v_dot2_f32_bf16 v11, v34, v34, v11
v_dot2_f32_bf16 v10, v35, v6, v10
v_dot2_f32_bf16 v11, v35, v35, v11
s_waitcnt vmcnt(2)
v_dot2_f32_bf16 v10, v36, v6, v10
v_dot2_f32_bf16 v11, v36, v36, v11
v_dot2_f32_bf16 v10, v37, v6, v10
v_dot2_f32_bf16 v11, v37, v37, v11
v_dot2_f32_bf16 v10, v38, v6, v10
v_dot2_f32_bf16 v11, v38, v38, v11
v_dot2_f32_bf16 v10, v39, v6, v10
v_dot2_f32_bf16 v11, v39, v39, v11
s_waitcnt vmcnt(1)
v_dot2_f32_bf16 v10, v40, v6, v10
v_dot2_f32_bf16 v11, v40, v40, v11
v_dot2_f32_bf16 v10, v41, v6, v10
v_dot2_f32_bf16 v11, v41, v41, v11
v_dot2_f32_bf16 v10, v42, v6, v10
v_dot2_f32_bf16 v11, v42, v42, v11
v_dot2_f32_bf16 v10, v43, v6, v10
v_dot2_f32_bf16 v11, v43, v43, v11
s_waitcnt vmcnt(0)
v_dot2_f32_bf16 v10, v44, v6, v10
v_dot2_f32_bf16 v11, v44, v44, v11
v_dot2_f32_bf16 v10, v45, v6, v10
v_dot2_f32_bf16 v11, v45, v45, v11
v_dot2_f32_bf16 v10, v46, v6, v10
v_dot2_f32_bf16 v11, v46, v46, v11
v_dot2_f32_bf16 v10, v47, v6, v10
v_dot2_f32_bf16 v11, v47, v47, v11
v_readfirstlane_b32 s48, v9
s_mul_i32 s48, s48, 1664525
s_add_u32 s48, s48, 1013904223
v_add_f32_dpp v10, v10, v10 row_ror:8 row_mask:0xf bank_mask:0xf
v_mov_b32 v12, v10
s_nop 1
v_permlane16_swap_b32 v10, v12
v_add_f32 v10, v10, v12
v_mov_b32 v12, v10
s_nop 1
v_permlane32_swap_b32 v10, v12
v_add_f32 v10, v10, v12
v_add_f32_dpp v11, v11, v11 row_ror:8 row_mask:0xf bank_mask:0xf
v_mov_b32 v12, v11
s_nop 1
v_permlane16_swap_b32 v11, v12
v_add_f32 v11, v11, v12
v_mov_b32 v12, v11
s_nop 1
v_permlane32_swap_b32 v11, v12
v_add_f32 v11, v11, v12
v_mul_f32 v10, 0x3b000000, v10
v_mul_f32 v11, 0x3b000000, v11
v_fma_f32 v11, -v10, v10, v11
v_max_f32 v11, 0, v11
v_add_f32 v11, 0x3727c5ac, v11
v_rsq_f32 v11, v11
s_nop 0
v_mul_f32 v10, v10, v11
v_sub_f32 v10, 0, v10
v_lshlrev_b32 v48, 16, v16
v_and_b32 v49, 0xffff0000, v16
v_fma_f32 v48, v48, v11, v10
v_fma_f32 v49, v49, v11, v10
v_cvt_pk_f16_f32 v16, v48, v49
v_lshlrev_b32 v50, 16, v17
v_and_b32 v51, 0xffff0000, v17
v_fma_f32 v50, v50, v11, v10
v_fma_f32 v51, v51, v11, v10
v_cvt_pk_f16_f32 v17, v50, v51
v_lshlrev_b32 v52, 16, v18
v_and_b32 v53, 0xffff0000, v18
v_fma_f32 v52, v52, v11, v10
v_fma_f32 v53, v53, v11, v10
v_cvt_pk_f16_f32 v18, v52, v53
v_lshlrev_b32 v54, 16, v19
v_and_b32 v55, 0xffff0000, v19
v_fma_f32 v54, v54, v11, v10
v_fma_f32 v55, v55, v11, v10
v_cvt_pk_f16_f32 v19, v54, v55
buffer_store_dwordx4 v[16:19], v4, s[24:27], s56 offen sc1
s_add_u32 s56, s56, 4096
v_lshlrev_b32 v48, 16, v20
v_and_b32 v49, 0xffff0000, v20
v_fma_f32 v48, v48, v11, v10
v_fma_f32 v49, v49, v11, v10
v_cvt_pk_f16_f32 v20, v48, v49
v_lshlrev_b32 v50, 16, v21
v_and_b32 v51, 0xffff0000, v21
v_fma_f32 v50, v50, v11, v10
v_fma_f32 v51, v51, v11, v10
v_cvt_pk_f16_f32 v21, v50, v51
v_lshlrev_b32 v52, 16, v22
v_and_b32 v53, 0xffff0000, v22
v_fma_f32 v52, v52, v11, v10
v_fma_f32 v53, v53, v11, v10
v_cvt_pk_f16_f32 v22, v52, v53
v_lshlrev_b32 v54, 16, v23
v_and_b32 v55, 0xffff0000, v23
v_fma_f32 v54, v54, v11, v10
v_fma_f32 v55, v55, v11, v10
v_cvt_pk_f16_f32 v23, v54, v55
buffer_store_dwordx4 v[20:23], v4, s[24:27], s56 offen sc1
s_add_u32 s56, s56, 4096
v_lshlrev_b32 v48, 16, v24
v_and_b32 v49, 0xffff0000, v24
v_fma_f32 v48, v48, v11, v10
v_fma_f32 v49, v49, v11, v10
v_cvt_pk_f16_f32 v24, v48, v49
v_lshlrev_b32 v50, 16, v25
v_and_b32 v51, 0xffff0000, v25
v_fma_f32 v50, v50, v11, v10
v_fma_f32 v51, v51, v11, v10
v_cvt_pk_f16_f32 v25, v50, v51
v_lshlrev_b32 v52, 16, v26
v_and_b32 v53, 0xffff0000, v26
v_fma_f32 v52, v52, v11, v10
v_fma_f32 v53, v53, v11, v10
v_cvt_pk_f16_f32 v26, v52, v53
v_lshlrev_b32 v54, 16, v27
v_and_b32 v55, 0xffff0000, v27
v_fma_f32 v54, v54, v11, v10
v_fma_f32 v55, v55, v11, v10
v_cvt_pk_f16_f32 v27, v54, v55
buffer_store_dwordx4 v[24:27], v4, s[24:27], s56 offen sc1
s_add_u32 s56, s56, 4096
v_lshlrev_b32 v48, 16, v28
v_and_b32 v49, 0xffff0000, v28
v_fma_f32 v48, v48, v11, v10
v_fma_f32 v49, v49, v11, v10
v_cvt_pk_f16_f32 v28, v48, v49
v_lshlrev_b32 v50, 16, v29
v_and_b32 v51, 0xffff0000, v29
v_fma_f32 v50, v50, v11, v10
v_fma_f32 v51, v51, v11, v10
v_cvt_pk_f16_f32 v29, v50, v51
v_lshlrev_b32 v52, 16, v30
v_and_b32 v53, 0xffff0000, v30
v_fma_f32 v52, v52, v11, v10
v_fma_f32 v53, v53, v11, v10
v_cvt_pk_f16_f32 v30, v52, v53
v_lshlrev_b32 v54, 16, v31
v_and_b32 v55, 0xffff0000, v31
v_fma_f32 v54, v54, v11, v10
v_fma_f32 v55, v55, v11, v10
v_cvt_pk_f16_f32 v31, v54, v55
buffer_store_dwordx4 v[28:31], v4, s[24:27], s56 offen sc1
s_add_u32 s56, s56, 4096
v_lshlrev_b32 v48, 16, v32
v_and_b32 v49, 0xffff0000, v32
v_fma_f32 v48, v48, v11, v10
v_fma_f32 v49, v49, v11, v10
v_cvt_pk_f16_f32 v32, v48, v49
v_lshlrev_b32 v50, 16, v33
v_and_b32 v51, 0xffff0000, v33
v_fma_f32 v50, v50, v11, v10
v_fma_f32 v51, v51, v11, v10
v_cvt_pk_f16_f32 v33, v50, v51
v_lshlrev_b32 v52, 16, v34
v_and_b32 v53, 0xffff0000, v34
v_fma_f32 v52, v52, v11, v10
v_fma_f32 v53, v53, v11, v10
v_cvt_pk_f16_f32 v34, v52, v53
v_lshlrev_b32 v54, 16, v35
v_and_b32 v55, 0xffff0000, v35
v_fma_f32 v54, v54, v11, v10
v_fma_f32 v55, v55, v11, v10
v_cvt_pk_f16_f32 v35, v54, v55
buffer_store_dwordx4 v[32:35], v4, s[24:27], s56 offen sc1
s_add_u32 s56, s56, 4096
v_lshlrev_b32 v48, 16, v36
v_and_b32 v49, 0xffff0000, v36
v_fma_f32 v48, v48, v11, v10
v_fma_f32 v49, v49, v11, v10
v_cvt_pk_f16_f32 v36, v48, v49
v_lshlrev_b32 v50, 16, v37
v_and_b32 v51, 0xffff0000, v37
v_fma_f32 v50, v50, v11, v10
v_fma_f32 v51, v51, v11, v10
v_cvt_pk_f16_f32 v37, v50, v51
v_lshlrev_b32 v52, 16, v38
v_and_b32 v53, 0xffff0000, v38
v_fma_f32 v52, v52, v11, v10
v_fma_f32 v53, v53, v11, v10
v_cvt_pk_f16_f32 v38, v52, v53
v_lshlrev_b32 v54, 16, v39
v_and_b32 v55, 0xffff0000, v39
v_fma_f32 v54, v54, v11, v10
v_fma_f32 v55, v55, v11, v10
v_cvt_pk_f16_f32 v39, v54, v55
buffer_store_dwordx4 v[36:39], v4, s[24:27], s56 offen sc1
s_add_u32 s56, s56, 4096
v_lshlrev_b32 v48, 16, v40
v_and_b32 v49, 0xffff0000, v40
v_fma_f32 v48, v48, v11, v10
v_fma_f32 v49, v49, v11, v10
v_cvt_pk_f16_f32 v40, v48, v49
v_lshlrev_b32 v50, 16, v41
v_and_b32 v51, 0xffff0000, v41
v_fma_f32 v50, v50, v11, v10
v_fma_f32 v51, v51, v11, v10
v_cvt_pk_f16_f32 v41, v50, v51
v_lshlrev_b32 v52, 16, v42
v_and_b32 v53, 0xffff0000, v42
v_fma_f32 v52, v52, v11, v10
v_fma_f32 v53, v53, v11, v10
v_cvt_pk_f16_f32 v42, v52, v53
v_lshlrev_b32 v54, 16, v43
v_and_b32 v55, 0xffff0000, v43
v_fma_f32 v54, v54, v11, v10
v_fma_f32 v55, v55, v11, v10
v_cvt_pk_f16_f32 v43, v54, v55
buffer_store_dwordx4 v[40:43], v4, s[24:27], s56 offen sc1
s_add_u32 s56, s56, 4096
v_lshlrev_b32 v48, 16, v44
v_and_b32 v49, 0xffff0000, v44
v_fma_f32 v48, v48, v11, v10
v_fma_f32 v49, v49, v11, v10
v_cvt_pk_f16_f32 v44, v48, v49
v_lshlrev_b32 v50, 16, v45
v_and_b32 v51, 0xffff0000, v45
v_fma_f32 v50, v50, v11, v10
v_fma_f32 v51, v51, v11, v10
v_cvt_pk_f16_f32 v45, v50, v51
v_lshlrev_b32 v52, 16, v46
v_and_b32 v53, 0xffff0000, v46
v_fma_f32 v52, v52, v11, v10
v_fma_f32 v53, v53, v11, v10
v_cvt_pk_f16_f32 v46, v52, v53
v_lshlrev_b32 v54, 16, v47
v_and_b32 v55, 0xffff0000, v47
v_fma_f32 v54, v54, v11, v10
v_fma_f32 v55, v55, v11, v10
v_cvt_pk_f16_f32 v47, v54, v55
buffer_store_dwordx4 v[44:47], v4, s[24:27], s56 offen sc1
v_add_u32 v2, 0, v0
v_mul_u32_u24 v3, 4682, v2
v_lshrrev_b32 v3, 16, v3
v_mul_u32_u24 v4, 14, v3
v_sub_u32 v4, v2, v4
v_lshlrev_b32 v4, 4, v4
v_mul_u32_u24 v3, 3584, v3
v_add_u32 v20, v3, v4
v_add_u32 v2, 64, v0
v_mul_u32_u24 v3, 4682, v2
v_lshrrev_b32 v3, 16, v3
v_mul_u32_u24 v4, 14, v3
v_sub_u32 v4, v2, v4
v_lshlrev_b32 v4, 4, v4
v_mul_u32_u24 v3, 3584, v3
v_add_u32 v21, v3, v4
v_add_u32 v2, 0x80, v0
v_mul_u32_u24 v3, 4682, v2
v_lshrrev_b32 v3, 16, v3
v_mul_u32_u24 v4, 14, v3
v_sub_u32 v4, v2, v4
v_lshlrev_b32 v4, 4, v4
v_mul_u32_u24 v3, 3584, v3
v_add_u32 v22, v3, v4
v_add_u32 v2, 0xc0, v0
v_mul_u32_u24 v3, 4682, v2
v_lshrrev_b32 v3, 16, v3
v_mul_u32_u24 v4, 14, v3
v_sub_u32 v4, v2, v4
v_lshlrev_b32 v4, 4, v4
v_mul_u32_u24 v3, 3584, v3
v_add_u32 v23, v3, v4
v_add_u32 v2, 0x100, v0
v_mul_u32_u24 v3, 4682, v2
v_lshrrev_b32 v3, 16, v3
v_mul_u32_u24 v4, 14, v3
v_sub_u32 v4, v2, v4
v_lshlrev_b32 v4, 4, v4
v_mul_u32_u24 v3, 3584, v3
v_add_u32 v24, v3, v4
v_add_u32 v2, 0x140, v0
v_mul_u32_u24 v3, 4682, v2
v_lshrrev_b32 v3, 16, v3
v_mul_u32_u24 v4, 14, v3
v_sub_u32 v4, v2, v4
v_lshlrev_b32 v4, 4, v4
v_mul_u32_u24 v3, 3584, v3
v_add_u32 v25, v3, v4
v_add_u32 v2, 0x180, v0
v_mul_u32_u24 v3, 4682, v2
v_lshrrev_b32 v3, 16, v3
v_mul_u32_u24 v4, 14, v3
v_sub_u32 v4, v2, v4
v_lshlrev_b32 v4, 4, v4
v_mul_u32_u24 v3, 3584, v3
v_add_u32 v26, v3, v4
s_waitcnt vmcnt(0)
s_lshl_b32 s60, s49, 4
s_add_u32 s60, s60, s50
s_lshl_b32 s60, s60, 2
s_add_u32 s60, s60, s51
s_lshl_b32 s60, s60, 6
s_add_u32 s60, s60, 0x10000
v_mov_b32 v12, s48
s_mov_b64 exec, 1
buffer_store_dword v12, off, s[24:27], s60 sc1
s_mov_b64 exec, -1
s_mul_i32 s56, s50, 224
s_add_u32 s56, s56, 0xe0000
s_mov_b32 m0, 0x1e000
s_nop 0
buffer_load_dwordx4 v20, s[16:19], s56 offen lds
s_mov_b32 m0, 0x1e400
s_nop 0
buffer_load_dwordx4 v21, s[16:19], s56 offen lds
s_mov_b32 m0, 0x1e800
s_nop 0
buffer_load_dwordx4 v22, s[16:19], s56 offen lds
s_mov_b32 m0, 0x1ec00
s_nop 0
buffer_load_dwordx4 v23, s[16:19], s56 offen lds
s_mov_b32 m0, 0x1f000
s_nop 0
buffer_load_dwordx4 v24, s[16:19], s56 offen lds
s_mov_b32 m0, 0x1f400
s_nop 0
buffer_load_dwordx4 v25, s[16:19], s56 offen lds
s_mov_b32 m0, 0x1f800
s_nop 0
buffer_load_dwordx4 v26, s[16:19], s56 offen lds
s_add_u32 s56, s56, 0x1c000
s_mov_b32 m0, 0x1fc00
s_nop 0
buffer_load_dwordx4 v20, s[16:19], s56 offen lds
s_mov_b32 m0, 0x20000
s_nop 0
buffer_load_dwordx4 v21, s[16:19], s56 offen lds
s_mov_b32 m0, 0x20400
s_nop 0
buffer_load_dwordx4 v22, s[16:19], s56 offen lds
s_mov_b32 m0, 0x20800
s_nop 0
buffer_load_dwordx4 v23, s[16:19], s56 offen lds
s_mov_b32 m0, 0x20c00
s_nop 0
buffer_load_dwordx4 v24, s[16:19], s56 offen lds
s_mov_b32 m0, 0x21000
s_nop 0
buffer_load_dwordx4 v25, s[16:19], s56 offen lds
s_mov_b32 m0, 0x21400
s_nop 0
buffer_load_dwordx4 v26, s[16:19], s56 offen lds
s_add_u32 s56, s56, 0x1c000
s_mov_b32 m0, 0x21800
s_nop 0
buffer_load_dwordx4 v20, s[16:19], s56 offen lds
s_mov_b32 m0, 0x21c00
s_nop 0
buffer_load_dwordx4 v21, s[16:19], s56 offen lds
s_mov_b32 m0, 0x22000
s_nop 0
buffer_load_dwordx4 v22, s[16:19], s56 offen lds
s_mov_b32 m0, 0x22400
s_nop 0
buffer_load_dwordx4 v23, s[16:19], s56 offen lds
s_mov_b32 m0, 0x22800
s_nop 0
buffer_load_dwordx4 v24, s[16:19], s56 offen lds
s_mov_b32 m0, 0x22c00
s_nop 0
buffer_load_dwordx4 v25, s[16:19], s56 offen lds
s_mov_b32 m0, 0x23000
s_nop 0
buffer_load_dwordx4 v26, s[16:19], s56 offen lds
s_add_u32 s56, s56, 0x1c000
s_mov_b32 m0, 0x23400
s_nop 0
buffer_load_dwordx4 v20, s[16:19], s56 offen lds
s_mov_b32 m0, 0x23800
s_nop 0
buffer_load_dwordx4 v21, s[16:19], s56 offen lds
s_mov_b32 m0, 0x23c00
s_nop 0
buffer_load_dwordx4 v22, s[16:19], s56 offen lds
s_mov_b32 m0, 0x24000
s_nop 0
buffer_load_dwordx4 v23, s[16:19], s56 offen lds
s_mov_b32 m0, 0x24400
s_nop 0
buffer_load_dwordx4 v24, s[16:19], s56 offen lds
s_mov_b32 m0, 0x24800
s_nop 0
buffer_load_dwordx4 v25, s[16:19], s56 offen lds
s_mov_b32 m0, 0x24c00
s_nop 0
buffer_load_dwordx4 v26, s[16:19], s56 offen lds
s_add_u32 s56, s56, 0x1c000
s_branch LMERGE
s_nop 0
LW3:
s_lshl_b32 s57, s49, 17
s_lshl_b32 s58, s50, 13
s_add_u32 s57, s57, s58
buffer_load_dword v14, off, s[4:7], s57
v_mov_b32 v8, 0x3f803f80
v_accvgpr_write_b32 a72, v8
v_accvgpr_write_b32 a73, v8
v_accvgpr_write_b32 a74, v8
v_accvgpr_write_b32 a75, v8
v_accvgpr_write_b32 a76, v8
v_accvgpr_write_b32 a77, v8
v_accvgpr_write_b32 a78, v8
v_accvgpr_write_b32 a79, v8
v_accvgpr_write_b32 a80, v8
v_accvgpr_write_b32 a81, v8
v_accvgpr_write_b32 a82, v8
v_accvgpr_write_b32 a83, v8
v_accvgpr_write_b32 a84, v8
v_accvgpr_write_b32 a85, v8
v_accvgpr_write_b32 a86, v8
v_accvgpr_write_b32 a87, v8
v_accvgpr_write_b32 a88, v8
v_accvgpr_write_b32 a89, v8
v_accvgpr_write_b32 a90, v8
v_accvgpr_write_b32 a91, v8
v_accvgpr_write_b32 a92, v8
v_accvgpr_write_b32 a93, v8
v_accvgpr_write_b32 a94, v8
v_accvgpr_write_b32 a95, v8
v_accvgpr_write_b32 a96, v8
v_accvgpr_write_b32 a97, v8
v_accvgpr_write_b32 a98, v8
v_accvgpr_write_b32 a99, v8
v_accvgpr_write_b32 a100, v8
v_accvgpr_write_b32 a101, v8
v_accvgpr_write_b32 a102, v8
v_accvgpr_write_b32 a103, v8
v_accvgpr_write_b32 a104, v8
v_accvgpr_write_b32 a105, v8
v_accvgpr_write_b32 a106, v8
v_accvgpr_write_b32 a107, v8
v_accvgpr_write_b32 a108, v8
v_accvgpr_write_b32 a109, v8
v_accvgpr_write_b32 a110, v8
v_accvgpr_write_b32 a111, v8
v_accvgpr_write_b32 a112, v8
v_accvgpr_write_b32 a113, v8
v_accvgpr_write_b32 a114, v8
v_accvgpr_write_b32 a115, v8
v_accvgpr_write_b32 a116, v8
v_accvgpr_write_b32 a117, v8
v_accvgpr_write_b32 a118, v8
v_accvgpr_write_b32 a119, v8
v_accvgpr_write_b32 a120, v8
v_accvgpr_write_b32 a121, v8
v_accvgpr_write_b32 a122, v8
v_accvgpr_write_b32 a123, v8
v_accvgpr_write_b32 a124, v8
v_accvgpr_write_b32 a125, v8
v_accvgpr_write_b32 a126, v8
v_accvgpr_write_b32 a127, v8
v_accvgpr_write_b32 a128, v8
v_accvgpr_write_b32 a129, v8
v_accvgpr_write_b32 a130, v8
v_accvgpr_write_b32 a131, v8
v_accvgpr_write_b32 a132, v8
v_accvgpr_write_b32 a133, v8
v_accvgpr_write_b32 a134, v8
v_accvgpr_write_b32 a135, v8
v_accvgpr_write_b32 a136, v8
v_accvgpr_write_b32 a137, v8
v_accvgpr_write_b32 a138, v8
v_accvgpr_write_b32 a139, v8
v_accvgpr_write_b32 a140, v8
v_accvgpr_write_b32 a141, v8
v_accvgpr_write_b32 a142, v8
v_accvgpr_write_b32 a143, v8
v_accvgpr_write_b32 a144, v8
v_accvgpr_write_b32 a145, v8
v_accvgpr_write_b32 a146, v8
v_accvgpr_write_b32 a147, v8
v_accvgpr_write_b32 a148, v8
v_accvgpr_write_b32 a149, v8
v_accvgpr_write_b32 a150, v8
v_accvgpr_write_b32 a151, v8
v_accvgpr_write_b32 a152, v8
v_accvgpr_write_b32 a153, v8
v_accvgpr_write_b32 a154, v8
v_accvgpr_write_b32 a155, v8
v_accvgpr_write_b32 a156, v8
v_accvgpr_write_b32 a157, v8
v_accvgpr_write_b32 a158, v8
v_accvgpr_write_b32 a159, v8
v_accvgpr_write_b32 a160, v8
v_accvgpr_write_b32 a161, v8
v_accvgpr_write_b32 a162, v8
v_accvgpr_write_b32 a163, v8
v_accvgpr_write_b32 a164, v8
v_accvgpr_write_b32 a165, v8
v_accvgpr_write_b32 a166, v8
v_accvgpr_write_b32 a167, v8
v_accvgpr_write_b32 a168, v8
v_accvgpr_write_b32 a169, v8
v_accvgpr_write_b32 a170, v8
v_accvgpr_write_b32 a171, v8
v_accvgpr_write_b32 a172, v8
v_accvgpr_write_b32 a173, v8
v_accvgpr_write_b32 a174, v8
v_accvgpr_write_b32 a175, v8
v_accvgpr_write_b32 a176, v8
v_accvgpr_write_b32 a177, v8
v_accvgpr_write_b32 a178, v8
v_accvgpr_write_b32 a179, v8
v_accvgpr_write_b32 a180, v8
v_accvgpr_write_b32 a181, v8
v_accvgpr_write_b32 a182, v8
v_accvgpr_write_b32 a183, v8
v_accvgpr_write_b32 a184, v8
v_accvgpr_write_b32 a185, v8
v_accvgpr_write_b32 a186, v8
v_accvgpr_write_b32 a187, v8
v_accvgpr_write_b32 a188, v8
v_accvgpr_write_b32 a189, v8
v_accvgpr_write_b32 a190, v8
v_accvgpr_write_b32 a191, v8
v_accvgpr_write_b32 a192, v8
v_accvgpr_write_b32 a193, v8
v_accvgpr_write_b32 a194, v8
v_accvgpr_write_b32 a195, v8
v_accvgpr_write_b32 a196, v8
v_accvgpr_write_b32 a197, v8
v_accvgpr_write_b32 a198, v8
v_accvgpr_write_b32 a199, v8
v_accvgpr_write_b32 a200, v8
v_accvgpr_write_b32 a201, v8
v_accvgpr_write_b32 a202, v8
v_accvgpr_write_b32 a203, v8
v_accvgpr_write_b32 a204, v8
v_accvgpr_write_b32 a205, v8
v_accvgpr_write_b32 a206, v8
v_accvgpr_write_b32 a207, v8
v_accvgpr_write_b32 a208, v8
v_accvgpr_write_b32 a209, v8
v_accvgpr_write_b32 a210, v8
v_accvgpr_write_b32 a211, v8
v_accvgpr_write_b32 a212, v8
v_accvgpr_write_b32 a213, v8
v_accvgpr_write_b32 a214, v8
v_accvgpr_write_b32 a215, v8
s_waitcnt vmcnt(0)
v_mov_b32 v14, v14
s_add_u32 s56, s51, 1
s_lshl_b32 s57, s56, 9
s_add_u32 s57, s57, s55
s_lshl_b32 s58, s56, 14
s_add_u32 m0, s58, 0x0
s_nop 0
buffer_load_dwordx4 v13, s[8:11], s57 offen lds
s_add_u32 s57, s57, 0xc000
s_add_u32 m0, s58, 0x400
s_nop 0
buffer_load_dwordx4 v13, s[8:11], s57 offen lds
s_add_u32 s57, s57, 0xc000
s_add_u32 m0, s58, 0x800
s_nop 0
buffer_load_dwordx4 v13, s[8:11], s57 offen lds
s_add_u32 s57, s57, 0xc000
s_add_u32 m0, s58, 0xc00
s_nop 0
buffer_load_dwordx4 v13, s[8:11], s57 offen lds
s_add_u32 s57, s57, 0xc000
s_add_u32 m0, s58, 0x1000
s_nop 0
buffer_load_dwordx4 v13, s[8:11], s57 offen lds
s_add_u32 s57, s57, 0xc000
s_add_u32 m0, s58, 0x1400
s_nop 0
buffer_load_dwordx4 v13, s[8:11], s57 offen lds
s_add_u32 s57, s57, 0xc000
s_add_u32 m0, s58, 0x1800
s_nop 0
buffer_load_dwordx4 v13, s[8:11], s57 offen lds
s_add_u32 s57, s57, 0xc000
s_add_u32 m0, s58, 0x1c00
s_nop 0
buffer_load_dwordx4 v13, s[8:11], s57 offen lds
s_add_u32 s57, s57, 0xc000
s_add_u32 m0, s58, 0x2000
s_nop 0
buffer_load_dwordx4 v13, s[8:11], s57 offen lds
s_add_u32 s57, s57, 0xc000
s_add_u32 m0, s58, 0x2400
s_nop 0
buffer_load_dwordx4 v13, s[8:11], s57 offen lds
s_add_u32 s57, s57, 0xc000
s_add_u32 m0, s58, 0x2800
s_nop 0
buffer_load_dwordx4 v13, s[8:11], s57 offen lds
s_add_u32 s57, s57, 0xc000
s_add_u32 m0, s58, 0x2c00
s_nop 0
buffer_load_dwordx4 v13, s[8:11], s57 offen lds
s_add_u32 s57, s57, 0xc000
s_add_u32 m0, s58, 0x3000
s_nop 0
buffer_load_dwordx4 v13, s[8:11], s57 offen lds
s_add_u32 s57, s57, 0xc000
s_add_u32 m0, s58, 0x3400
s_nop 0
buffer_load_dwordx4 v13, s[8:11], s57 offen lds
s_add_u32 s57, s57, 0xc000
s_add_u32 m0, s58, 0x3800
s_nop 0
buffer_load_dwordx4 v13, s[8:11], s57 offen lds
s_add_u32 s57, s57, 0xc000
s_add_u32 m0, s58, 0x3c00
s_nop 0
buffer_load_dwordx4 v13, s[8:11], s57 offen lds
s_add_u32 s57, s57, 0xc000
s_add_u32 m0, s58, 0x4000
s_nop 0
buffer_load_dwordx4 v13, s[8:11], s57 offen lds
s_add_u32 s57, s57, 0xc000
s_add_u32 m0, s58, 0x4400
s_nop 0
buffer_load_dwordx4 v13, s[8:11], s57 offen lds
s_add_u32 s57, s57, 0xc000
s_add_u32 m0, s58, 0x4800
s_nop 0
buffer_load_dwordx4 v13, s[8:11], s57 offen lds
s_add_u32 s57, s57, 0xc000
s_add_u32 m0, s58, 0x4c00
s_nop 0
buffer_load_dwordx4 v13, s[8:11], s57 offen lds
s_add_u32 s57, s57, 0xc000
s_add_u32 m0, s58, 0x5000
s_nop 0
buffer_load_dwordx4 v13, s[8:11], s57 offen lds
s_add_u32 s57, s57, 0xc000
s_add_u32 m0, s58, 0x5400
s_nop 0
buffer_load_dwordx4 v13, s[8:11], s57 offen lds
s_add_u32 s57, s57, 0xc000
s_add_u32 m0, s58, 0x5800
s_nop 0
buffer_load_dwordx4 v13, s[8:11], s57 offen lds
s_add_u32 s57, s57, 0xc000
s_add_u32 m0, s58, 0x5c00
s_nop 0
buffer_load_dwordx4 v13, s[8:11], s57 offen lds
s_add_u32 s57, s57, 0xc000
s_add_u32 m0, s58, 0x6000
s_nop 0
buffer_load_dwordx4 v13, s[8:11], s57 offen lds
s_add_u32 s57, s57, 0xc000
s_add_u32 m0, s58, 0x6400
s_nop 0
buffer_load_dwordx4 v13, s[8:11], s57 offen lds
s_add_u32 s57, s57, 0xc000
s_add_u32 m0, s58, 0x6800
s_nop 0
buffer_load_dwordx4 v13, s[8:11], s57 offen lds
s_add_u32 s57, s57, 0xc000
s_add_u32 m0, s58, 0x6c00
s_nop 0
buffer_load_dwordx4 v13, s[8:11], s57 offen lds
s_add_u32 s57, s57, 0xc000
s_add_u32 m0, s58, 0x7000
s_nop 0
buffer_load_dwordx4 v13, s[8:11], s57 offen lds
s_add_u32 s57, s57, 0xc000
s_add_u32 m0, s58, 0x7400
s_nop 0
buffer_load_dwordx4 v13, s[8:11], s57 offen lds
s_add_u32 s57, s57, 0xc000
s_add_u32 m0, s58, 0x7800
s_nop 0
buffer_load_dwordx4 v13, s[8:11], s57 offen lds
s_add_u32 s57, s57, 0xc000
s_add_u32 m0, s58, 0x7c00
s_nop 0
buffer_load_dwordx4 v13, s[8:11], s57 offen lds
s_add_u32 s57, s57, 0xc000
s_lshr_b32 s56, s51, 1
s_mul_i32 s57, s56, 0x90000
s_add_u32 s57, s57, s55
s_add_u32 s57, s57, 0x60000
s_mul_i32 s58, s56, 0x3000
s_add_u32 m0, s58, 0x2000
s_nop 0
buffer_load_dwordx4 v13, s[8:11], s57 offen lds
s_add_u32 s57, s57, 0xc000
s_add_u32 m0, s58, 0x2400
s_nop 0
buffer_load_dwordx4 v13, s[8:11], s57 offen lds
s_add_u32 s57, s57, 0xc000
s_add_u32 m0, s58, 0x2800
s_nop 0
buffer_load_dwordx4 v13, s[8:11], s57 offen lds
s_add_u32 s57, s57, 0xc000
s_add_u32 m0, s58, 0x2c00
s_nop 0
buffer_load_dwordx4 v13, s[8:11], s57 offen lds
s_add_u32 s57, s57, 0xc000
s_add_u32 m0, s58, 0x3000
s_nop 0
buffer_load_dwordx4 v13, s[8:11], s57 offen lds
s_add_u32 s57, s57, 0xc000
s_add_u32 m0, s58, 0x3400
s_nop 0
buffer_load_dwordx4 v13, s[8:11], s57 offen lds
s_add_u32 s57, s57, 0xc000
s_add_u32 m0, s58, 0x3800
s_nop 0
buffer_load_dwordx4 v13, s[8:11], s57 offen lds
s_add_u32 s57, s57, 0xc000
s_add_u32 m0, s58, 0x3c00
s_nop 0
buffer_load_dwordx4 v13, s[8:11], s57 offen lds
s_add_u32 s57, s57, 0xc000
s_add_u32 m0, s58, 0x4000
s_nop 0
buffer_load_dwordx4 v13, s[8:11], s57 offen lds
s_add_u32 s57, s57, 0xc000
s_add_u32 m0, s58, 0x4400
s_nop 0
buffer_load_dwordx4 v13, s[8:11], s57 offen lds
s_add_u32 s57, s57, 0xc000
s_add_u32 m0, s58, 0x4800
s_nop 0
buffer_load_dwordx4 v13, s[8:11], s57 offen lds
s_add_u32 s57, s57, 0xc000
s_add_u32 m0, s58, 0x4c00
s_nop 0
buffer_load_dwordx4 v13, s[8:11], s57 offen lds
s_add_u32 s57, s57, 0xc000
s_getpc_b64 s[62:63]
LPC:
v_lshlrev_b32 v4, 7, v0
s_lshr_b32 s56, s51, 1
s_lshl_b32 s56, s56, 13
v_add_u32 v4, s56, v4
v_min_u32 v5, LEND-LPC, v4
global_load_dword v255, v5, s[62:63]
v_add_u32 v4, 0x4000, v4
v_min_u32 v5, LEND-LPC, v4
global_load_dword v255, v5, s[62:63]
v_add_u32 v4, 0x4000, v4
v_min_u32 v5, LEND-LPC, v4
global_load_dword v255, v5, s[62:63]
v_add_u32 v4, 0x4000, v4
v_min_u32 v5, LEND-LPC, v4
global_load_dword v255, v5, s[62:63]
v_add_u32 v4, 0x4000, v4
v_readfirstlane_b32 s48, v9
s_mul_i32 s48, s48, 1664525
s_add_u32 s48, s48, 1013904223
s_branch LMERGE
s_nop 1
LW2:
s_cmp_ge_u32 s53, 24
s_cbranch_scc1 LNOMOD
s_min_u32 s63, s53, 23
s_lshr_b32 s63, s63, 2
s_lshl_b32 s62, s54, 1
s_add_u32 s62, s62, s63
s_lshl_b32 s60, s54, 2
s_add_u32 s60, s60, s63
s_add_u32 s60, s60, 14
s_cmp_lt_u32 s53, 8
s_cselect_b32 s62, s62, s60
s_lshl_b32 s62, s62, 6
s_and_b32 s63, s53, 3
s_lshl_b32 s63, s63, 4
s_add_u32 s62, s62, s63
s_mov_b32 s58, s62
v_lshrrev_b32 v2, 1, v0
v_mul_u32_u24 v2, 6144, v2
v_and_b32 v3, 1, v0
v_lshl_add_u32 v10, v3, 4, v2
s_lshl_b32 s59, s58, 1
buffer_load_dwordx4 v[156:159], v1, s[36:39], 0 offen
s_mov_b32 m0, 0x18000
s_nop 0
buffer_load_dwordx4 v10, s[32:35], s59 offen lds
s_add_u32 s59, s59, 0x30000
s_mov_b32 m0, 0x18400
s_nop 0
buffer_load_dwordx4 v10, s[32:35], s59 offen lds
s_add_u32 s59, s59, 0x30000
s_mov_b32 m0, 0x18800
s_nop 0
buffer_load_dwordx4 v10, s[32:35], s59 offen lds
s_add_u32 s59, s59, 0x30000
s_mov_b32 m0, 0x18c00
s_nop 0
buffer_load_dwordx4 v10, s[32:35], s59 offen lds
s_add_u32 s59, s59, 0x30000
s_mov_b32 m0, 0x19000
s_nop 0
buffer_load_dwordx4 v10, s[32:35], s59 offen lds
s_add_u32 s59, s59, 0x30000
s_mov_b32 m0, 0x19400
s_nop 0
buffer_load_dwordx4 v10, s[32:35], s59 offen lds
s_add_u32 s59, s59, 0x30000
s_mov_b32 m0, 0x19800
s_nop 0
buffer_load_dwordx4 v10, s[32:35], s59 offen lds
s_add_u32 s59, s59, 0x30000
s_mov_b32 m0, 0x19c00
s_nop 0
buffer_load_dwordx4 v10, s[32:35], s59 offen lds
s_add_u32 s59, s59, 0x30000
s_mov_b32 m0, 0x1a000
s_nop 0
buffer_load_dwordx4 v10, s[32:35], s59 offen lds
s_add_u32 s59, s59, 0x30000
s_mov_b32 m0, 0x1a400
s_nop 0
buffer_load_dwordx4 v10, s[32:35], s59 offen lds
s_add_u32 s59, s59, 0x30000
s_mov_b32 m0, 0x1a800
s_nop 0
buffer_load_dwordx4 v10, s[32:35], s59 offen lds
s_add_u32 s59, s59, 0x30000
s_mov_b32 m0, 0x1ac00
s_nop 0
buffer_load_dwordx4 v10, s[32:35], s59 offen lds
s_add_u32 s59, s59, 0x30000
s_mov_b32 m0, 0x1b000
s_nop 0
buffer_load_dwordx4 v10, s[32:35], s59 offen lds
s_add_u32 s59, s59, 0x30000
s_mov_b32 m0, 0x1b400
s_nop 0
buffer_load_dwordx4 v10, s[32:35], s59 offen lds
s_add_u32 s59, s59, 0x30000
s_mov_b32 m0, 0x1b800
s_nop 0
buffer_load_dwordx4 v10, s[32:35], s59 offen lds
s_add_u32 s59, s59, 0x30000
s_mov_b32 m0, 0x1bc00
s_nop 0
buffer_load_dwordx4 v10, s[32:35], s59 offen lds
s_add_u32 s59, s59, 0x30000
s_waitcnt vmcnt(16)
v_lshlrev_b32 v160, 16, v156
v_and_b32 v161, 0xffff0000, v156
v_lshlrev_b32 v162, 16, v157
v_and_b32 v163, 0xffff0000, v157
v_lshlrev_b32 v164, 16, v158
v_and_b32 v165, 0xffff0000, v158
v_lshlrev_b32 v166, 16, v159
v_and_b32 v167, 0xffff0000, v159
v_mul_f32 v168, 0xbfb8aa3b, v160
v_exp_f32 v168, v168
v_mul_f32 v169, 0xbfb8aa3b, v161
v_exp_f32 v169, v169
v_mul_f32 v170, 0xbfb8aa3b, v162
v_exp_f32 v170, v170
v_mul_f32 v171, 0xbfb8aa3b, v163
v_exp_f32 v171, v171
v_mul_f32 v172, 0xbfb8aa3b, v164
v_exp_f32 v172, v172
v_mul_f32 v173, 0xbfb8aa3b, v165
v_exp_f32 v173, v173
v_mul_f32 v174, 0xbfb8aa3b, v166
v_exp_f32 v174, v174
v_mul_f32 v175, 0xbfb8aa3b, v167
v_exp_f32 v175, v175
v_add_f32 v168, 1.0, v168
v_rcp_f32 v168, v168
v_add_f32 v169, 1.0, v169
v_rcp_f32 v169, v169
v_add_f32 v170, 1.0, v170
v_rcp_f32 v170, v170
v_add_f32 v171, 1.0, v171
v_rcp_f32 v171, v171
v_add_f32 v172, 1.0, v172
v_rcp_f32 v172, v172
v_add_f32 v173, 1.0, v173
v_rcp_f32 v173, v173
v_add_f32 v174, 1.0, v174
v_rcp_f32 v174, v174
v_add_f32 v175, 1.0, v175
v_rcp_f32 v175, v175
v_mul_f32 v168, v168, v160
v_mul_f32 v169, v169, v161
v_mul_f32 v170, v170, v162
v_mul_f32 v171, v171, v163
v_mul_f32 v172, v172, v164
v_mul_f32 v173, v173, v165
v_mul_f32 v174, v174, v166
v_mul_f32 v175, v175, v167
v_cvt_pk_bf16_f32 v156, v168, v169
v_cvt_pk_bf16_f32 v157, v170, v171
v_cvt_pk_bf16_f32 v158, v172, v173
v_cvt_pk_bf16_f32 v159, v174, v175
v_add_u32 v2, 0x27800, v1
ds_write_b128 v2, v[156:159]
v_lshrrev_b32 v3, 4, v0
v_lshlrev_b32 v4, 3, v3
v_add_u32 v4, 0x27800, v4
ds_read_b64 a[0:1], v4 offset:0
ds_read_b64 a[2:3], v4 offset:32
ds_read_b64 a[4:5], v4 offset:64
ds_read_b64 a[6:7], v4 offset:96
ds_read_b64 a[8:9], v4 offset:128
ds_read_b64 a[10:11], v4 offset:160
ds_read_b64 a[12:13], v4 offset:192
ds_read_b64 a[14:15], v4 offset:224
ds_read_b64 a[16:17], v4 offset:256
ds_read_b64 a[18:19], v4 offset:288
ds_read_b64 a[20:21], v4 offset:320
ds_read_b64 a[22:23], v4 offset:352
ds_read_b64 a[24:25], v4 offset:384
ds_read_b64 a[26:27], v4 offset:416
ds_read_b64 a[28:29], v4 offset:448
ds_read_b64 a[30:31], v4 offset:480
ds_read_b64 a[32:33], v4 offset:512
ds_read_b64 a[34:35], v4 offset:544
ds_read_b64 a[36:37], v4 offset:576
ds_read_b64 a[38:39], v4 offset:608
ds_read_b64 a[40:41], v4 offset:640
ds_read_b64 a[42:43], v4 offset:672
ds_read_b64 a[44:45], v4 offset:704
ds_read_b64 a[46:47], v4 offset:736
ds_read_b64 a[48:49], v4 offset:768
ds_read_b64 a[50:51], v4 offset:800
ds_read_b64 a[52:53], v4 offset:832
ds_read_b64 a[54:55], v4 offset:864
ds_read_b64 a[56:57], v4 offset:896
ds_read_b64 a[58:59], v4 offset:928
ds_read_b64 a[60:61], v4 offset:960
ds_read_b64 a[62:63], v4 offset:992
v_bfe_u32 v5, v0, 2, 2
v_lshl_add_u32 v5, v3, 2, v5
v_lshlrev_b32 v5, 5, v5
v_and_b32 v6, 3, v0
v_lshl_add_u32 v5, v6, 3, v5
v_add_u32 v5, 0x18000, v5
v_readfirstlane_b32 s48, v9
s_mul_i32 s48, s48, 1664525
s_add_u32 s48, s48, 1013904223
s_lshr_b32 s59, s58, 9
s_cmp_eq_u32 s59, 1
s_cselect_b32 s60, 1.0, 0
s_cmp_eq_u32 s59, 4
s_cselect_b32 s60, 1.0, s60
s_lshl_b32 s58, s58, 2
s_add_u32 s58, s58, 0xa0000
v_lshlrev_b32 v3, 4, v3
v_and_b32 v4, 15, v0
v_mul_u32_u24 v4, 0x4100, v4
v_add_u32 v3, v3, v4
v_mov_b32 v165, s48
v_mov_b32 v167, s48
s_waitcnt vmcnt(15)
ds_read_b64_tr_b16 a[64:65], v5 offset:0
ds_read_b64_tr_b16 a[66:67], v5 offset:512
s_waitcnt vmcnt(14)
ds_read_b64_tr_b16 a[68:69], v5 offset:1024
ds_read_b64_tr_b16 a[70:71], v5 offset:1536
s_waitcnt vmcnt(13)
ds_read_b64_tr_b16 a[72:73], v5 offset:2048
ds_read_b64_tr_b16 a[74:75], v5 offset:2560
s_waitcnt lgkmcnt(4)
v_mfma_f32_16x16x32_bf16 v[140:143], a[64:67], a[0:3], 0
s_waitcnt vmcnt(12)
ds_read_b64_tr_b16 a[76:77], v5 offset:3072
ds_read_b64_tr_b16 a[78:79], v5 offset:3584
s_waitcnt lgkmcnt(4)
v_mfma_f32_16x16x32_bf16 v[144:147], a[68:71], a[4:7], 0
s_waitcnt vmcnt(11)
ds_read_b64_tr_b16 a[80:81], v5 offset:4096
ds_read_b64_tr_b16 a[82:83], v5 offset:4608
s_waitcnt lgkmcnt(4)
v_mfma_f32_16x16x32_bf16 v[140:143], a[72:75], a[8:11], v[140:143]
s_waitcnt vmcnt(10)
ds_read_b64_tr_b16 a[84:85], v5 offset:5120
ds_read_b64_tr_b16 a[86:87], v5 offset:5632
s_waitcnt lgkmcnt(4)
v_mfma_f32_16x16x32_bf16 v[144:147], a[76:79], a[12:15], v[144:147]
s_waitcnt vmcnt(9)
ds_read_b64_tr_b16 a[88:89], v5 offset:6144
ds_read_b64_tr_b16 a[90:91], v5 offset:6656
s_waitcnt lgkmcnt(4)
v_mfma_f32_16x16x32_bf16 v[140:143], a[80:83], a[16:19], v[140:143]
s_waitcnt vmcnt(8)
ds_read_b64_tr_b16 a[92:93], v5 offset:7168
ds_read_b64_tr_b16 a[94:95], v5 offset:7680
s_waitcnt lgkmcnt(4)
v_mfma_f32_16x16x32_bf16 v[144:147], a[84:87], a[20:23], v[144:147]
s_waitcnt vmcnt(7)
ds_read_b64_tr_b16 a[96:97], v5 offset:8192
ds_read_b64_tr_b16 a[98:99], v5 offset:8704
s_waitcnt lgkmcnt(4)
v_mfma_f32_16x16x32_bf16 v[140:143], a[88:91], a[24:27], v[140:143]
s_waitcnt vmcnt(6)
ds_read_b64_tr_b16 a[100:101], v5 offset:9216
ds_read_b64_tr_b16 a[102:103], v5 offset:9728
s_waitcnt lgkmcnt(4)
v_mfma_f32_16x16x32_bf16 v[144:147], a[92:95], a[28:31], v[144:147]
s_waitcnt vmcnt(5)
ds_read_b64_tr_b16 a[104:105], v5 offset:10240
ds_read_b64_tr_b16 a[106:107], v5 offset:10752
s_waitcnt lgkmcnt(4)
v_mfma_f32_16x16x32_bf16 v[140:143], a[96:99], a[32:35], v[140:143]
s_waitcnt vmcnt(4)
ds_read_b64_tr_b16 a[108:109], v5 offset:11264
ds_read_b64_tr_b16 a[110:111], v5 offset:11776
s_waitcnt lgkmcnt(4)
v_mfma_f32_16x16x32_bf16 v[144:147], a[100:103], a[36:39], v[144:147]
s_waitcnt vmcnt(3)
ds_read_b64_tr_b16 a[112:113], v5 offset:12288
ds_read_b64_tr_b16 a[114:115], v5 offset:12800
s_waitcnt lgkmcnt(4)
v_mfma_f32_16x16x32_bf16 v[140:143], a[104:107], a[40:43], v[140:143]
s_waitcnt vmcnt(2)
ds_read_b64_tr_b16 a[116:117], v5 offset:13312
ds_read_b64_tr_b16 a[118:119], v5 offset:13824
s_waitcnt lgkmcnt(4)
v_mfma_f32_16x16x32_bf16 v[144:147], a[108:111], a[44:47], v[144:147]
s_waitcnt vmcnt(1)
ds_read_b64_tr_b16 a[120:121], v5 offset:14336
ds_read_b64_tr_b16 a[122:123], v5 offset:14848
s_waitcnt lgkmcnt(4)
v_mfma_f32_16x16x32_bf16 v[140:143], a[112:115], a[48:51], v[140:143]
s_waitcnt vmcnt(0)
ds_read_b64_tr_b16 a[124:125], v5 offset:15360
ds_read_b64_tr_b16 a[126:127], v5 offset:15872
s_waitcnt lgkmcnt(4)
v_mfma_f32_16x16x32_bf16 v[144:147], a[116:119], a[52:55], v[144:147]
s_waitcnt lgkmcnt(2)
v_mfma_f32_16x16x32_bf16 v[140:143], a[120:123], a[56:59], v[140:143]
s_waitcnt lgkmcnt(0)
v_mfma_f32_16x16x32_bf16 v[144:147], a[124:127], a[60:63], v[144:147]
s_nop 7
v_add_f32 v160, v140, v144
v_add_f32 v161, v141, v145
v_add_f32 v162, v142, v146
v_add_f32 v163, v143, v147
v_cvt_pk_bf16_f32 v164, v160, v161
v_cvt_pk_bf16_f32 v166, v162, v163
v_lshlrev_b32 v160, 16, v164
v_and_b32 v161, 0xffff0000, v164
v_lshlrev_b32 v162, 16, v166
v_and_b32 v163, 0xffff0000, v166
v_add_f32 v160, s60, v160
v_add_f32 v161, s60, v161
v_add_f32 v162, s60, v162
v_add_f32 v163, s60, v163
v_cvt_pk_bf16_f32 v164, v160, v161
v_cvt_pk_bf16_f32 v166, v162, v163
buffer_store_dwordx4 v[164:167], v3, s[24:27], s58 offen sc1
s_branch LW2B
s_nop 2
LNOMOD:
s_waitcnt vmcnt(0)
v_readfirstlane_b32 s48, v9
s_mul_i32 s48, s48, 1664525
s_add_u32 s48, s48, 1013904223
s_nop 2
LW2B:
s_mov_b32 m0, 0x0
s_nop 0
buffer_load_dwordx4 v13, s[8:11], s55 offen lds
s_add_u32 s55, s55, 0xc000
s_mov_b32 m0, 0x400
s_nop 0
buffer_load_dwordx4 v13, s[8:11], s55 offen lds
s_add_u32 s55, s55, 0xc000
s_mov_b32 m0, 0x800
s_nop 0
buffer_load_dwordx4 v13, s[8:11], s55 offen lds
s_add_u32 s55, s55, 0xc000
s_mov_b32 m0, 0xc00
s_nop 0
buffer_load_dwordx4 v13, s[8:11], s55 offen lds
s_add_u32 s55, s55, 0xc000
s_mov_b32 m0, 0x1000
s_nop 0
buffer_load_dwordx4 v13, s[8:11], s55 offen lds
s_add_u32 s55, s55, 0xc000
s_mov_b32 m0, 0x1400
s_nop 0
buffer_load_dwordx4 v13, s[8:11], s55 offen lds
s_add_u32 s55, s55, 0xc000
s_mov_b32 m0, 0x1800
s_nop 0
buffer_load_dwordx4 v13, s[8:11], s55 offen lds
s_add_u32 s55, s55, 0xc000
s_mov_b32 m0, 0x1c00
s_nop 0
buffer_load_dwordx4 v13, s[8:11], s55 offen lds
s_add_u32 s55, s55, 0xc000
v_mov_b32 v8, 0x3f803f80
v_accvgpr_write_b32 a72, v8
v_accvgpr_write_b32 a73, v8
v_accvgpr_write_b32 a74, v8
v_accvgpr_write_b32 a75, v8
v_accvgpr_write_b32 a76, v8
v_accvgpr_write_b32 a77, v8
v_accvgpr_write_b32 a78, v8
v_accvgpr_write_b32 a79, v8
v_accvgpr_write_b32 a80, v8
v_accvgpr_write_b32 a81, v8
v_accvgpr_write_b32 a82, v8
v_accvgpr_write_b32 a83, v8
v_accvgpr_write_b32 a84, v8
v_accvgpr_write_b32 a85, v8
v_accvgpr_write_b32 a86, v8
v_accvgpr_write_b32 a87, v8
v_accvgpr_write_b32 a88, v8
v_accvgpr_write_b32 a89, v8
v_accvgpr_write_b32 a90, v8
v_accvgpr_write_b32 a91, v8
v_accvgpr_write_b32 a92, v8
v_accvgpr_write_b32 a93, v8
v_accvgpr_write_b32 a94, v8
v_accvgpr_write_b32 a95, v8
v_accvgpr_write_b32 a96, v8
v_accvgpr_write_b32 a97, v8
v_accvgpr_write_b32 a98, v8
v_accvgpr_write_b32 a99, v8
v_accvgpr_write_b32 a100, v8
v_accvgpr_write_b32 a101, v8
v_accvgpr_write_b32 a102, v8
v_accvgpr_write_b32 a103, v8
v_accvgpr_write_b32 a104, v8
v_accvgpr_write_b32 a105, v8
v_accvgpr_write_b32 a106, v8
v_accvgpr_write_b32 a107, v8
v_accvgpr_write_b32 a108, v8
v_accvgpr_write_b32 a109, v8
v_accvgpr_write_b32 a110, v8
v_accvgpr_write_b32 a111, v8
v_accvgpr_write_b32 a112, v8
v_accvgpr_write_b32 a113, v8
v_accvgpr_write_b32 a114, v8
v_accvgpr_write_b32 a115, v8
v_accvgpr_write_b32 a116, v8
v_accvgpr_write_b32 a117, v8
v_accvgpr_write_b32 a118, v8
v_accvgpr_write_b32 a119, v8
v_accvgpr_write_b32 a120, v8
v_accvgpr_write_b32 a121, v8
v_accvgpr_write_b32 a122, v8
v_accvgpr_write_b32 a123, v8
v_accvgpr_write_b32 a124, v8
v_accvgpr_write_b32 a125, v8
v_accvgpr_write_b32 a126, v8
v_accvgpr_write_b32 a127, v8
v_accvgpr_write_b32 a128, v8
v_accvgpr_write_b32 a129, v8
v_accvgpr_write_b32 a130, v8
v_accvgpr_write_b32 a131, v8
v_accvgpr_write_b32 a132, v8
v_accvgpr_write_b32 a133, v8
v_accvgpr_write_b32 a134, v8
v_accvgpr_write_b32 a135, v8
v_accvgpr_write_b32 a136, v8
v_accvgpr_write_b32 a137, v8
v_accvgpr_write_b32 a138, v8
v_accvgpr_write_b32 a139, v8
v_accvgpr_write_b32 a140, v8
v_accvgpr_write_b32 a141, v8
v_accvgpr_write_b32 a142, v8
v_accvgpr_write_b32 a143, v8
v_accvgpr_write_b32 a144, v8
v_accvgpr_write_b32 a145, v8
v_accvgpr_write_b32 a146, v8
v_accvgpr_write_b32 a147, v8
v_accvgpr_write_b32 a148, v8
v_accvgpr_write_b32 a149, v8
v_accvgpr_write_b32 a150, v8
v_accvgpr_write_b32 a151, v8
v_accvgpr_write_b32 a152, v8
v_accvgpr_write_b32 a153, v8
v_accvgpr_write_b32 a154, v8
v_accvgpr_write_b32 a155, v8
v_accvgpr_write_b32 a156, v8
v_accvgpr_write_b32 a157, v8
v_accvgpr_write_b32 a158, v8
v_accvgpr_write_b32 a159, v8
v_accvgpr_write_b32 a160, v8
v_accvgpr_write_b32 a161, v8
v_accvgpr_write_b32 a162, v8
v_accvgpr_write_b32 a163, v8
v_accvgpr_write_b32 a164, v8
v_accvgpr_write_b32 a165, v8
v_accvgpr_write_b32 a166, v8
v_accvgpr_write_b32 a167, v8
v_accvgpr_write_b32 a168, v8
v_accvgpr_write_b32 a169, v8
v_accvgpr_write_b32 a170, v8
v_accvgpr_write_b32 a171, v8
v_accvgpr_write_b32 a172, v8
v_accvgpr_write_b32 a173, v8
v_accvgpr_write_b32 a174, v8
v_accvgpr_write_b32 a175, v8
v_accvgpr_write_b32 a176, v8
v_accvgpr_write_b32 a177, v8
v_accvgpr_write_b32 a178, v8
v_accvgpr_write_b32 a179, v8
v_accvgpr_write_b32 a180, v8
v_accvgpr_write_b32 a181, v8
v_accvgpr_write_b32 a182, v8
v_accvgpr_write_b32 a183, v8
v_accvgpr_write_b32 a184, v8
v_accvgpr_write_b32 a185, v8
v_accvgpr_write_b32 a186, v8
v_accvgpr_write_b32 a187, v8
v_accvgpr_write_b32 a188, v8
v_accvgpr_write_b32 a189, v8
v_accvgpr_write_b32 a190, v8
v_accvgpr_write_b32 a191, v8
v_accvgpr_write_b32 a192, v8
v_accvgpr_write_b32 a193, v8
v_accvgpr_write_b32 a194, v8
v_accvgpr_write_b32 a195, v8
v_accvgpr_write_b32 a196, v8
v_accvgpr_write_b32 a197, v8
v_accvgpr_write_b32 a198, v8
v_accvgpr_write_b32 a199, v8
v_accvgpr_write_b32 a200, v8
v_accvgpr_write_b32 a201, v8
v_accvgpr_write_b32 a202, v8
v_accvgpr_write_b32 a203, v8
v_accvgpr_write_b32 a204, v8
v_accvgpr_write_b32 a205, v8
v_accvgpr_write_b32 a206, v8
v_accvgpr_write_b32 a207, v8
v_accvgpr_write_b32 a208, v8
v_accvgpr_write_b32 a209, v8
v_accvgpr_write_b32 a210, v8
v_accvgpr_write_b32 a211, v8
v_accvgpr_write_b32 a212, v8
v_accvgpr_write_b32 a213, v8
v_accvgpr_write_b32 a214, v8
v_accvgpr_write_b32 a215, v8
s_nop 4
LMERGE:
s_lshl_b32 s74, s51, 13
s_and_b32 s75, s50, 7
s_lshl_b32 s75, s75, 7
s_lshl_b32 s76, s49, 7
s_lshr_b32 s56, s50, 3
s_lshl_b32 s56, s56, 6
s_add_u32 s76, s76, s56
s_lshl_b32 s56, s51, 4
s_add_u32 s76, s76, s56
s_lshl_b32 s77, s76, 10
s_add_u32 s77, s77, s75
v_and_b32 v2, 15, v0
v_lshlrev_b32 v2, 10, v2
v_lshrrev_b32 v3, 4, v0
v_lshl_add_u32 v7, v3, 3, v2
buffer_load_dwordx2 a[236:237], v7, s[4:7], s77 offen offset:0
buffer_load_dwordx2 a[238:239], v7, s[4:7], s77 offen offset:32
buffer_load_dwordx2 a[240:241], v7, s[4:7], s77 offen offset:64
buffer_load_dwordx2 a[242:243], v7, s[4:7], s77 offen offset:96
v_lshlrev_b32 v2, 3, v3
s_mul_i32 s56, s50, 224
s_lshl_b32 s57, s51, 5
s_add_u32 s56, s56, s57
buffer_load_dwordx2 a[224:225], v2, s[40:43], s56 offen
buffer_load_dwordx2 a[226:227], v2, s[40:43], s56 offen offset:128
buffer_load_dwordx2 a[228:229], v2, s[44:47], s75 offen offset:0
buffer_load_dwordx2 a[230:231], v2, s[44:47], s75 offen offset:32
buffer_load_dwordx2 a[232:233], v2, s[44:47], s75 offen offset:64
buffer_load_dwordx2 a[234:235], v2, s[44:47], s75 offen offset:96
v_and_b32 v2, 3, v0
v_lshlrev_b32 v2, 8, v2
s_lshl_b32 s56, s49, 12
s_lshl_b32 s57, s51, 10
s_add_u32 s56, s56, s57
s_add_u32 s56, s56, 0x10000
v_add_u32 v2, s56, v2
s_lshl_b32 s64, s61, 15
s_add_u32 s64, s64, 0x100000
s_add_u32 s65, s64, 0x1000
s_add_u32 s66, s64, 0x2000
s_add_u32 s67, s64, 0x3000
s_add_u32 s68, s64, 0x4000
s_add_u32 s69, s64, 0x5000
s_add_u32 s70, s64, 0x6000
s_add_u32 s71, s64, 0x7000
s_nop 1
Lp_1:
buffer_load_dword v3, v2, s[24:27], 0 offen sc1
s_waitcnt vmcnt(0)
v_cmp_ne_u32 vcc, s48, v3
s_cbranch_vccz Ld_2
s_cmp_eq_u32 s52, 0
s_cbranch_scc1 Ld_2
s_sub_u32 s52, s52, 1
s_sleep 2
s_branch Lp_1
Ld_2:
s_nop 0
buffer_load_dwordx4 v[12:15], v1, s[24:27], s64 offen offset:0 sc1
buffer_load_dwordx4 v[16:19], v1, s[24:27], s64 offen offset:1024 sc1
buffer_load_dwordx4 v[20:23], v1, s[24:27], s64 offen offset:2048 sc1
buffer_load_dwordx4 v[24:27], v1, s[24:27], s64 offen offset:3072 sc1
buffer_load_dwordx4 v[28:31], v1, s[24:27], s65 offen offset:0 sc1
buffer_load_dwordx4 v[32:35], v1, s[24:27], s65 offen offset:1024 sc1
buffer_load_dwordx4 v[36:39], v1, s[24:27], s65 offen offset:2048 sc1
buffer_load_dwordx4 v[40:43], v1, s[24:27], s65 offen offset:3072 sc1
buffer_load_dwordx4 v[44:47], v1, s[24:27], s66 offen offset:0 sc1
buffer_load_dwordx4 v[48:51], v1, s[24:27], s66 offen offset:1024 sc1
buffer_load_dwordx4 v[52:55], v1, s[24:27], s66 offen offset:2048 sc1
buffer_load_dwordx4 v[56:59], v1, s[24:27], s66 offen offset:3072 sc1
buffer_load_dwordx4 v[60:63], v1, s[24:27], s67 offen offset:0 sc1
buffer_load_dwordx4 v[64:67], v1, s[24:27], s67 offen offset:1024 sc1
buffer_load_dwordx4 v[68:71], v1, s[24:27], s67 offen offset:2048 sc1
buffer_load_dwordx4 v[72:75], v1, s[24:27], s67 offen offset:3072 sc1
buffer_load_dwordx4 v[76:79], v1, s[24:27], s68 offen offset:0 sc1
buffer_load_dwordx4 v[80:83], v1, s[24:27], s68 offen offset:1024 sc1
buffer_load_dwordx4 v[84:87], v1, s[24:27], s68 offen offset:2048 sc1
buffer_load_dwordx4 v[88:91], v1, s[24:27], s68 offen offset:3072 sc1
buffer_load_dwordx4 v[92:95], v1, s[24:27], s69 offen offset:0 sc1
buffer_load_dwordx4 v[96:99], v1, s[24:27], s69 offen offset:1024 sc1
buffer_load_dwordx4 v[100:103], v1, s[24:27], s69 offen offset:2048 sc1
buffer_load_dwordx4 v[104:107], v1, s[24:27], s69 offen offset:3072 sc1
buffer_load_dwordx4 v[108:111], v1, s[24:27], s70 offen offset:0 sc1
buffer_load_dwordx4 v[112:115], v1, s[24:27], s70 offen offset:1024 sc1
buffer_load_dwordx4 v[116:119], v1, s[24:27], s70 offen offset:2048 sc1
buffer_load_dwordx4 v[120:123], v1, s[24:27], s70 offen offset:3072 sc1
buffer_load_dwordx4 v[124:127], v1, s[24:27], s71 offen offset:0 sc1
buffer_load_dwordx4 v[128:131], v1, s[24:27], s71 offen offset:1024 sc1
buffer_load_dwordx4 v[132:135], v1, s[24:27], s71 offen offset:2048 sc1
buffer_load_dwordx4 v[136:139], v1, s[24:27], s71 offen offset:3072 sc1
v_lshrrev_b32 v4, 5, v0
v_lshlrev_b32 v6, 5, v4
v_add_u32 v6, 0x1c000, v6
v_lshlrev_b32 v4, 3, v4
v_bfe_u32 v5, v0, 2, 2
v_add_u32 v4, v4, v5
v_lshlrev_b32 v4, 6, v4
v_bfe_u32 v5, v0, 4, 1
v_lshl_add_u32 v4, v5, 5, v4
v_and_b32 v5, 3, v0
v_lshl_add_u32 v4, v5, 3, v4
v_add_u32 v5, 0x10000, v4
s_lshl_b32 s56, s51, 10
s_add_u32 s57, s56, s73
s_add_u32 s58, s56, 0x1c000
v_add_u32 v3, s58, v1
s_nop 4
Lp_3:
buffer_load_dwordx4 v[224:227], v1, s[24:27], s57 offen sc1
s_waitcnt vmcnt(0)
v_xor_b32 v8, s48, v225
v_xor_b32 v7, s48, v227
v_or_b32 v8, v8, v7
v_cmp_ne_u32 vcc, 0, v8
s_cbranch_vccz Ld_4
s_cmp_eq_u32 s52, 0
s_cbranch_scc1 Ld_4
s_sub_u32 s52, s52, 1
s_sleep 4
s_branch Lp_3
Ld_4:
s_nop 0
v_lshlrev_b32 v228, 16, v224
v_and_b32 v229, 0xffff0000, v224
v_lshlrev_b32 v230, 16, v226
v_and_b32 v231, 0xffff0000, v226
ds_write_b128 v3, v[228:231]
s_waitcnt lgkmcnt(0)
s_barrier
ds_read_b128 v[224:227], v6 offset:0
ds_read_b128 v[228:231], v6 offset:16
ds_read_b128 v[232:235], v6 offset:2048
ds_read_b128 v[236:239], v6 offset:2064
ds_read_b128 v[240:243], v6 offset:64
ds_read_b128 v[244:247], v6 offset:80
ds_read_b128 v[248:251], v6 offset:2112
ds_read_b128 v[252:255], v6 offset:2128
ds_read_b64_tr_b16 v[192:193], v4 offset:32768
ds_read_b64_tr_b16 v[194:195], v4 offset:33024
ds_read_b64_tr_b16 v[196:197], v5 offset:0
ds_read_b64_tr_b16 v[198:199], v5 offset:256
ds_read_b64_tr_b16 v[188:189], v4 offset:0
ds_read_b64_tr_b16 v[190:191], v4 offset:256
ds_read_b64_tr_b16 v[204:205], v4 offset:33792
ds_read_b64_tr_b16 v[206:207], v4 offset:34048
ds_read_b64_tr_b16 v[208:209], v5 offset:1024
ds_read_b64_tr_b16 v[210:211], v5 offset:1280
ds_read_b64_tr_b16 v[200:201], v4 offset:1024
ds_read_b64_tr_b16 v[202:203], v4 offset:1280
s_lshl_b32 s56, s53, 2
s_add_u32 s56, s56, s51
s_mul_i32 s57, s56, 0x3800
s_lshl_b32 s58, s56, 12
v_lshlrev_b32 v2, 7, v0
v_add_u32 v3, 0x1800, v2
v_and_b32 v7, 0xfff, v2
buffer_load_dword a218, v7, s[12:15], s58 offen
buffer_load_dword a216, v2, s[20:23], s57 offen
buffer_load_dword a217, v3, s[20:23], s57 offen
v_fma_mix_f32 v224, v12, v232, v224 op_sel:[0,0,0] op_sel_hi:[1,0,0]
v_fma_mix_f32 v225, v12, v233, v225 op_sel:[1,0,0] op_sel_hi:[1,0,0]
v_fma_mix_f32 v226, v13, v234, v226 op_sel:[0,0,0] op_sel_hi:[1,0,0]
v_fma_mix_f32 v227, v13, v235, v227 op_sel:[1,0,0] op_sel_hi:[1,0,0]
v_fma_mix_f32 v228, v14, v236, v228 op_sel:[0,0,0] op_sel_hi:[1,0,0]
v_fma_mix_f32 v229, v14, v237, v229 op_sel:[1,0,0] op_sel_hi:[1,0,0]
v_fma_mix_f32 v230, v15, v238, v230 op_sel:[0,0,0] op_sel_hi:[1,0,0]
v_fma_mix_f32 v231, v15, v239, v231 op_sel:[1,0,0] op_sel_hi:[1,0,0]
v_cvt_pk_bf16_f32 v12, v224, v225
v_cvt_pk_bf16_f32 v13, v226, v227
v_cvt_pk_bf16_f32 v14, v228, v229
v_cvt_pk_bf16_f32 v15, v230, v231
s_waitcnt lgkmcnt(10)
s_nop 0
v_mfma_f32_32x32x16_bf16 v[156:171], v[192:195], v[12:15], 0
ds_read_b128 v[224:227], v6 offset:128
ds_read_b128 v[228:231], v6 offset:144
ds_read_b128 v[232:235], v6 offset:2176
ds_read_b128 v[236:239], v6 offset:2192
v_fma_mix_f32 v240, v16, v248, v240 op_sel:[0,0,0] op_sel_hi:[1,0,0]
v_fma_mix_f32 v241, v16, v249, v241 op_sel:[1,0,0] op_sel_hi:[1,0,0]
v_fma_mix_f32 v242, v17, v250, v242 op_sel:[0,0,0] op_sel_hi:[1,0,0]
v_fma_mix_f32 v243, v17, v251, v243 op_sel:[1,0,0] op_sel_hi:[1,0,0]
s_waitcnt lgkmcnt(12)
v_mfma_f32_32x32x16_bf16 v[172:187], v[12:15], v[196:199], 0
ds_read_b64_tr_b16 v[216:217], v4 offset:34816
ds_read_b64_tr_b16 v[218:219], v4 offset:35072
ds_read_b64_tr_b16 v[220:221], v5 offset:2048
ds_read_b64_tr_b16 v[222:223], v5 offset:2304
ds_read_b64_tr_b16 v[212:213], v4 offset:2048
ds_read_b64_tr_b16 v[214:215], v4 offset:2304
v_fma_mix_f32 v244, v18, v252, v244 op_sel:[0,0,0] op_sel_hi:[1,0,0]
v_mfma_f32_32x32x16_bf16 v[140:155], v[188:191], v[12:15], 0
v_fma_mix_f32 v245, v18, v253, v245 op_sel:[1,0,0] op_sel_hi:[1,0,0]
v_fma_mix_f32 v246, v19, v254, v246 op_sel:[0,0,0] op_sel_hi:[1,0,0]
v_fma_mix_f32 v247, v19, v255, v247 op_sel:[1,0,0] op_sel_hi:[1,0,0]
v_cvt_pk_bf16_f32 v16, v240, v241
v_cvt_pk_bf16_f32 v17, v242, v243
v_cvt_pk_bf16_f32 v18, v244, v245
v_cvt_pk_bf16_f32 v19, v246, v247
s_waitcnt lgkmcnt(14)
s_nop 0
v_mfma_f32_32x32x16_bf16 v[156:171], v[204:207], v[16:19], v[156:171]
ds_read_b128 v[240:243], v6 offset:192
ds_read_b128 v[244:247], v6 offset:208
ds_read_b128 v[248:251], v6 offset:2240
ds_read_b128 v[252:255], v6 offset:2256
s_waitcnt lgkmcnt(11)
v_fma_mix_f32 v224, v20, v232, v224 op_sel:[0,0,0] op_sel_hi:[1,0,0]
v_fma_mix_f32 v225, v20, v233, v225 op_sel:[1,0,0] op_sel_hi:[1,0,0]
v_fma_mix_f32 v226, v21, v234, v226 op_sel:[0,0,0] op_sel_hi:[1,0,0]
v_fma_mix_f32 v227, v21, v235, v227 op_sel:[1,0,0] op_sel_hi:[1,0,0]
v_mfma_f32_32x32x16_bf16 v[172:187], v[16:19], v[208:211], v[172:187]
ds_read_b64_tr_b16 v[192:193], v4 offset:35840
ds_read_b64_tr_b16 v[194:195], v4 offset:36096
ds_read_b64_tr_b16 v[196:197], v5 offset:3072
ds_read_b64_tr_b16 v[198:199], v5 offset:3328
ds_read_b64_tr_b16 v[188:189], v4 offset:3072
ds_read_b64_tr_b16 v[190:191], v4 offset:3328
v_fma_mix_f32 v228, v22, v236, v228 op_sel:[0,0,0] op_sel_hi:[1,0,0]
v_mfma_f32_32x32x16_bf16 v[140:155], v[200:203], v[16:19], v[140:155]
v_fma_mix_f32 v229, v22, v237, v229 op_sel:[1,0,0] op_sel_hi:[1,0,0]
v_fma_mix_f32 v230, v23, v238, v230 op_sel:[0,0,0] op_sel_hi:[1,0,0]
v_fma_mix_f32 v231, v23, v239, v231 op_sel:[1,0,0] op_sel_hi:[1,0,0]
v_cvt_pk_bf16_f32 v20, v224, v225
v_cvt_pk_bf16_f32 v21, v226, v227
v_cvt_pk_bf16_f32 v22, v228, v229
v_cvt_pk_bf16_f32 v23, v230, v231
s_waitcnt lgkmcnt(14)
s_nop 0
v_mfma_f32_32x32x16_bf16 v[156:171], v[216:219], v[20:23], v[156:171]
ds_read_b128 v[224:227], v6 offset:256
ds_read_b128 v[228:231], v6 offset:272
ds_read_b128 v[232:235], v6 offset:2304
ds_read_b128 v[236:239], v6 offset:2320
s_waitcnt lgkmcnt(11)
v_fma_mix_f32 v240, v24, v248, v240 op_sel:[0,0,0] op_sel_hi:[1,0,0]
v_fma_mix_f32 v241, v24, v249, v241 op_sel:[1,0,0] op_sel_hi:[1,0,0]
v_fma_mix_f32 v242, v25, v250, v242 op_sel:[0,0,0] op_sel_hi:[1,0,0]
v_fma_mix_f32 v243, v25, v251, v243 op_sel:[1,0,0] op_sel_hi:[1,0,0]
v_mfma_f32_32x32x16_bf16 v[172:187], v[20:23], v[220:223], v[172:187]
ds_read_b64_tr_b16 v[204:205], v4 offset:36864
ds_read_b64_tr_b16 v[206:207], v4 offset:37120
ds_read_b64_tr_b16 v[208:209], v5 offset:4096
ds_read_b64_tr_b16 v[210:211], v5 offset:4352
ds_read_b64_tr_b16 v[200:201], v4 offset:4096
ds_read_b64_tr_b16 v[202:203], v4 offset:4352
v_fma_mix_f32 v244, v26, v252, v244 op_sel:[0,0,0] op_sel_hi:[1,0,0]
v_mfma_f32_32x32x16_bf16 v[140:155], v[212:215], v[20:23], v[140:155]
v_fma_mix_f32 v245, v26, v253, v245 op_sel:[1,0,0] op_sel_hi:[1,0,0]
v_fma_mix_f32 v246, v27, v254, v246 op_sel:[0,0,0] op_sel_hi:[1,0,0]
v_fma_mix_f32 v247, v27, v255, v247 op_sel:[1,0,0] op_sel_hi:[1,0,0]
v_cvt_pk_bf16_f32 v24, v240, v241
v_cvt_pk_bf16_f32 v25, v242, v243
v_cvt_pk_bf16_f32 v26, v244, v245
v_cvt_pk_bf16_f32 v27, v246, v247
s_waitcnt lgkmcnt(14)
s_nop 0
v_mfma_f32_32x32x16_bf16 v[156:171], v[192:195], v[24:27], v[156:171]
ds_read_b128 v[240:243], v6 offset:320
ds_read_b128 v[244:247], v6 offset:336
ds_read_b128 v[248:251], v6 offset:2368
ds_read_b128 v[252:255], v6 offset:2384
s_waitcnt lgkmcnt(11)
v_fma_mix_f32 v224, v28, v232, v224 op_sel:[0,0,0] op_sel_hi:[1,0,0]
v_fma_mix_f32 v225, v28, v233, v225 op_sel:[1,0,0] op_sel_hi:[1,0,0]
v_fma_mix_f32 v226, v29, v234, v226 op_sel:[0,0,0] op_sel_hi:[1,0,0]
v_fma_mix_f32 v227, v29, v235, v227 op_sel:[1,0,0] op_sel_hi:[1,0,0]
v_mfma_f32_32x32x16_bf16 v[172:187], v[24:27], v[196:199], v[172:187]
ds_read_b64_tr_b16 v[216:217], v4 offset:37888
ds_read_b64_tr_b16 v[218:219], v4 offset:38144
ds_read_b64_tr_b16 v[220:221], v5 offset:5120
ds_read_b64_tr_b16 v[222:223], v5 offset:5376
ds_read_b64_tr_b16 v[212:213], v4 offset:5120
ds_read_b64_tr_b16 v[214:215], v4 offset:5376
v_fma_mix_f32 v228, v30, v236, v228 op_sel:[0,0,0] op_sel_hi:[1,0,0]
v_mfma_f32_32x32x16_bf16 v[140:155], v[188:191], v[24:27], v[140:155]
v_fma_mix_f32 v229, v30, v237, v229 op_sel:[1,0,0] op_sel_hi:[1,0,0]
v_fma_mix_f32 v230, v31, v238, v230 op_sel:[0,0,0] op_sel_hi:[1,0,0]
v_fma_mix_f32 v231, v31, v239, v231 op_sel:[1,0,0] op_sel_hi:[1,0,0]
v_cvt_pk_bf16_f32 v28, v224, v225
v_cvt_pk_bf16_f32 v29, v226, v227
v_cvt_pk_bf16_f32 v30, v228, v229
v_cvt_pk_bf16_f32 v31, v230, v231
s_waitcnt lgkmcnt(14)
s_nop 0
v_mfma_f32_32x32x16_bf16 v[156:171], v[204:207], v[28:31], v[156:171]
ds_read_b128 v[224:227], v6 offset:384
ds_read_b128 v[228:231], v6 offset:400
ds_read_b128 v[232:235], v6 offset:2432
ds_read_b128 v[236:239], v6 offset:2448
s_waitcnt lgkmcnt(11)
v_fma_mix_f32 v240, v32, v248, v240 op_sel:[0,0,0] op_sel_hi:[1,0,0]
v_fma_mix_f32 v241, v32, v249, v241 op_sel:[1,0,0] op_sel_hi:[1,0,0]
v_fma_mix_f32 v242, v33, v250, v242 op_sel:[0,0,0] op_sel_hi:[1,0,0]
v_fma_mix_f32 v243, v33, v251, v243 op_sel:[1,0,0] op_sel_hi:[1,0,0]
v_mfma_f32_32x32x16_bf16 v[172:187], v[28:31], v[208:211], v[172:187]
ds_read_b64_tr_b16 v[192:193], v4 offset:38912
ds_read_b64_tr_b16 v[194:195], v4 offset:39168
ds_read_b64_tr_b16 v[196:197], v5 offset:6144
ds_read_b64_tr_b16 v[198:199], v5 offset:6400
ds_read_b64_tr_b16 v[188:189], v4 offset:6144
ds_read_b64_tr_b16 v[190:191], v4 offset:6400
v_fma_mix_f32 v244, v34, v252, v244 op_sel:[0,0,0] op_sel_hi:[1,0,0]
v_mfma_f32_32x32x16_bf16 v[140:155], v[200:203], v[28:31], v[140:155]
v_fma_mix_f32 v245, v34, v253, v245 op_sel:[1,0,0] op_sel_hi:[1,0,0]
v_fma_mix_f32 v246, v35, v254, v246 op_sel:[0,0,0] op_sel_hi:[1,0,0]
v_fma_mix_f32 v247, v35, v255, v247 op_sel:[1,0,0] op_sel_hi:[1,0,0]
v_cvt_pk_bf16_f32 v32, v240, v241
v_cvt_pk_bf16_f32 v33, v242, v243
v_cvt_pk_bf16_f32 v34, v244, v245
v_cvt_pk_bf16_f32 v35, v246, v247
s_waitcnt lgkmcnt(14)
s_nop 0
v_mfma_f32_32x32x16_bf16 v[156:171], v[216:219], v[32:35], v[156:171]
ds_read_b128 v[240:243], v6 offset:448
ds_read_b128 v[244:247], v6 offset:464
ds_read_b128 v[248:251], v6 offset:2496
ds_read_b128 v[252:255], v6 offset:2512
s_waitcnt lgkmcnt(11)
v_fma_mix_f32 v224, v36, v232, v224 op_sel:[0,0,0] op_sel_hi:[1,0,0]
v_fma_mix_f32 v225, v36, v233, v225 op_sel:[1,0,0] op_sel_hi:[1,0,0]
v_fma_mix_f32 v226, v37, v234, v226 op_sel:[0,0,0] op_sel_hi:[1,0,0]
v_fma_mix_f32 v227, v37, v235, v227 op_sel:[1,0,0] op_sel_hi:[1,0,0]
v_mfma_f32_32x32x16_bf16 v[172:187], v[32:35], v[220:223], v[172:187]
ds_read_b64_tr_b16 v[204:205], v4 offset:39936
ds_read_b64_tr_b16 v[206:207], v4 offset:40192
ds_read_b64_tr_b16 v[208:209], v5 offset:7168
ds_read_b64_tr_b16 v[210:211], v5 offset:7424
ds_read_b64_tr_b16 v[200:201], v4 offset:7168
ds_read_b64_tr_b16 v[202:203], v4 offset:7424
v_fma_mix_f32 v228, v38, v236, v228 op_sel:[0,0,0] op_sel_hi:[1,0,0]
v_mfma_f32_32x32x16_bf16 v[140:155], v[212:215], v[32:35], v[140:155]
v_fma_mix_f32 v229, v38, v237, v229 op_sel:[1,0,0] op_sel_hi:[1,0,0]
v_fma_mix_f32 v230, v39, v238, v230 op_sel:[0,0,0] op_sel_hi:[1,0,0]
v_fma_mix_f32 v231, v39, v239, v231 op_sel:[1,0,0] op_sel_hi:[1,0,0]
v_cvt_pk_bf16_f32 v36, v224, v225
v_cvt_pk_bf16_f32 v37, v226, v227
v_cvt_pk_bf16_f32 v38, v228, v229
v_cvt_pk_bf16_f32 v39, v230, v231
s_waitcnt lgkmcnt(14)
s_nop 0
v_mfma_f32_32x32x16_bf16 v[156:171], v[192:195], v[36:39], v[156:171]
ds_read_b128 v[224:227], v6 offset:512
ds_read_b128 v[228:231], v6 offset:528
ds_read_b128 v[232:235], v6 offset:2560
ds_read_b128 v[236:239], v6 offset:2576
s_waitcnt lgkmcnt(11)
v_fma_mix_f32 v240, v40, v248, v240 op_sel:[0,0,0] op_sel_hi:[1,0,0]
v_fma_mix_f32 v241, v40, v249, v241 op_sel:[1,0,0] op_sel_hi:[1,0,0]
v_fma_mix_f32 v242, v41, v250, v242 op_sel:[0,0,0] op_sel_hi:[1,0,0]
v_fma_mix_f32 v243, v41, v251, v243 op_sel:[1,0,0] op_sel_hi:[1,0,0]
v_mfma_f32_32x32x16_bf16 v[172:187], v[36:39], v[196:199], v[172:187]
ds_read_b64_tr_b16 v[216:217], v4 offset:40960
ds_read_b64_tr_b16 v[218:219], v4 offset:41216
ds_read_b64_tr_b16 v[220:221], v5 offset:8192
ds_read_b64_tr_b16 v[222:223], v5 offset:8448
ds_read_b64_tr_b16 v[212:213], v4 offset:8192
ds_read_b64_tr_b16 v[214:215], v4 offset:8448
v_fma_mix_f32 v244, v42, v252, v244 op_sel:[0,0,0] op_sel_hi:[1,0,0]
v_mfma_f32_32x32x16_bf16 v[140:155], v[188:191], v[36:39], v[140:155]
v_fma_mix_f32 v245, v42, v253, v245 op_sel:[1,0,0] op_sel_hi:[1,0,0]
v_fma_mix_f32 v246, v43, v254, v246 op_sel:[0,0,0] op_sel_hi:[1,0,0]
v_fma_mix_f32 v247, v43, v255, v247 op_sel:[1,0,0] op_sel_hi:[1,0,0]
v_cvt_pk_bf16_f32 v40, v240, v241
v_cvt_pk_bf16_f32 v41, v242, v243
v_cvt_pk_bf16_f32 v42, v244, v245
v_cvt_pk_bf16_f32 v43, v246, v247
s_waitcnt lgkmcnt(14)
s_nop 0
v_mfma_f32_32x32x16_bf16 v[156:171], v[204:207], v[40:43], v[156:171]
ds_read_b128 v[240:243], v6 offset:576
ds_read_b128 v[244:247], v6 offset:592
ds_read_b128 v[248:251], v6 offset:2624
ds_read_b128 v[252:255], v6 offset:2640
s_waitcnt lgkmcnt(11)
v_fma_mix_f32 v224, v44, v232, v224 op_sel:[0,0,0] op_sel_hi:[1,0,0]
v_fma_mix_f32 v225, v44, v233, v225 op_sel:[1,0,0] op_sel_hi:[1,0,0]
v_fma_mix_f32 v226, v45, v234, v226 op_sel:[0,0,0] op_sel_hi:[1,0,0]
v_fma_mix_f32 v227, v45, v235, v227 op_sel:[1,0,0] op_sel_hi:[1,0,0]
v_mfma_f32_32x32x16_bf16 v[172:187], v[40:43], v[208:211], v[172:187]
ds_read_b64_tr_b16 v[192:193], v4 offset:41984
ds_read_b64_tr_b16 v[194:195], v4 offset:42240
ds_read_b64_tr_b16 v[196:197], v5 offset:9216
ds_read_b64_tr_b16 v[198:199], v5 offset:9472
ds_read_b64_tr_b16 v[188:189], v4 offset:9216
ds_read_b64_tr_b16 v[190:191], v4 offset:9472
v_fma_mix_f32 v228, v46, v236, v228 op_sel:[0,0,0] op_sel_hi:[1,0,0]
v_mfma_f32_32x32x16_bf16 v[140:155], v[200:203], v[40:43], v[140:155]
v_fma_mix_f32 v229, v46, v237, v229 op_sel:[1,0,0] op_sel_hi:[1,0,0]
v_fma_mix_f32 v230, v47, v238, v230 op_sel:[0,0,0] op_sel_hi:[1,0,0]
v_fma_mix_f32 v231, v47, v239, v231 op_sel:[1,0,0] op_sel_hi:[1,0,0]
v_cvt_pk_bf16_f32 v44, v224, v225
v_cvt_pk_bf16_f32 v45, v226, v227
v_cvt_pk_bf16_f32 v46, v228, v229
v_cvt_pk_bf16_f32 v47, v230, v231
s_waitcnt lgkmcnt(14)
s_nop 0
v_mfma_f32_32x32x16_bf16 v[156:171], v[216:219], v[44:47], v[156:171]
ds_read_b128 v[224:227], v6 offset:640
ds_read_b128 v[228:231], v6 offset:656
ds_read_b128 v[232:235], v6 offset:2688
ds_read_b128 v[236:239], v6 offset:2704
s_waitcnt lgkmcnt(11)
v_fma_mix_f32 v240, v48, v248, v240 op_sel:[0,0,0] op_sel_hi:[1,0,0]
v_fma_mix_f32 v241, v48, v249, v241 op_sel:[1,0,0] op_sel_hi:[1,0,0]
v_fma_mix_f32 v242, v49, v250, v242 op_sel:[0,0,0] op_sel_hi:[1,0,0]
v_fma_mix_f32 v243, v49, v251, v243 op_sel:[1,0,0] op_sel_hi:[1,0,0]
v_mfma_f32_32x32x16_bf16 v[172:187], v[44:47], v[220:223], v[172:187]
ds_read_b64_tr_b16 v[204:205], v4 offset:43008
ds_read_b64_tr_b16 v[206:207], v4 offset:43264
ds_read_b64_tr_b16 v[208:209], v5 offset:10240
ds_read_b64_tr_b16 v[210:211], v5 offset:10496
ds_read_b64_tr_b16 v[200:201], v4 offset:10240
ds_read_b64_tr_b16 v[202:203], v4 offset:10496
v_fma_mix_f32 v244, v50, v252, v244 op_sel:[0,0,0] op_sel_hi:[1,0,0]
v_mfma_f32_32x32x16_bf16 v[140:155], v[212:215], v[44:47], v[140:155]
v_fma_mix_f32 v245, v50, v253, v245 op_sel:[1,0,0] op_sel_hi:[1,0,0]
v_fma_mix_f32 v246, v51, v254, v246 op_sel:[0,0,0] op_sel_hi:[1,0,0]
v_fma_mix_f32 v247, v51, v255, v247 op_sel:[1,0,0] op_sel_hi:[1,0,0]
v_cvt_pk_bf16_f32 v48, v240, v241
v_cvt_pk_bf16_f32 v49, v242, v243
v_cvt_pk_bf16_f32 v50, v244, v245
v_cvt_pk_bf16_f32 v51, v246, v247
s_waitcnt lgkmcnt(14)
s_nop 0
v_mfma_f32_32x32x16_bf16 v[156:171], v[192:195], v[48:51], v[156:171]
ds_read_b128 v[240:243], v6 offset:704
ds_read_b128 v[244:247], v6 offset:720
ds_read_b128 v[248:251], v6 offset:2752
ds_read_b128 v[252:255], v6 offset:2768
s_waitcnt lgkmcnt(11)
v_fma_mix_f32 v224, v52, v232, v224 op_sel:[0,0,0] op_sel_hi:[1,0,0]
v_fma_mix_f32 v225, v52, v233, v225 op_sel:[1,0,0] op_sel_hi:[1,0,0]
v_fma_mix_f32 v226, v53, v234, v226 op_sel:[0,0,0] op_sel_hi:[1,0,0]
v_fma_mix_f32 v227, v53, v235, v227 op_sel:[1,0,0] op_sel_hi:[1,0,0]
v_mfma_f32_32x32x16_bf16 v[172:187], v[48:51], v[196:199], v[172:187]
ds_read_b64_tr_b16 v[216:217], v4 offset:44032
ds_read_b64_tr_b16 v[218:219], v4 offset:44288
ds_read_b64_tr_b16 v[220:221], v5 offset:11264
ds_read_b64_tr_b16 v[222:223], v5 offset:11520
ds_read_b64_tr_b16 v[212:213], v4 offset:11264
ds_read_b64_tr_b16 v[214:215], v4 offset:11520
v_fma_mix_f32 v228, v54, v236, v228 op_sel:[0,0,0] op_sel_hi:[1,0,0]
v_mfma_f32_32x32x16_bf16 v[140:155], v[188:191], v[48:51], v[140:155]
v_fma_mix_f32 v229, v54, v237, v229 op_sel:[1,0,0] op_sel_hi:[1,0,0]
v_fma_mix_f32 v230, v55, v238, v230 op_sel:[0,0,0] op_sel_hi:[1,0,0]
v_fma_mix_f32 v231, v55, v239, v231 op_sel:[1,0,0] op_sel_hi:[1,0,0]
v_cvt_pk_bf16_f32 v52, v224, v225
v_cvt_pk_bf16_f32 v53, v226, v227
v_cvt_pk_bf16_f32 v54, v228, v229
v_cvt_pk_bf16_f32 v55, v230, v231
s_waitcnt lgkmcnt(14)
s_nop 0
v_mfma_f32_32x32x16_bf16 v[156:171], v[204:207], v[52:55], v[156:171]
ds_read_b128 v[224:227], v6 offset:768
ds_read_b128 v[228:231], v6 offset:784
ds_read_b128 v[232:235], v6 offset:2816
ds_read_b128 v[236:239], v6 offset:2832
s_waitcnt lgkmcnt(11)
v_fma_mix_f32 v240, v56, v248, v240 op_sel:[0,0,0] op_sel_hi:[1,0,0]
v_fma_mix_f32 v241, v56, v249, v241 op_sel:[1,0,0] op_sel_hi:[1,0,0]
v_fma_mix_f32 v242, v57, v250, v242 op_sel:[0,0,0] op_sel_hi:[1,0,0]
v_fma_mix_f32 v243, v57, v251, v243 op_sel:[1,0,0] op_sel_hi:[1,0,0]
v_mfma_f32_32x32x16_bf16 v[172:187], v[52:55], v[208:211], v[172:187]
ds_read_b64_tr_b16 v[192:193], v4 offset:45056
ds_read_b64_tr_b16 v[194:195], v4 offset:45312
ds_read_b64_tr_b16 v[196:197], v5 offset:12288
ds_read_b64_tr_b16 v[198:199], v5 offset:12544
ds_read_b64_tr_b16 v[188:189], v4 offset:12288
ds_read_b64_tr_b16 v[190:191], v4 offset:12544
v_fma_mix_f32 v244, v58, v252, v244 op_sel:[0,0,0] op_sel_hi:[1,0,0]
v_mfma_f32_32x32x16_bf16 v[140:155], v[200:203], v[52:55], v[140:155]
v_fma_mix_f32 v245, v58, v253, v245 op_sel:[1,0,0] op_sel_hi:[1,0,0]
v_fma_mix_f32 v246, v59, v254, v246 op_sel:[0,0,0] op_sel_hi:[1,0,0]
v_fma_mix_f32 v247, v59, v255, v247 op_sel:[1,0,0] op_sel_hi:[1,0,0]
v_cvt_pk_bf16_f32 v56, v240, v241
v_cvt_pk_bf16_f32 v57, v242, v243
v_cvt_pk_bf16_f32 v58, v244, v245
v_cvt_pk_bf16_f32 v59, v246, v247
s_waitcnt lgkmcnt(14)
s_nop 0
v_mfma_f32_32x32x16_bf16 v[156:171], v[216:219], v[56:59], v[156:171]
ds_read_b128 v[240:243], v6 offset:832
ds_read_b128 v[244:247], v6 offset:848
ds_read_b128 v[248:251], v6 offset:2880
ds_read_b128 v[252:255], v6 offset:2896
s_waitcnt lgkmcnt(11)
v_fma_mix_f32 v224, v60, v232, v224 op_sel:[0,0,0] op_sel_hi:[1,0,0]
v_fma_mix_f32 v225, v60, v233, v225 op_sel:[1,0,0] op_sel_hi:[1,0,0]
v_fma_mix_f32 v226, v61, v234, v226 op_sel:[0,0,0] op_sel_hi:[1,0,0]
v_fma_mix_f32 v227, v61, v235, v227 op_sel:[1,0,0] op_sel_hi:[1,0,0]
v_mfma_f32_32x32x16_bf16 v[172:187], v[56:59], v[220:223], v[172:187]
ds_read_b64_tr_b16 v[204:205], v4 offset:46080
ds_read_b64_tr_b16 v[206:207], v4 offset:46336
ds_read_b64_tr_b16 v[208:209], v5 offset:13312
ds_read_b64_tr_b16 v[210:211], v5 offset:13568
ds_read_b64_tr_b16 v[200:201], v4 offset:13312
ds_read_b64_tr_b16 v[202:203], v4 offset:13568
v_fma_mix_f32 v228, v62, v236, v228 op_sel:[0,0,0] op_sel_hi:[1,0,0]
v_mfma_f32_32x32x16_bf16 v[140:155], v[212:215], v[56:59], v[140:155]
v_fma_mix_f32 v229, v62, v237, v229 op_sel:[1,0,0] op_sel_hi:[1,0,0]
v_fma_mix_f32 v230, v63, v238, v230 op_sel:[0,0,0] op_sel_hi:[1,0,0]
v_fma_mix_f32 v231, v63, v239, v231 op_sel:[1,0,0] op_sel_hi:[1,0,0]
v_cvt_pk_bf16_f32 v60, v224, v225
v_cvt_pk_bf16_f32 v61, v226, v227
v_cvt_pk_bf16_f32 v62, v228, v229
v_cvt_pk_bf16_f32 v63, v230, v231
s_waitcnt lgkmcnt(14)
s_nop 0
v_mfma_f32_32x32x16_bf16 v[156:171], v[192:195], v[60:63], v[156:171]
ds_read_b128 v[224:227], v6 offset:896
ds_read_b128 v[228:231], v6 offset:912
ds_read_b128 v[232:235], v6 offset:2944
ds_read_b128 v[236:239], v6 offset:2960
s_waitcnt lgkmcnt(11)
v_fma_mix_f32 v240, v64, v248, v240 op_sel:[0,0,0] op_sel_hi:[1,0,0]
v_fma_mix_f32 v241, v64, v249, v241 op_sel:[1,0,0] op_sel_hi:[1,0,0]
v_fma_mix_f32 v242, v65, v250, v242 op_sel:[0,0,0] op_sel_hi:[1,0,0]
v_fma_mix_f32 v243, v65, v251, v243 op_sel:[1,0,0] op_sel_hi:[1,0,0]
v_mfma_f32_32x32x16_bf16 v[172:187], v[60:63], v[196:199], v[172:187]
ds_read_b64_tr_b16 v[216:217], v4 offset:47104
ds_read_b64_tr_b16 v[218:219], v4 offset:47360
ds_read_b64_tr_b16 v[220:221], v5 offset:14336
ds_read_b64_tr_b16 v[222:223], v5 offset:14592
ds_read_b64_tr_b16 v[212:213], v4 offset:14336
ds_read_b64_tr_b16 v[214:215], v4 offset:14592
v_fma_mix_f32 v244, v66, v252, v244 op_sel:[0,0,0] op_sel_hi:[1,0,0]
v_mfma_f32_32x32x16_bf16 v[140:155], v[188:191], v[60:63], v[140:155]
v_fma_mix_f32 v245, v66, v253, v245 op_sel:[1,0,0] op_sel_hi:[1,0,0]
v_fma_mix_f32 v246, v67, v254, v246 op_sel:[0,0,0] op_sel_hi:[1,0,0]
v_fma_mix_f32 v247, v67, v255, v247 op_sel:[1,0,0] op_sel_hi:[1,0,0]
v_cvt_pk_bf16_f32 v64, v240, v241
v_cvt_pk_bf16_f32 v65, v242, v243
v_cvt_pk_bf16_f32 v66, v244, v245
v_cvt_pk_bf16_f32 v67, v246, v247
s_waitcnt lgkmcnt(14)
s_nop 0
v_mfma_f32_32x32x16_bf16 v[156:171], v[204:207], v[64:67], v[156:171]
ds_read_b128 v[240:243], v6 offset:960
ds_read_b128 v[244:247], v6 offset:976
ds_read_b128 v[248:251], v6 offset:3008
ds_read_b128 v[252:255], v6 offset:3024
s_waitcnt lgkmcnt(11)
v_fma_mix_f32 v224, v68, v232, v224 op_sel:[0,0,0] op_sel_hi:[1,0,0]
v_fma_mix_f32 v225, v68, v233, v225 op_sel:[1,0,0] op_sel_hi:[1,0,0]
v_fma_mix_f32 v226, v69, v234, v226 op_sel:[0,0,0] op_sel_hi:[1,0,0]
v_fma_mix_f32 v227, v69, v235, v227 op_sel:[1,0,0] op_sel_hi:[1,0,0]
v_mfma_f32_32x32x16_bf16 v[172:187], v[64:67], v[208:211], v[172:187]
ds_read_b64_tr_b16 v[192:193], v4 offset:48128
ds_read_b64_tr_b16 v[194:195], v4 offset:48384
ds_read_b64_tr_b16 v[196:197], v5 offset:15360
ds_read_b64_tr_b16 v[198:199], v5 offset:15616
ds_read_b64_tr_b16 v[188:189], v4 offset:15360
ds_read_b64_tr_b16 v[190:191], v4 offset:15616
v_fma_mix_f32 v228, v70, v236, v228 op_sel:[0,0,0] op_sel_hi:[1,0,0]
v_mfma_f32_32x32x16_bf16 v[140:155], v[200:203], v[64:67], v[140:155]
v_fma_mix_f32 v229, v70, v237, v229 op_sel:[1,0,0] op_sel_hi:[1,0,0]
v_fma_mix_f32 v230, v71, v238, v230 op_sel:[0,0,0] op_sel_hi:[1,0,0]
v_fma_mix_f32 v231, v71, v239, v231 op_sel:[1,0,0] op_sel_hi:[1,0,0]
v_cvt_pk_bf16_f32 v68, v224, v225
v_cvt_pk_bf16_f32 v69, v226, v227
v_cvt_pk_bf16_f32 v70, v228, v229
v_cvt_pk_bf16_f32 v71, v230, v231
s_waitcnt lgkmcnt(14)
s_nop 0
v_mfma_f32_32x32x16_bf16 v[156:171], v[216:219], v[68:71], v[156:171]
ds_read_b128 v[224:227], v6 offset:1024
ds_read_b128 v[228:231], v6 offset:1040
ds_read_b128 v[232:235], v6 offset:3072
ds_read_b128 v[236:239], v6 offset:3088
s_waitcnt lgkmcnt(11)
v_fma_mix_f32 v240, v72, v248, v240 op_sel:[0,0,0] op_sel_hi:[1,0,0]
v_fma_mix_f32 v241, v72, v249, v241 op_sel:[1,0,0] op_sel_hi:[1,0,0]
v_fma_mix_f32 v242, v73, v250, v242 op_sel:[0,0,0] op_sel_hi:[1,0,0]
v_fma_mix_f32 v243, v73, v251, v243 op_sel:[1,0,0] op_sel_hi:[1,0,0]
v_mfma_f32_32x32x16_bf16 v[172:187], v[68:71], v[220:223], v[172:187]
ds_read_b64_tr_b16 v[204:205], v4 offset:49152
ds_read_b64_tr_b16 v[206:207], v4 offset:49408
ds_read_b64_tr_b16 v[208:209], v5 offset:16384
ds_read_b64_tr_b16 v[210:211], v5 offset:16640
ds_read_b64_tr_b16 v[200:201], v4 offset:16384
ds_read_b64_tr_b16 v[202:203], v4 offset:16640
v_fma_mix_f32 v244, v74, v252, v244 op_sel:[0,0,0] op_sel_hi:[1,0,0]
v_mfma_f32_32x32x16_bf16 v[140:155], v[212:215], v[68:71], v[140:155]
v_fma_mix_f32 v245, v74, v253, v245 op_sel:[1,0,0] op_sel_hi:[1,0,0]
v_fma_mix_f32 v246, v75, v254, v246 op_sel:[0,0,0] op_sel_hi:[1,0,0]
v_fma_mix_f32 v247, v75, v255, v247 op_sel:[1,0,0] op_sel_hi:[1,0,0]
v_cvt_pk_bf16_f32 v72, v240, v241
v_cvt_pk_bf16_f32 v73, v242, v243
v_cvt_pk_bf16_f32 v74, v244, v245
v_cvt_pk_bf16_f32 v75, v246, v247
s_waitcnt lgkmcnt(14)
s_nop 0
v_mfma_f32_32x32x16_bf16 v[156:171], v[192:195], v[72:75], v[156:171]
ds_read_b128 v[240:243], v6 offset:1088
ds_read_b128 v[244:247], v6 offset:1104
ds_read_b128 v[248:251], v6 offset:3136
ds_read_b128 v[252:255], v6 offset:3152
s_waitcnt lgkmcnt(11)
v_fma_mix_f32 v224, v76, v232, v224 op_sel:[0,0,0] op_sel_hi:[1,0,0]
v_fma_mix_f32 v225, v76, v233, v225 op_sel:[1,0,0] op_sel_hi:[1,0,0]
v_fma_mix_f32 v226, v77, v234, v226 op_sel:[0,0,0] op_sel_hi:[1,0,0]
v_fma_mix_f32 v227, v77, v235, v227 op_sel:[1,0,0] op_sel_hi:[1,0,0]
v_mfma_f32_32x32x16_bf16 v[172:187], v[72:75], v[196:199], v[172:187]
ds_read_b64_tr_b16 v[216:217], v4 offset:50176
ds_read_b64_tr_b16 v[218:219], v4 offset:50432
ds_read_b64_tr_b16 v[220:221], v5 offset:17408
ds_read_b64_tr_b16 v[222:223], v5 offset:17664
ds_read_b64_tr_b16 v[212:213], v4 offset:17408
ds_read_b64_tr_b16 v[214:215], v4 offset:17664
v_fma_mix_f32 v228, v78, v236, v228 op_sel:[0,0,0] op_sel_hi:[1,0,0]
v_mfma_f32_32x32x16_bf16 v[140:155], v[188:191], v[72:75], v[140:155]
v_fma_mix_f32 v229, v78, v237, v229 op_sel:[1,0,0] op_sel_hi:[1,0,0]
v_fma_mix_f32 v230, v79, v238, v230 op_sel:[0,0,0] op_sel_hi:[1,0,0]
v_fma_mix_f32 v231, v79, v239, v231 op_sel:[1,0,0] op_sel_hi:[1,0,0]
v_cvt_pk_bf16_f32 v76, v224, v225
v_cvt_pk_bf16_f32 v77, v226, v227
v_cvt_pk_bf16_f32 v78, v228, v229
v_cvt_pk_bf16_f32 v79, v230, v231
s_waitcnt lgkmcnt(14)
s_nop 0
v_mfma_f32_32x32x16_bf16 v[156:171], v[204:207], v[76:79], v[156:171]
ds_read_b128 v[224:227], v6 offset:1152
ds_read_b128 v[228:231], v6 offset:1168
ds_read_b128 v[232:235], v6 offset:3200
ds_read_b128 v[236:239], v6 offset:3216
s_waitcnt lgkmcnt(11)
v_fma_mix_f32 v240, v80, v248, v240 op_sel:[0,0,0] op_sel_hi:[1,0,0]
v_fma_mix_f32 v241, v80, v249, v241 op_sel:[1,0,0] op_sel_hi:[1,0,0]
v_fma_mix_f32 v242, v81, v250, v242 op_sel:[0,0,0] op_sel_hi:[1,0,0]
v_fma_mix_f32 v243, v81, v251, v243 op_sel:[1,0,0] op_sel_hi:[1,0,0]
v_mfma_f32_32x32x16_bf16 v[172:187], v[76:79], v[208:211], v[172:187]
ds_read_b64_tr_b16 v[192:193], v4 offset:51200
ds_read_b64_tr_b16 v[194:195], v4 offset:51456
ds_read_b64_tr_b16 v[196:197], v5 offset:18432
ds_read_b64_tr_b16 v[198:199], v5 offset:18688
ds_read_b64_tr_b16 v[188:189], v4 offset:18432
ds_read_b64_tr_b16 v[190:191], v4 offset:18688
v_fma_mix_f32 v244, v82, v252, v244 op_sel:[0,0,0] op_sel_hi:[1,0,0]
v_mfma_f32_32x32x16_bf16 v[140:155], v[200:203], v[76:79], v[140:155]
v_fma_mix_f32 v245, v82, v253, v245 op_sel:[1,0,0] op_sel_hi:[1,0,0]
v_fma_mix_f32 v246, v83, v254, v246 op_sel:[0,0,0] op_sel_hi:[1,0,0]
v_fma_mix_f32 v247, v83, v255, v247 op_sel:[1,0,0] op_sel_hi:[1,0,0]
v_cvt_pk_bf16_f32 v80, v240, v241
v_cvt_pk_bf16_f32 v81, v242, v243
v_cvt_pk_bf16_f32 v82, v244, v245
v_cvt_pk_bf16_f32 v83, v246, v247
s_waitcnt lgkmcnt(14)
s_nop 0
v_mfma_f32_32x32x16_bf16 v[156:171], v[216:219], v[80:83], v[156:171]
ds_read_b128 v[240:243], v6 offset:1216
ds_read_b128 v[244:247], v6 offset:1232
ds_read_b128 v[248:251], v6 offset:3264
ds_read_b128 v[252:255], v6 offset:3280
s_waitcnt lgkmcnt(11)
v_fma_mix_f32 v224, v84, v232, v224 op_sel:[0,0,0] op_sel_hi:[1,0,0]
v_fma_mix_f32 v225, v84, v233, v225 op_sel:[1,0,0] op_sel_hi:[1,0,0]
v_fma_mix_f32 v226, v85, v234, v226 op_sel:[0,0,0] op_sel_hi:[1,0,0]
v_fma_mix_f32 v227, v85, v235, v227 op_sel:[1,0,0] op_sel_hi:[1,0,0]
v_mfma_f32_32x32x16_bf16 v[172:187], v[80:83], v[220:223], v[172:187]
ds_read_b64_tr_b16 v[204:205], v4 offset:52224
ds_read_b64_tr_b16 v[206:207], v4 offset:52480
ds_read_b64_tr_b16 v[208:209], v5 offset:19456
ds_read_b64_tr_b16 v[210:211], v5 offset:19712
ds_read_b64_tr_b16 v[200:201], v4 offset:19456
ds_read_b64_tr_b16 v[202:203], v4 offset:19712
v_fma_mix_f32 v228, v86, v236, v228 op_sel:[0,0,0] op_sel_hi:[1,0,0]
v_mfma_f32_32x32x16_bf16 v[140:155], v[212:215], v[80:83], v[140:155]
v_fma_mix_f32 v229, v86, v237, v229 op_sel:[1,0,0] op_sel_hi:[1,0,0]
v_fma_mix_f32 v230, v87, v238, v230 op_sel:[0,0,0] op_sel_hi:[1,0,0]
v_fma_mix_f32 v231, v87, v239, v231 op_sel:[1,0,0] op_sel_hi:[1,0,0]
v_cvt_pk_bf16_f32 v84, v224, v225
v_cvt_pk_bf16_f32 v85, v226, v227
v_cvt_pk_bf16_f32 v86, v228, v229
v_cvt_pk_bf16_f32 v87, v230, v231
s_waitcnt lgkmcnt(14)
s_nop 0
v_mfma_f32_32x32x16_bf16 v[156:171], v[192:195], v[84:87], v[156:171]
ds_read_b128 v[224:227], v6 offset:1280
ds_read_b128 v[228:231], v6 offset:1296
ds_read_b128 v[232:235], v6 offset:3328
ds_read_b128 v[236:239], v6 offset:3344
s_waitcnt lgkmcnt(11)
v_fma_mix_f32 v240, v88, v248, v240 op_sel:[0,0,0] op_sel_hi:[1,0,0]
v_fma_mix_f32 v241, v88, v249, v241 op_sel:[1,0,0] op_sel_hi:[1,0,0]
v_fma_mix_f32 v242, v89, v250, v242 op_sel:[0,0,0] op_sel_hi:[1,0,0]
v_fma_mix_f32 v243, v89, v251, v243 op_sel:[1,0,0] op_sel_hi:[1,0,0]
v_mfma_f32_32x32x16_bf16 v[172:187], v[84:87], v[196:199], v[172:187]
ds_read_b64_tr_b16 v[216:217], v4 offset:53248
ds_read_b64_tr_b16 v[218:219], v4 offset:53504
ds_read_b64_tr_b16 v[220:221], v5 offset:20480
ds_read_b64_tr_b16 v[222:223], v5 offset:20736
ds_read_b64_tr_b16 v[212:213], v4 offset:20480
ds_read_b64_tr_b16 v[214:215], v4 offset:20736
v_fma_mix_f32 v244, v90, v252, v244 op_sel:[0,0,0] op_sel_hi:[1,0,0]
v_mfma_f32_32x32x16_bf16 v[140:155], v[188:191], v[84:87], v[140:155]
v_fma_mix_f32 v245, v90, v253, v245 op_sel:[1,0,0] op_sel_hi:[1,0,0]
v_fma_mix_f32 v246, v91, v254, v246 op_sel:[0,0,0] op_sel_hi:[1,0,0]
v_fma_mix_f32 v247, v91, v255, v247 op_sel:[1,0,0] op_sel_hi:[1,0,0]
v_cvt_pk_bf16_f32 v88, v240, v241
v_cvt_pk_bf16_f32 v89, v242, v243
v_cvt_pk_bf16_f32 v90, v244, v245
v_cvt_pk_bf16_f32 v91, v246, v247
s_waitcnt lgkmcnt(14)
s_nop 0
v_mfma_f32_32x32x16_bf16 v[156:171], v[204:207], v[88:91], v[156:171]
ds_read_b128 v[240:243], v6 offset:1344
ds_read_b128 v[244:247], v6 offset:1360
ds_read_b128 v[248:251], v6 offset:3392
ds_read_b128 v[252:255], v6 offset:3408
s_waitcnt lgkmcnt(11)
v_fma_mix_f32 v224, v92, v232, v224 op_sel:[0,0,0] op_sel_hi:[1,0,0]
v_fma_mix_f32 v225, v92, v233, v225 op_sel:[1,0,0] op_sel_hi:[1,0,0]
v_fma_mix_f32 v226, v93, v234, v226 op_sel:[0,0,0] op_sel_hi:[1,0,0]
v_fma_mix_f32 v227, v93, v235, v227 op_sel:[1,0,0] op_sel_hi:[1,0,0]
v_mfma_f32_32x32x16_bf16 v[172:187], v[88:91], v[208:211], v[172:187]
ds_read_b64_tr_b16 v[192:193], v4 offset:54272
ds_read_b64_tr_b16 v[194:195], v4 offset:54528
ds_read_b64_tr_b16 v[196:197], v5 offset:21504
ds_read_b64_tr_b16 v[198:199], v5 offset:21760
ds_read_b64_tr_b16 v[188:189], v4 offset:21504
ds_read_b64_tr_b16 v[190:191], v4 offset:21760
v_fma_mix_f32 v228, v94, v236, v228 op_sel:[0,0,0] op_sel_hi:[1,0,0]
v_mfma_f32_32x32x16_bf16 v[140:155], v[200:203], v[88:91], v[140:155]
v_fma_mix_f32 v229, v94, v237, v229 op_sel:[1,0,0] op_sel_hi:[1,0,0]
v_fma_mix_f32 v230, v95, v238, v230 op_sel:[0,0,0] op_sel_hi:[1,0,0]
v_fma_mix_f32 v231, v95, v239, v231 op_sel:[1,0,0] op_sel_hi:[1,0,0]
v_cvt_pk_bf16_f32 v92, v224, v225
v_cvt_pk_bf16_f32 v93, v226, v227
v_cvt_pk_bf16_f32 v94, v228, v229
v_cvt_pk_bf16_f32 v95, v230, v231
s_waitcnt lgkmcnt(14)
s_nop 0
v_mfma_f32_32x32x16_bf16 v[156:171], v[216:219], v[92:95], v[156:171]
ds_read_b128 v[224:227], v6 offset:1408
ds_read_b128 v[228:231], v6 offset:1424
ds_read_b128 v[232:235], v6 offset:3456
ds_read_b128 v[236:239], v6 offset:3472
s_waitcnt lgkmcnt(11)
v_fma_mix_f32 v240, v96, v248, v240 op_sel:[0,0,0] op_sel_hi:[1,0,0]
v_fma_mix_f32 v241, v96, v249, v241 op_sel:[1,0,0] op_sel_hi:[1,0,0]
v_fma_mix_f32 v242, v97, v250, v242 op_sel:[0,0,0] op_sel_hi:[1,0,0]
v_fma_mix_f32 v243, v97, v251, v243 op_sel:[1,0,0] op_sel_hi:[1,0,0]
v_mfma_f32_32x32x16_bf16 v[172:187], v[92:95], v[220:223], v[172:187]
ds_read_b64_tr_b16 v[204:205], v4 offset:55296
ds_read_b64_tr_b16 v[206:207], v4 offset:55552
ds_read_b64_tr_b16 v[208:209], v5 offset:22528
ds_read_b64_tr_b16 v[210:211], v5 offset:22784
ds_read_b64_tr_b16 v[200:201], v4 offset:22528
ds_read_b64_tr_b16 v[202:203], v4 offset:22784
v_fma_mix_f32 v244, v98, v252, v244 op_sel:[0,0,0] op_sel_hi:[1,0,0]
v_mfma_f32_32x32x16_bf16 v[140:155], v[212:215], v[92:95], v[140:155]
v_fma_mix_f32 v245, v98, v253, v245 op_sel:[1,0,0] op_sel_hi:[1,0,0]
v_fma_mix_f32 v246, v99, v254, v246 op_sel:[0,0,0] op_sel_hi:[1,0,0]
v_fma_mix_f32 v247, v99, v255, v247 op_sel:[1,0,0] op_sel_hi:[1,0,0]
v_cvt_pk_bf16_f32 v96, v240, v241
v_cvt_pk_bf16_f32 v97, v242, v243
v_cvt_pk_bf16_f32 v98, v244, v245
v_cvt_pk_bf16_f32 v99, v246, v247
s_waitcnt lgkmcnt(14)
s_nop 0
v_mfma_f32_32x32x16_bf16 v[156:171], v[192:195], v[96:99], v[156:171]
ds_read_b128 v[240:243], v6 offset:1472
ds_read_b128 v[244:247], v6 offset:1488
ds_read_b128 v[248:251], v6 offset:3520
ds_read_b128 v[252:255], v6 offset:3536
s_waitcnt lgkmcnt(11)
v_fma_mix_f32 v224, v100, v232, v224 op_sel:[0,0,0] op_sel_hi:[1,0,0]
v_fma_mix_f32 v225, v100, v233, v225 op_sel:[1,0,0] op_sel_hi:[1,0,0]
v_fma_mix_f32 v226, v101, v234, v226 op_sel:[0,0,0] op_sel_hi:[1,0,0]
v_fma_mix_f32 v227, v101, v235, v227 op_sel:[1,0,0] op_sel_hi:[1,0,0]
v_mfma_f32_32x32x16_bf16 v[172:187], v[96:99], v[196:199], v[172:187]
ds_read_b64_tr_b16 v[216:217], v4 offset:56320
ds_read_b64_tr_b16 v[218:219], v4 offset:56576
ds_read_b64_tr_b16 v[220:221], v5 offset:23552
ds_read_b64_tr_b16 v[222:223], v5 offset:23808
ds_read_b64_tr_b16 v[212:213], v4 offset:23552
ds_read_b64_tr_b16 v[214:215], v4 offset:23808
v_fma_mix_f32 v228, v102, v236, v228 op_sel:[0,0,0] op_sel_hi:[1,0,0]
v_mfma_f32_32x32x16_bf16 v[140:155], v[188:191], v[96:99], v[140:155]
v_fma_mix_f32 v229, v102, v237, v229 op_sel:[1,0,0] op_sel_hi:[1,0,0]
v_fma_mix_f32 v230, v103, v238, v230 op_sel:[0,0,0] op_sel_hi:[1,0,0]
v_fma_mix_f32 v231, v103, v239, v231 op_sel:[1,0,0] op_sel_hi:[1,0,0]
v_cvt_pk_bf16_f32 v100, v224, v225
v_cvt_pk_bf16_f32 v101, v226, v227
v_cvt_pk_bf16_f32 v102, v228, v229
v_cvt_pk_bf16_f32 v103, v230, v231
s_waitcnt lgkmcnt(14)
s_nop 0
v_mfma_f32_32x32x16_bf16 v[156:171], v[204:207], v[100:103], v[156:171]
ds_read_b128 v[224:227], v6 offset:1536
ds_read_b128 v[228:231], v6 offset:1552
ds_read_b128 v[232:235], v6 offset:3584
ds_read_b128 v[236:239], v6 offset:3600
s_waitcnt lgkmcnt(11)
v_fma_mix_f32 v240, v104, v248, v240 op_sel:[0,0,0] op_sel_hi:[1,0,0]
v_fma_mix_f32 v241, v104, v249, v241 op_sel:[1,0,0] op_sel_hi:[1,0,0]
v_fma_mix_f32 v242, v105, v250, v242 op_sel:[0,0,0] op_sel_hi:[1,0,0]
v_fma_mix_f32 v243, v105, v251, v243 op_sel:[1,0,0] op_sel_hi:[1,0,0]
v_mfma_f32_32x32x16_bf16 v[172:187], v[100:103], v[208:211], v[172:187]
ds_read_b64_tr_b16 v[192:193], v4 offset:57344
ds_read_b64_tr_b16 v[194:195], v4 offset:57600
ds_read_b64_tr_b16 v[196:197], v5 offset:24576
ds_read_b64_tr_b16 v[198:199], v5 offset:24832
ds_read_b64_tr_b16 v[188:189], v4 offset:24576
ds_read_b64_tr_b16 v[190:191], v4 offset:24832
v_fma_mix_f32 v244, v106, v252, v244 op_sel:[0,0,0] op_sel_hi:[1,0,0]
v_mfma_f32_32x32x16_bf16 v[140:155], v[200:203], v[100:103], v[140:155]
v_fma_mix_f32 v245, v106, v253, v245 op_sel:[1,0,0] op_sel_hi:[1,0,0]
v_fma_mix_f32 v246, v107, v254, v246 op_sel:[0,0,0] op_sel_hi:[1,0,0]
v_fma_mix_f32 v247, v107, v255, v247 op_sel:[1,0,0] op_sel_hi:[1,0,0]
v_cvt_pk_bf16_f32 v104, v240, v241
v_cvt_pk_bf16_f32 v105, v242, v243
v_cvt_pk_bf16_f32 v106, v244, v245
v_cvt_pk_bf16_f32 v107, v246, v247
s_waitcnt lgkmcnt(14)
s_nop 0
v_mfma_f32_32x32x16_bf16 v[156:171], v[216:219], v[104:107], v[156:171]
ds_read_b128 v[240:243], v6 offset:1600
ds_read_b128 v[244:247], v6 offset:1616
ds_read_b128 v[248:251], v6 offset:3648
ds_read_b128 v[252:255], v6 offset:3664
s_waitcnt lgkmcnt(11)
v_fma_mix_f32 v224, v108, v232, v224 op_sel:[0,0,0] op_sel_hi:[1,0,0]
v_fma_mix_f32 v225, v108, v233, v225 op_sel:[1,0,0] op_sel_hi:[1,0,0]
v_fma_mix_f32 v226, v109, v234, v226 op_sel:[0,0,0] op_sel_hi:[1,0,0]
v_fma_mix_f32 v227, v109, v235, v227 op_sel:[1,0,0] op_sel_hi:[1,0,0]
v_mfma_f32_32x32x16_bf16 v[172:187], v[104:107], v[220:223], v[172:187]
ds_read_b64_tr_b16 v[204:205], v4 offset:58368
ds_read_b64_tr_b16 v[206:207], v4 offset:58624
ds_read_b64_tr_b16 v[208:209], v5 offset:25600
ds_read_b64_tr_b16 v[210:211], v5 offset:25856
ds_read_b64_tr_b16 v[200:201], v4 offset:25600
ds_read_b64_tr_b16 v[202:203], v4 offset:25856
v_fma_mix_f32 v228, v110, v236, v228 op_sel:[0,0,0] op_sel_hi:[1,0,0]
v_mfma_f32_32x32x16_bf16 v[140:155], v[212:215], v[104:107], v[140:155]
v_fma_mix_f32 v229, v110, v237, v229 op_sel:[1,0,0] op_sel_hi:[1,0,0]
v_fma_mix_f32 v230, v111, v238, v230 op_sel:[0,0,0] op_sel_hi:[1,0,0]
v_fma_mix_f32 v231, v111, v239, v231 op_sel:[1,0,0] op_sel_hi:[1,0,0]
v_cvt_pk_bf16_f32 v108, v224, v225
v_cvt_pk_bf16_f32 v109, v226, v227
v_cvt_pk_bf16_f32 v110, v228, v229
v_cvt_pk_bf16_f32 v111, v230, v231
s_waitcnt lgkmcnt(14)
s_nop 0
v_mfma_f32_32x32x16_bf16 v[156:171], v[192:195], v[108:111], v[156:171]
ds_read_b128 v[224:227], v6 offset:1664
ds_read_b128 v[228:231], v6 offset:1680
ds_read_b128 v[232:235], v6 offset:3712
ds_read_b128 v[236:239], v6 offset:3728
s_waitcnt lgkmcnt(11)
v_fma_mix_f32 v240, v112, v248, v240 op_sel:[0,0,0] op_sel_hi:[1,0,0]
v_fma_mix_f32 v241, v112, v249, v241 op_sel:[1,0,0] op_sel_hi:[1,0,0]
v_fma_mix_f32 v242, v113, v250, v242 op_sel:[0,0,0] op_sel_hi:[1,0,0]
v_fma_mix_f32 v243, v113, v251, v243 op_sel:[1,0,0] op_sel_hi:[1,0,0]
v_mfma_f32_32x32x16_bf16 v[172:187], v[108:111], v[196:199], v[172:187]
ds_read_b64_tr_b16 v[216:217], v4 offset:59392
ds_read_b64_tr_b16 v[218:219], v4 offset:59648
ds_read_b64_tr_b16 v[220:221], v5 offset:26624
ds_read_b64_tr_b16 v[222:223], v5 offset:26880
ds_read_b64_tr_b16 v[212:213], v4 offset:26624
ds_read_b64_tr_b16 v[214:215], v4 offset:26880
v_fma_mix_f32 v244, v114, v252, v244 op_sel:[0,0,0] op_sel_hi:[1,0,0]
v_mfma_f32_32x32x16_bf16 v[140:155], v[188:191], v[108:111], v[140:155]
v_fma_mix_f32 v245, v114, v253, v245 op_sel:[1,0,0] op_sel_hi:[1,0,0]
v_fma_mix_f32 v246, v115, v254, v246 op_sel:[0,0,0] op_sel_hi:[1,0,0]
v_fma_mix_f32 v247, v115, v255, v247 op_sel:[1,0,0] op_sel_hi:[1,0,0]
v_cvt_pk_bf16_f32 v112, v240, v241
v_cvt_pk_bf16_f32 v113, v242, v243
v_cvt_pk_bf16_f32 v114, v244, v245
v_cvt_pk_bf16_f32 v115, v246, v247
s_waitcnt lgkmcnt(14)
s_nop 0
v_mfma_f32_32x32x16_bf16 v[156:171], v[204:207], v[112:115], v[156:171]
ds_read_b128 v[240:243], v6 offset:1728
ds_read_b128 v[244:247], v6 offset:1744
ds_read_b128 v[248:251], v6 offset:3776
ds_read_b128 v[252:255], v6 offset:3792
s_waitcnt lgkmcnt(11)
v_fma_mix_f32 v224, v116, v232, v224 op_sel:[0,0,0] op_sel_hi:[1,0,0]
v_fma_mix_f32 v225, v116, v233, v225 op_sel:[1,0,0] op_sel_hi:[1,0,0]
v_fma_mix_f32 v226, v117, v234, v226 op_sel:[0,0,0] op_sel_hi:[1,0,0]
v_fma_mix_f32 v227, v117, v235, v227 op_sel:[1,0,0] op_sel_hi:[1,0,0]
v_mfma_f32_32x32x16_bf16 v[172:187], v[112:115], v[208:211], v[172:187]
ds_read_b64_tr_b16 v[192:193], v4 offset:60416
ds_read_b64_tr_b16 v[194:195], v4 offset:60672
ds_read_b64_tr_b16 v[196:197], v5 offset:27648
ds_read_b64_tr_b16 v[198:199], v5 offset:27904
ds_read_b64_tr_b16 v[188:189], v4 offset:27648
ds_read_b64_tr_b16 v[190:191], v4 offset:27904
v_fma_mix_f32 v228, v118, v236, v228 op_sel:[0,0,0] op_sel_hi:[1,0,0]
v_mfma_f32_32x32x16_bf16 v[140:155], v[200:203], v[112:115], v[140:155]
v_fma_mix_f32 v229, v118, v237, v229 op_sel:[1,0,0] op_sel_hi:[1,0,0]
v_fma_mix_f32 v230, v119, v238, v230 op_sel:[0,0,0] op_sel_hi:[1,0,0]
v_fma_mix_f32 v231, v119, v239, v231 op_sel:[1,0,0] op_sel_hi:[1,0,0]
v_cvt_pk_bf16_f32 v116, v224, v225
v_cvt_pk_bf16_f32 v117, v226, v227
v_cvt_pk_bf16_f32 v118, v228, v229
v_cvt_pk_bf16_f32 v119, v230, v231
s_waitcnt lgkmcnt(14)
s_nop 0
v_mfma_f32_32x32x16_bf16 v[156:171], v[216:219], v[116:119], v[156:171]
ds_read_b128 v[224:227], v6 offset:1792
ds_read_b128 v[228:231], v6 offset:1808
ds_read_b128 v[232:235], v6 offset:3840
ds_read_b128 v[236:239], v6 offset:3856
s_waitcnt lgkmcnt(11)
v_fma_mix_f32 v240, v120, v248, v240 op_sel:[0,0,0] op_sel_hi:[1,0,0]
v_fma_mix_f32 v241, v120, v249, v241 op_sel:[1,0,0] op_sel_hi:[1,0,0]
v_fma_mix_f32 v242, v121, v250, v242 op_sel:[0,0,0] op_sel_hi:[1,0,0]
v_fma_mix_f32 v243, v121, v251, v243 op_sel:[1,0,0] op_sel_hi:[1,0,0]
v_mfma_f32_32x32x16_bf16 v[172:187], v[116:119], v[220:223], v[172:187]
ds_read_b64_tr_b16 v[204:205], v4 offset:61440
ds_read_b64_tr_b16 v[206:207], v4 offset:61696
ds_read_b64_tr_b16 v[208:209], v5 offset:28672
ds_read_b64_tr_b16 v[210:211], v5 offset:28928
ds_read_b64_tr_b16 v[200:201], v4 offset:28672
ds_read_b64_tr_b16 v[202:203], v4 offset:28928
v_fma_mix_f32 v244, v122, v252, v244 op_sel:[0,0,0] op_sel_hi:[1,0,0]
v_mfma_f32_32x32x16_bf16 v[140:155], v[212:215], v[116:119], v[140:155]
v_fma_mix_f32 v245, v122, v253, v245 op_sel:[1,0,0] op_sel_hi:[1,0,0]
v_fma_mix_f32 v246, v123, v254, v246 op_sel:[0,0,0] op_sel_hi:[1,0,0]
v_fma_mix_f32 v247, v123, v255, v247 op_sel:[1,0,0] op_sel_hi:[1,0,0]
v_cvt_pk_bf16_f32 v120, v240, v241
v_cvt_pk_bf16_f32 v121, v242, v243
v_cvt_pk_bf16_f32 v122, v244, v245
v_cvt_pk_bf16_f32 v123, v246, v247
s_waitcnt lgkmcnt(14)
s_nop 0
v_mfma_f32_32x32x16_bf16 v[156:171], v[192:195], v[120:123], v[156:171]
ds_read_b128 v[240:243], v6 offset:1856
ds_read_b128 v[244:247], v6 offset:1872
ds_read_b128 v[248:251], v6 offset:3904
ds_read_b128 v[252:255], v6 offset:3920
s_waitcnt lgkmcnt(11)
v_fma_mix_f32 v224, v124, v232, v224 op_sel:[0,0,0] op_sel_hi:[1,0,0]
v_fma_mix_f32 v225, v124, v233, v225 op_sel:[1,0,0] op_sel_hi:[1,0,0]
v_fma_mix_f32 v226, v125, v234, v226 op_sel:[0,0,0] op_sel_hi:[1,0,0]
v_fma_mix_f32 v227, v125, v235, v227 op_sel:[1,0,0] op_sel_hi:[1,0,0]
v_mfma_f32_32x32x16_bf16 v[172:187], v[120:123], v[196:199], v[172:187]
ds_read_b64_tr_b16 v[216:217], v4 offset:62464
ds_read_b64_tr_b16 v[218:219], v4 offset:62720
ds_read_b64_tr_b16 v[220:221], v5 offset:29696
ds_read_b64_tr_b16 v[222:223], v5 offset:29952
ds_read_b64_tr_b16 v[212:213], v4 offset:29696
ds_read_b64_tr_b16 v[214:215], v4 offset:29952
v_fma_mix_f32 v228, v126, v236, v228 op_sel:[0,0,0] op_sel_hi:[1,0,0]
v_mfma_f32_32x32x16_bf16 v[140:155], v[188:191], v[120:123], v[140:155]
v_fma_mix_f32 v229, v126, v237, v229 op_sel:[1,0,0] op_sel_hi:[1,0,0]
v_fma_mix_f32 v230, v127, v238, v230 op_sel:[0,0,0] op_sel_hi:[1,0,0]
v_fma_mix_f32 v231, v127, v239, v231 op_sel:[1,0,0] op_sel_hi:[1,0,0]
v_cvt_pk_bf16_f32 v124, v224, v225
v_cvt_pk_bf16_f32 v125, v226, v227
v_cvt_pk_bf16_f32 v126, v228, v229
v_cvt_pk_bf16_f32 v127, v230, v231
s_waitcnt lgkmcnt(14)
s_nop 0
v_mfma_f32_32x32x16_bf16 v[156:171], v[204:207], v[124:127], v[156:171]
ds_read_b128 v[224:227], v6 offset:1920
ds_read_b128 v[228:231], v6 offset:1936
ds_read_b128 v[232:235], v6 offset:3968
ds_read_b128 v[236:239], v6 offset:3984
s_waitcnt lgkmcnt(11)
v_fma_mix_f32 v240, v128, v248, v240 op_sel:[0,0,0] op_sel_hi:[1,0,0]
v_fma_mix_f32 v241, v128, v249, v241 op_sel:[1,0,0] op_sel_hi:[1,0,0]
v_fma_mix_f32 v242, v129, v250, v242 op_sel:[0,0,0] op_sel_hi:[1,0,0]
v_fma_mix_f32 v243, v129, v251, v243 op_sel:[1,0,0] op_sel_hi:[1,0,0]
v_mfma_f32_32x32x16_bf16 v[172:187], v[124:127], v[208:211], v[172:187]
ds_read_b64_tr_b16 v[192:193], v4 offset:63488
ds_read_b64_tr_b16 v[194:195], v4 offset:63744
ds_read_b64_tr_b16 v[196:197], v5 offset:30720
ds_read_b64_tr_b16 v[198:199], v5 offset:30976
ds_read_b64_tr_b16 v[188:189], v4 offset:30720
ds_read_b64_tr_b16 v[190:191], v4 offset:30976
v_fma_mix_f32 v244, v130, v252, v244 op_sel:[0,0,0] op_sel_hi:[1,0,0]
v_mfma_f32_32x32x16_bf16 v[140:155], v[200:203], v[124:127], v[140:155]
v_fma_mix_f32 v245, v130, v253, v245 op_sel:[1,0,0] op_sel_hi:[1,0,0]
v_fma_mix_f32 v246, v131, v254, v246 op_sel:[0,0,0] op_sel_hi:[1,0,0]
v_fma_mix_f32 v247, v131, v255, v247 op_sel:[1,0,0] op_sel_hi:[1,0,0]
v_cvt_pk_bf16_f32 v128, v240, v241
v_cvt_pk_bf16_f32 v129, v242, v243
v_cvt_pk_bf16_f32 v130, v244, v245
v_cvt_pk_bf16_f32 v131, v246, v247
s_waitcnt lgkmcnt(14)
s_nop 0
v_mfma_f32_32x32x16_bf16 v[156:171], v[216:219], v[128:131], v[156:171]
ds_read_b128 v[240:243], v6 offset:1984
ds_read_b128 v[244:247], v6 offset:2000
ds_read_b128 v[248:251], v6 offset:4032
ds_read_b128 v[252:255], v6 offset:4048
s_waitcnt lgkmcnt(11)
v_fma_mix_f32 v224, v132, v232, v224 op_sel:[0,0,0] op_sel_hi:[1,0,0]
v_fma_mix_f32 v225, v132, v233, v225 op_sel:[1,0,0] op_sel_hi:[1,0,0]
v_fma_mix_f32 v226, v133, v234, v226 op_sel:[0,0,0] op_sel_hi:[1,0,0]
v_fma_mix_f32 v227, v133, v235, v227 op_sel:[1,0,0] op_sel_hi:[1,0,0]
v_mfma_f32_32x32x16_bf16 v[172:187], v[128:131], v[220:223], v[172:187]
ds_read_b64_tr_b16 v[204:205], v4 offset:64512
ds_read_b64_tr_b16 v[206:207], v4 offset:64768
ds_read_b64_tr_b16 v[208:209], v5 offset:31744
ds_read_b64_tr_b16 v[210:211], v5 offset:32000
ds_read_b64_tr_b16 v[200:201], v4 offset:31744
ds_read_b64_tr_b16 v[202:203], v4 offset:32000
v_fma_mix_f32 v228, v134, v236, v228 op_sel:[0,0,0] op_sel_hi:[1,0,0]
v_mfma_f32_32x32x16_bf16 v[140:155], v[212:215], v[128:131], v[140:155]
v_fma_mix_f32 v229, v134, v237, v229 op_sel:[1,0,0] op_sel_hi:[1,0,0]
v_fma_mix_f32 v230, v135, v238, v230 op_sel:[0,0,0] op_sel_hi:[1,0,0]
v_fma_mix_f32 v231, v135, v239, v231 op_sel:[1,0,0] op_sel_hi:[1,0,0]
v_cvt_pk_bf16_f32 v132, v224, v225
v_cvt_pk_bf16_f32 v133, v226, v227
v_cvt_pk_bf16_f32 v134, v228, v229
v_cvt_pk_bf16_f32 v135, v230, v231
s_waitcnt lgkmcnt(14)
s_nop 0
v_mfma_f32_32x32x16_bf16 v[156:171], v[192:195], v[132:135], v[156:171]
s_waitcnt lgkmcnt(7)
v_fma_mix_f32 v240, v136, v248, v240 op_sel:[0,0,0] op_sel_hi:[1,0,0]
v_fma_mix_f32 v241, v136, v249, v241 op_sel:[1,0,0] op_sel_hi:[1,0,0]
v_fma_mix_f32 v242, v137, v250, v242 op_sel:[0,0,0] op_sel_hi:[1,0,0]
v_fma_mix_f32 v243, v137, v251, v243 op_sel:[1,0,0] op_sel_hi:[1,0,0]
v_mfma_f32_32x32x16_bf16 v[172:187], v[132:135], v[196:199], v[172:187]
s_waitcnt lgkmcnt(6)
v_fma_mix_f32 v244, v138, v252, v244 op_sel:[0,0,0] op_sel_hi:[1,0,0]
v_fma_mix_f32 v245, v138, v253, v245 op_sel:[1,0,0] op_sel_hi:[1,0,0]
v_fma_mix_f32 v246, v139, v254, v246 op_sel:[0,0,0] op_sel_hi:[1,0,0]
v_fma_mix_f32 v247, v139, v255, v247 op_sel:[1,0,0] op_sel_hi:[1,0,0]
v_mfma_f32_32x32x16_bf16 v[140:155], v[188:191], v[132:135], v[140:155]
v_cvt_pk_bf16_f32 v136, v240, v241
v_cvt_pk_bf16_f32 v137, v242, v243
v_cvt_pk_bf16_f32 v138, v244, v245
v_cvt_pk_bf16_f32 v139, v246, v247
s_waitcnt lgkmcnt(4)
s_nop 0
v_mfma_f32_32x32x16_bf16 v[156:171], v[204:207], v[136:139], v[156:171]
s_waitcnt lgkmcnt(2)
v_mfma_f32_32x32x16_bf16 v[172:187], v[136:139], v[208:211], v[172:187]
s_waitcnt lgkmcnt(0)
v_mfma_f32_32x32x16_bf16 v[140:155], v[200:203], v[136:139], v[140:155]
s_lshl_b32 s56, s61, 4
s_add_u32 s56, s56, s50
s_lshl_b32 s56, s56, 12
s_add_u32 s56, s56, 0x300000
s_lshl_b32 s57, s51, 12
s_add_u32 s57, s57, 0x10000
v_add_u32 v7, s57, v1
s_nop 0
v_cvt_pk_bf16_f32 v16, v156, v157
v_cvt_pk_bf16_f32 v17, v158, v159
v_cvt_pk_bf16_f32 v18, v160, v161
v_cvt_pk_bf16_f32 v19, v162, v163
v_cvt_pk_bf16_f32 v20, v164, v165
v_cvt_pk_bf16_f32 v21, v166, v167
v_cvt_pk_bf16_f32 v22, v168, v169
v_cvt_pk_bf16_f32 v23, v170, v171
buffer_store_dwordx4 v[16:19], v1, s[24:27], s56 offen offset:0 sc1
buffer_store_dwordx4 v[20:23], v1, s[24:27], s56 offen offset:1024 sc1
v_cvt_pk_bf16_f32 v24, v172, v173
v_cvt_pk_bf16_f32 v25, v174, v175
v_cvt_pk_bf16_f32 v26, v176, v177
v_cvt_pk_bf16_f32 v27, v178, v179
v_cvt_pk_bf16_f32 v28, v180, v181
v_cvt_pk_bf16_f32 v29, v182, v183
v_cvt_pk_bf16_f32 v30, v184, v185
v_cvt_pk_bf16_f32 v31, v186, v187
buffer_store_dwordx4 v[24:27], v1, s[24:27], s56 offen offset:2048 sc1
buffer_store_dwordx4 v[28:31], v1, s[24:27], s56 offen offset:3072 sc1
ds_write_b128 v7, v[16:19] offset:32768
ds_write_b128 v7, v[20:23] offset:33792
ds_write_b128 v7, v[24:27] offset:34816
ds_write_b128 v7, v[28:31] offset:35840
v_mul_f32 v140, 0x3eb8aa3b, v140
v_mul_f32 v141, 0x3eb8aa3b, v141
v_mul_f32 v142, 0x3eb8aa3b, v142
v_mul_f32 v143, 0x3eb8aa3b, v143
v_mul_f32 v144, 0x3eb8aa3b, v144
v_mul_f32 v145, 0x3eb8aa3b, v145
v_mul_f32 v146, 0x3eb8aa3b, v146
v_mul_f32 v147, 0x3eb8aa3b, v147
v_mul_f32 v148, 0x3eb8aa3b, v148
v_mul_f32 v149, 0x3eb8aa3b, v149
v_mul_f32 v150, 0x3eb8aa3b, v150
v_mul_f32 v151, 0x3eb8aa3b, v151
v_mul_f32 v152, 0x3eb8aa3b, v152
v_mul_f32 v153, 0x3eb8aa3b, v153
v_mul_f32 v154, 0x3eb8aa3b, v154
v_mul_f32 v155, 0x3eb8aa3b, v155
v_cvt_pk_bf16_f32 v8, v140, v141
v_cvt_pk_bf16_f32 v9, v142, v143
v_cvt_pk_bf16_f32 v10, v144, v145
v_cvt_pk_bf16_f32 v11, v146, v147
v_cvt_pk_bf16_f32 v12, v148, v149
v_cvt_pk_bf16_f32 v13, v150, v151
v_cvt_pk_bf16_f32 v14, v152, v153
v_cvt_pk_bf16_f32 v15, v154, v155
s_waitcnt vmcnt(0)
s_lshl_b32 s60, s49, 4
s_add_u32 s60, s60, s50
s_lshl_b32 s60, s60, 2
s_add_u32 s60, s60, s51
s_lshl_b32 s60, s60, 6
s_add_u32 s60, s60, 0x20000
v_mov_b32 v3, s48
s_mov_b64 exec, 1
buffer_store_dword v3, off, s[24:27], s60 sc1
s_mov_b64 exec, -1
s_lshl_b32 s56, s51, 1
s_lshl_b32 s57, s49, 2
s_add_u32 s56, s56, s57
s_sub_i32 s56, s56, 8
v_and_b32 v2, 1, v0
v_add_u32 v2, s56, v2
v_max_i32 v2, 0, v2
v_lshrrev_b32 v3, 2, v2
v_lshlrev_b32 v3, 12, v3
v_and_b32 v2, 3, v2
v_lshl_add_u32 v2, v2, 6, v3
s_lshl_b32 s58, s50, 8
s_add_u32 s58, s58, 0x20000
v_add_u32 v2, s58, v2
s_add_i32 s64, s56, 0
s_max_i32 s64, s64, 0
s_lshl_b32 s64, s64, 16
s_lshl_b32 s58, s50, 12
s_add_u32 s64, s64, s58
s_add_u32 s64, s64, 0x300000
s_add_i32 s65, s56, 1
s_max_i32 s65, s65, 0
s_lshl_b32 s65, s65, 16
s_lshl_b32 s58, s50, 12
s_add_u32 s65, s65, s58
s_add_u32 s65, s65, 0x300000
s_lshl_b32 s66, s51, 13
s_add_u32 s66, s66, 0x10000
v_and_b32 v4, 31, v0
v_lshrrev_b32 v5, 5, v0
v_lshlrev_b32 v5, 2, v5
v_sub_u32 v4, v4, v5
v_mov_b32 v6, 0xf149f2ca
v_cmp_gt_i32 vcc, 0, v4
s_nop 1
v_cndmask_b32 v16, 0, v6, vcc
v_sub_f32 v32, v6, v16
v_cmp_gt_i32 vcc, 1, v4
s_nop 1
v_cndmask_b32 v17, 0, v6, vcc
v_sub_f32 v33, v6, v17
v_cmp_gt_i32 vcc, 2, v4
s_nop 1
v_cndmask_b32 v18, 0, v6, vcc
v_sub_f32 v34, v6, v18
v_cmp_gt_i32 vcc, 3, v4
s_nop 1
v_cndmask_b32 v19, 0, v6, vcc
v_sub_f32 v35, v6, v19
v_cmp_gt_i32 vcc, 8, v4
s_nop 1
v_cndmask_b32 v20, 0, v6, vcc
v_sub_f32 v36, v6, v20
v_cmp_gt_i32 vcc, 9, v4
s_nop 1
v_cndmask_b32 v21, 0, v6, vcc
v_sub_f32 v37, v6, v21
v_cmp_gt_i32 vcc, 10, v4
s_nop 1
v_cndmask_b32 v22, 0, v6, vcc
v_sub_f32 v38, v6, v22
v_cmp_gt_i32 vcc, 11, v4
s_nop 1
v_cndmask_b32 v23, 0, v6, vcc
v_sub_f32 v39, v6, v23
v_cmp_gt_i32 vcc, 16, v4
s_nop 1
v_cndmask_b32 v24, 0, v6, vcc
v_sub_f32 v40, v6, v24
v_cmp_gt_i32 vcc, 17, v4
s_nop 1
v_cndmask_b32 v25, 0, v6, vcc
v_sub_f32 v41, v6, v25
v_cmp_gt_i32 vcc, 18, v4
s_nop 1
v_cndmask_b32 v26, 0, v6, vcc
v_sub_f32 v42, v6, v26
v_cmp_gt_i32 vcc, 19, v4
s_nop 1
v_cndmask_b32 v27, 0, v6, vcc
v_sub_f32 v43, v6, v27
v_cmp_gt_i32 vcc, 24, v4
s_nop 1
v_cndmask_b32 v28, 0, v6, vcc
v_sub_f32 v44, v6, v28
v_cmp_gt_i32 vcc, 25, v4
s_nop 1
v_cndmask_b32 v29, 0, v6, vcc
v_sub_f32 v45, v6, v29
v_cmp_gt_i32 vcc, 26, v4
s_nop 1
v_cndmask_b32 v30, 0, v6, vcc
v_sub_f32 v46, v6, v30
v_cmp_gt_i32 vcc, 27, v4
s_nop 1
v_cndmask_b32 v31, 0, v6, vcc
v_sub_f32 v47, v6, v31
v_mov_b32 v91, v2
v_and_b32 v2, 15, v0
v_lshlrev_b32 v2, 10, v2
v_lshrrev_b32 v3, 4, v0
v_lshl_add_u32 v231, v3, 3, v2
v_accvgpr_read_b32 v232, a236
v_accvgpr_read_b32 v233, a237
v_accvgpr_read_b32 v234, a238
v_accvgpr_read_b32 v235, a239
v_accvgpr_read_b32 v236, a240
v_accvgpr_read_b32 v237, a241
v_accvgpr_read_b32 v238, a242
v_accvgpr_read_b32 v239, a243
v_add_u32 v2, 0, v0
v_mul_u32_u24 v3, 4682, v2
v_lshrrev_b32 v3, 16, v3
v_mul_u32_u24 v4, 14, v3
v_sub_u32 v4, v2, v4
v_lshlrev_b32 v4, 4, v4
v_mul_u32_u24 v3, 3584, v3
v_add_u32 v220, v3, v4
v_add_u32 v2, 64, v0
v_mul_u32_u24 v3, 4682, v2
v_lshrrev_b32 v3, 16, v3
v_mul_u32_u24 v4, 14, v3
v_sub_u32 v4, v2, v4
v_lshlrev_b32 v4, 4, v4
v_mul_u32_u24 v3, 3584, v3
v_add_u32 v221, v3, v4
v_add_u32 v2, 0x80, v0
v_mul_u32_u24 v3, 4682, v2
v_lshrrev_b32 v3, 16, v3
v_mul_u32_u24 v4, 14, v3
v_sub_u32 v4, v2, v4
v_lshlrev_b32 v4, 4, v4
v_mul_u32_u24 v3, 3584, v3
v_add_u32 v222, v3, v4
v_add_u32 v2, 0xc0, v0
v_mul_u32_u24 v3, 4682, v2
v_lshrrev_b32 v3, 16, v3
v_mul_u32_u24 v4, 14, v3
v_sub_u32 v4, v2, v4
v_lshlrev_b32 v4, 4, v4
v_mul_u32_u24 v3, 3584, v3
v_add_u32 v223, v3, v4
v_add_u32 v2, 0x100, v0
v_mul_u32_u24 v3, 4682, v2
v_lshrrev_b32 v3, 16, v3
v_mul_u32_u24 v4, 14, v3
v_sub_u32 v4, v2, v4
v_lshlrev_b32 v4, 4, v4
v_mul_u32_u24 v3, 3584, v3
v_add_u32 v224, v3, v4
v_add_u32 v2, 0x140, v0
v_mul_u32_u24 v3, 4682, v2
v_lshrrev_b32 v3, 16, v3
v_mul_u32_u24 v4, 14, v3
v_sub_u32 v4, v2, v4
v_lshlrev_b32 v4, 4, v4
v_mul_u32_u24 v3, 3584, v3
v_add_u32 v225, v3, v4
v_add_u32 v2, 0x180, v0
v_mul_u32_u24 v3, 4682, v2
v_lshrrev_b32 v3, 16, v3
v_mul_u32_u24 v4, 14, v3
v_sub_u32 v4, v2, v4
v_lshlrev_b32 v4, 4, v4
v_mul_u32_u24 v3, 3584, v3
v_add_u32 v226, v3, v4
s_mul_i32 s70, s51, 14336
s_add_u32 s70, s70, 0x10000
s_mul_i32 s71, s50, 224
s_mul_i32 s56, s51, 0x38000
s_add_u32 s71, s71, s56
s_add_u32 s72, s71, 0x1c000
v_lshrrev_b32 v2, 2, v0
v_lshlrev_b32 v2, 10, v2
v_and_b32 v3, 3, v0
v_lshl_add_u32 v92, v3, 4, v2
s_barrier
s_lshl_b32 s56, s51, 11
s_add_u32 s56, s56, s73
s_add_u32 s56, s56, 4096
s_add_u32 s57, s56, 1024
s_lshl_b32 s58, s51, 10
s_add_u32 s58, s58, 0x26800
v_lshlrev_b32 v90, 3, v0
v_add_u32 v90, s58, v90
s_nop 4
Lp_5:
buffer_load_dwordx4 v[80:83], v1, s[24:27], s56 offen sc1
buffer_load_dwordx4 v[84:87], v1, s[24:27], s57 offen sc1
buffer_load_dword v3, v91, s[24:27], 0 offen sc1
s_waitcnt vmcnt(0)
v_xor_b32 v89, s48, v3
v_xor_b32 v88, s48, v81
v_or_b32 v89, v89, v88
v_xor_b32 v88, s48, v83
v_or_b32 v89, v89, v88
v_xor_b32 v88, s48, v85
v_or_b32 v89, v89, v88
v_xor_b32 v88, s48, v87
v_or_b32 v89, v89, v88
v_cmp_ne_u32 vcc, 0, v89
s_cbranch_vccz Ld_6
s_cmp_eq_u32 s52, 0
s_cbranch_scc1 Ld_6
s_sub_u32 s52, s52, 1
s_sleep 4
s_branch Lp_5
Ld_6:
s_nop 0
s_add_u32 m0, s66, 0x0
s_nop 0
buffer_load_dwordx4 v1, s[24:27], s64 offen offset:0 sc1 lds
buffer_load_dwordx4 v1, s[24:27], s64 offen offset:1024 sc1 lds
buffer_load_dwordx4 v1, s[24:27], s64 offen offset:2048 sc1 lds
buffer_load_dwordx4 v1, s[24:27], s64 offen offset:3072 sc1 lds
s_add_u32 m0, s66, 0x1000
s_nop 0
buffer_load_dwordx4 v1, s[24:27], s65 offen offset:0 sc1 lds
buffer_load_dwordx4 v1, s[24:27], s65 offen offset:1024 sc1 lds
buffer_load_dwordx4 v1, s[24:27], s65 offen offset:2048 sc1 lds
buffer_load_dwordx4 v1, s[24:27], s65 offen offset:3072 sc1 lds
v_mov_b32 v81, v82
v_mov_b32 v85, v86
ds_write_b64 v90, v[80:81]
ds_write_b64 v90, v[84:85] offset:512
s_lshl_b32 s56, s51, 17
s_add_u32 s56, s56, s75
s_add_u32 s56, s56, 0
s_add_u32 m0, s74, 0x0
s_nop 0
buffer_load_dwordx4 v92, s[12:15], s56 offen lds
s_add_u32 s56, s56, 0x4000
s_add_u32 m0, s74, 0x400
s_nop 0
buffer_load_dwordx4 v92, s[12:15], s56 offen lds
s_add_u32 s56, s56, 0x4000
s_add_u32 m0, s74, 0x800
s_nop 0
buffer_load_dwordx4 v92, s[12:15], s56 offen lds
s_add_u32 s56, s56, 0x4000
s_add_u32 m0, s74, 0xc00
s_nop 0
buffer_load_dwordx4 v92, s[12:15], s56 offen lds
s_add_u32 s56, s56, 0x4000
s_add_u32 m0, s74, 0x1000
s_nop 0
buffer_load_dwordx4 v92, s[12:15], s56 offen lds
s_add_u32 s56, s56, 0x4000
s_add_u32 m0, s74, 0x1400
s_nop 0
buffer_load_dwordx4 v92, s[12:15], s56 offen lds
s_add_u32 s56, s56, 0x4000
s_add_u32 m0, s74, 0x1800
s_nop 0
buffer_load_dwordx4 v92, s[12:15], s56 offen lds
s_add_u32 s56, s56, 0x4000
s_add_u32 m0, s74, 0x1c00
s_nop 0
buffer_load_dwordx4 v92, s[12:15], s56 offen lds
s_add_u32 s56, s56, 0x4000
s_lshl_b32 s56, s51, 17
s_add_u32 s56, s56, s75
s_add_u32 s56, s56, 64
s_add_u32 m0, s74, 0x8000
s_nop 0
buffer_load_dwordx4 v92, s[12:15], s56 offen lds
s_add_u32 s56, s56, 0x4000
s_add_u32 m0, s74, 0x8400
s_nop 0
buffer_load_dwordx4 v92, s[12:15], s56 offen lds
s_add_u32 s56, s56, 0x4000
s_add_u32 m0, s74, 0x8800
s_nop 0
buffer_load_dwordx4 v92, s[12:15], s56 offen lds
s_add_u32 s56, s56, 0x4000
s_add_u32 m0, s74, 0x8c00
s_nop 0
buffer_load_dwordx4 v92, s[12:15], s56 offen lds
s_add_u32 s56, s56, 0x4000
s_add_u32 m0, s74, 0x9000
s_nop 0
buffer_load_dwordx4 v92, s[12:15], s56 offen lds
s_add_u32 s56, s56, 0x4000
s_add_u32 m0, s74, 0x9400
s_nop 0
buffer_load_dwordx4 v92, s[12:15], s56 offen lds
s_add_u32 s56, s56, 0x4000
s_add_u32 m0, s74, 0x9800
s_nop 0
buffer_load_dwordx4 v92, s[12:15], s56 offen lds
s_add_u32 s56, s56, 0x4000
s_add_u32 m0, s74, 0x9c00
s_nop 0
buffer_load_dwordx4 v92, s[12:15], s56 offen lds
s_add_u32 s56, s56, 0x4000
v_mov_b32 v228, v6
v_mov_b32 v229, v6
s_mov_b32 s62, 0x0000ffff
s_mov_b32 s63, 0x0000ffff
s_mov_b32 s68, 0xffff0000
s_mov_b32 s69, 0xffff0000
s_waitcnt vmcnt(16)
s_waitcnt lgkmcnt(0)
s_barrier
ds_read_b128 a[0:3], v7 offset:32768
ds_read_b128 a[4:7], v7 offset:33792
ds_read_b128 a[8:11], v7 offset:28672
ds_read_b128 a[12:15], v7 offset:29696
ds_read_b128 a[16:19], v7 offset:24576
ds_read_b128 a[20:23], v7 offset:25600
s_waitcnt lgkmcnt(5)
v_mfma_f32_32x32x16_bf16 v[80:95], a[0:3], v[8:11], v[16:31]
s_waitcnt lgkmcnt(4)
v_mfma_f32_32x32x16_bf16 v[96:111], a[4:7], v[12:15], v[16:31]
s_waitcnt lgkmcnt(3)
v_mfma_f32_32x32x16_bf16 v[112:127], a[8:11], v[8:11], 0
ds_read_b128 a[24:27], v7 offset:20480
ds_read_b128 a[28:31], v7 offset:21504
s_mov_b64 exec, s[62:63]
ds_read_b128 a[72:75], v7 offset:34816
ds_read_b128 a[76:79], v7 offset:35840
s_mov_b64 exec, -1
s_waitcnt lgkmcnt(6)
v_mfma_f32_32x32x16_bf16 v[128:143], a[12:15], v[12:15], 0
s_mov_b64 exec, s[68:69]
ds_read_b128 a[144:147], v7 offset:34816
ds_read_b128 a[148:151], v7 offset:35840
s_mov_b64 exec, -1
v_max3_f32 v228, v80, v81, v228
v_max3_f32 v228, v82, v83, v228
v_max3_f32 v228, v84, v85, v228
v_max3_f32 v228, v86, v87, v228
v_max3_f32 v228, v88, v89, v228
v_max3_f32 v228, v90, v91, v228
v_max3_f32 v228, v92, v93, v228
v_max3_f32 v228, v94, v95, v228
v_max3_f32 v229, v96, v97, v229
v_max3_f32 v229, v98, v99, v229
v_max3_f32 v229, v100, v101, v229
v_max3_f32 v229, v102, v103, v229
v_max3_f32 v229, v104, v105, v229
v_max3_f32 v229, v106, v107, v229
v_max3_f32 v229, v108, v109, v229
v_max3_f32 v229, v110, v111, v229
s_cmp_eq_u32 s61, 0
s_cbranch_scc1 LP1E
s_waitcnt lgkmcnt(7)
v_mfma_f32_32x32x16_bf16 v[80:95], a[16:19], v[8:11], 0
ds_read_b128 a[32:35], v7 offset:16384
ds_read_b128 a[36:39], v7 offset:17408
s_mov_b64 exec, s[62:63]
ds_read_b128 a[80:83], v7 offset:30720
ds_read_b128 a[84:87], v7 offset:31744
s_mov_b64 exec, -1
s_waitcnt lgkmcnt(10)
v_mfma_f32_32x32x16_bf16 v[96:111], a[20:23], v[12:15], 0
s_mov_b64 exec, s[68:69]
ds_read_b128 a[152:155], v7 offset:30720
ds_read_b128 a[156:159], v7 offset:31744
s_mov_b64 exec, -1
v_max3_f32 v228, v112, v113, v228
v_max3_f32 v228, v114, v115, v228
v_max3_f32 v228, v116, v117, v228
v_max3_f32 v228, v118, v119, v228
v_max3_f32 v228, v120, v121, v228
v_max3_f32 v228, v122, v123, v228
v_max3_f32 v228, v124, v125, v228
v_max3_f32 v228, v126, v127, v228
v_max3_f32 v229, v128, v129, v229
v_max3_f32 v229, v130, v131, v229
v_max3_f32 v229, v132, v133, v229
v_max3_f32 v229, v134, v135, v229
v_max3_f32 v229, v136, v137, v229
v_max3_f32 v229, v138, v139, v229
v_max3_f32 v229, v140, v141, v229
v_max3_f32 v229, v142, v143, v229
s_cmp_eq_u32 s61, 1
s_cbranch_scc1 LP1E
s_waitcnt lgkmcnt(11)
v_mfma_f32_32x32x16_bf16 v[112:127], a[24:27], v[8:11], 0
ds_read_b128 a[40:43], v7 offset:12288
ds_read_b128 a[44:47], v7 offset:13312
s_mov_b64 exec, s[62:63]
ds_read_b128 a[88:91], v7 offset:26624
ds_read_b128 a[92:95], v7 offset:27648
s_mov_b64 exec, -1
s_waitcnt lgkmcnt(14)
v_mfma_f32_32x32x16_bf16 v[128:143], a[28:31], v[12:15], 0
s_mov_b64 exec, s[68:69]
ds_read_b128 a[160:163], v7 offset:26624
ds_read_b128 a[164:167], v7 offset:27648
s_mov_b64 exec, -1
v_max3_f32 v228, v80, v81, v228
v_max3_f32 v228, v82, v83, v228
v_max3_f32 v228, v84, v85, v228
v_max3_f32 v228, v86, v87, v228
v_max3_f32 v228, v88, v89, v228
v_max3_f32 v228, v90, v91, v228
v_max3_f32 v228, v92, v93, v228
v_max3_f32 v228, v94, v95, v228
v_max3_f32 v229, v96, v97, v229
v_max3_f32 v229, v98, v99, v229
v_max3_f32 v229, v100, v101, v229
v_max3_f32 v229, v102, v103, v229
v_max3_f32 v229, v104, v105, v229
v_max3_f32 v229, v106, v107, v229
v_max3_f32 v229, v108, v109, v229
v_max3_f32 v229, v110, v111, v229
s_cmp_eq_u32 s61, 2
s_cbranch_scc1 LP1E
s_waitcnt lgkmcnt(11)
v_mfma_f32_32x32x16_bf16 v[80:95], a[32:35], v[8:11], 0
ds_read_b128 a[48:51], v7 offset:8192
ds_read_b128 a[52:55], v7 offset:9216
s_mov_b64 exec, s[62:63]
ds_read_b128 a[96:99], v7 offset:22528
ds_read_b128 a[100:103], v7 offset:23552
s_mov_b64 exec, -1
s_waitcnt lgkmcnt(14)
v_mfma_f32_32x32x16_bf16 v[96:111], a[36:39], v[12:15], 0
s_mov_b64 exec, s[68:69]
ds_read_b128 a[168:171], v7 offset:22528
ds_read_b128 a[172:175], v7 offset:23552
s_mov_b64 exec, -1
v_max3_f32 v228, v112, v113, v228
v_max3_f32 v228, v114, v115, v228
v_max3_f32 v228, v116, v117, v228
v_max3_f32 v228, v118, v119, v228
v_max3_f32 v228, v120, v121, v228
v_max3_f32 v228, v122, v123, v228
v_max3_f32 v228, v124, v125, v228
v_max3_f32 v228, v126, v127, v228
v_max3_f32 v229, v128, v129, v229
v_max3_f32 v229, v130, v131, v229
v_max3_f32 v229, v132, v133, v229
v_max3_f32 v229, v134, v135, v229
v_max3_f32 v229, v136, v137, v229
v_max3_f32 v229, v138, v139, v229
v_max3_f32 v229, v140, v141, v229
v_max3_f32 v229, v142, v143, v229
s_cmp_eq_u32 s61, 3
s_cbranch_scc1 LP1E
s_waitcnt lgkmcnt(11)
v_mfma_f32_32x32x16_bf16 v[112:127], a[40:43], v[8:11], 0
ds_read_b128 a[56:59], v7 offset:4096
ds_read_b128 a[60:63], v7 offset:5120
s_mov_b64 exec, s[62:63]
ds_read_b128 a[104:107], v7 offset:18432
ds_read_b128 a[108:111], v7 offset:19456
s_mov_b64 exec, -1
s_waitcnt lgkmcnt(14)
v_mfma_f32_32x32x16_bf16 v[128:143], a[44:47], v[12:15], 0
s_mov_b64 exec, s[68:69]
ds_read_b128 a[176:179], v7 offset:18432
ds_read_b128 a[180:183], v7 offset:19456
s_mov_b64 exec, -1
v_max3_f32 v228, v80, v81, v228
v_max3_f32 v228, v82, v83, v228
v_max3_f32 v228, v84, v85, v228
v_max3_f32 v228, v86, v87, v228
v_max3_f32 v228, v88, v89, v228
v_max3_f32 v228, v90, v91, v228
v_max3_f32 v228, v92, v93, v228
v_max3_f32 v228, v94, v95, v228
v_max3_f32 v229, v96, v97, v229
v_max3_f32 v229, v98, v99, v229
v_max3_f32 v229, v100, v101, v229
v_max3_f32 v229, v102, v103, v229
v_max3_f32 v229, v104, v105, v229
v_max3_f32 v229, v106, v107, v229
v_max3_f32 v229, v108, v109, v229
v_max3_f32 v229, v110, v111, v229
s_cmp_eq_u32 s61, 4
s_cbranch_scc1 LP1E
s_waitcnt lgkmcnt(11)
v_mfma_f32_32x32x16_bf16 v[80:95], a[48:51], v[8:11], 0
ds_read_b128 a[64:67], v7 offset:0
ds_read_b128 a[68:71], v7 offset:1024
s_mov_b64 exec, s[62:63]
ds_read_b128 a[112:115], v7 offset:14336
ds_read_b128 a[116:119], v7 offset:15360
s_mov_b64 exec, -1
s_waitcnt lgkmcnt(14)
v_mfma_f32_32x32x16_bf16 v[96:111], a[52:55], v[12:15], 0
s_mov_b64 exec, s[68:69]
ds_read_b128 a[184:187], v7 offset:14336
ds_read_b128 a[188:191], v7 offset:15360
s_mov_b64 exec, -1
v_max3_f32 v228, v112, v113, v228
v_max3_f32 v228, v114, v115, v228
v_max3_f32 v228, v116, v117, v228
v_max3_f32 v228, v118, v119, v228
v_max3_f32 v228, v120, v121, v228
v_max3_f32 v228, v122, v123, v228
v_max3_f32 v228, v124, v125, v228
v_max3_f32 v228, v126, v127, v228
v_max3_f32 v229, v128, v129, v229
v_max3_f32 v229, v130, v131, v229
v_max3_f32 v229, v132, v133, v229
v_max3_f32 v229, v134, v135, v229
v_max3_f32 v229, v136, v137, v229
v_max3_f32 v229, v138, v139, v229
v_max3_f32 v229, v140, v141, v229
v_max3_f32 v229, v142, v143, v229
s_cmp_eq_u32 s61, 5
s_cbranch_scc1 LP1E
s_waitcnt lgkmcnt(11)
v_mfma_f32_32x32x16_bf16 v[112:127], a[56:59], v[8:11], 0
s_mov_b64 exec, s[62:63]
ds_read_b128 a[120:123], v7 offset:10240
ds_read_b128 a[124:127], v7 offset:11264
s_mov_b64 exec, -1
s_waitcnt lgkmcnt(12)
v_mfma_f32_32x32x16_bf16 v[128:143], a[60:63], v[12:15], 0
s_mov_b64 exec, s[68:69]
ds_read_b128 a[192:195], v7 offset:10240
ds_read_b128 a[196:199], v7 offset:11264
s_mov_b64 exec, -1
v_max3_f32 v228, v80, v81, v228
v_max3_f32 v228, v82, v83, v228
v_max3_f32 v228, v84, v85, v228
v_max3_f32 v228, v86, v87, v228
v_max3_f32 v228, v88, v89, v228
v_max3_f32 v228, v90, v91, v228
v_max3_f32 v228, v92, v93, v228
v_max3_f32 v228, v94, v95, v228
v_max3_f32 v229, v96, v97, v229
v_max3_f32 v229, v98, v99, v229
v_max3_f32 v229, v100, v101, v229
v_max3_f32 v229, v102, v103, v229
v_max3_f32 v229, v104, v105, v229
v_max3_f32 v229, v106, v107, v229
v_max3_f32 v229, v108, v109, v229
v_max3_f32 v229, v110, v111, v229
s_cmp_eq_u32 s61, 6
s_cbranch_scc1 LP1E
s_waitcnt lgkmcnt(9)
v_mfma_f32_32x32x16_bf16 v[80:95], a[64:67], v[8:11], v[32:47]
s_mov_b64 exec, s[62:63]
ds_read_b128 a[128:131], v7 offset:6144
ds_read_b128 a[132:135], v7 offset:7168
s_mov_b64 exec, -1
s_waitcnt lgkmcnt(10)
v_mfma_f32_32x32x16_bf16 v[96:111], a[68:71], v[12:15], v[32:47]
s_mov_b64 exec, s[68:69]
ds_read_b128 a[200:203], v7 offset:6144
ds_read_b128 a[204:207], v7 offset:7168
s_mov_b64 exec, -1
v_max3_f32 v228, v112, v113, v228
v_max3_f32 v228, v114, v115, v228
v_max3_f32 v228, v116, v117, v228
v_max3_f32 v228, v118, v119, v228
v_max3_f32 v228, v120, v121, v228
v_max3_f32 v228, v122, v123, v228
v_max3_f32 v228, v124, v125, v228
v_max3_f32 v228, v126, v127, v228
v_max3_f32 v229, v128, v129, v229
v_max3_f32 v229, v130, v131, v229
v_max3_f32 v229, v132, v133, v229
v_max3_f32 v229, v134, v135, v229
v_max3_f32 v229, v136, v137, v229
v_max3_f32 v229, v138, v139, v229
v_max3_f32 v229, v140, v141, v229
v_max3_f32 v229, v142, v143, v229
s_cmp_eq_u32 s61, 7
s_cbranch_scc1 LP1E
s_mov_b64 exec, s[62:63]
ds_read_b128 a[136:139], v7 offset:2048
ds_read_b128 a[140:143], v7 offset:3072
s_mov_b64 exec, -1
s_mov_b64 exec, s[68:69]
ds_read_b128 a[208:211], v7 offset:2048
ds_read_b128 a[212:215], v7 offset:3072
s_mov_b64 exec, -1
v_max3_f32 v228, v80, v81, v228
v_max3_f32 v228, v82, v83, v228
v_max3_f32 v228, v84, v85, v228
v_max3_f32 v228, v86, v87, v228
v_max3_f32 v228, v88, v89, v228
v_max3_f32 v228, v90, v91, v228
v_max3_f32 v228, v92, v93, v228
v_max3_f32 v228, v94, v95, v228
v_max3_f32 v229, v96, v97, v229
v_max3_f32 v229, v98, v99, v229
v_max3_f32 v229, v100, v101, v229
v_max3_f32 v229, v102, v103, v229
v_max3_f32 v229, v104, v105, v229
v_max3_f32 v229, v106, v107, v229
v_max3_f32 v229, v108, v109, v229
v_max3_f32 v229, v110, v111, v229
LP1E:
s_nop 11
s_waitcnt lgkmcnt(0)
s_barrier
v_mov_b32 v230, v228
s_nop 1
v_permlane32_swap_b32 v228, v230
v_max_f32 v228, v228, v230
v_sub_f32 v48, 0, v228
v_sub_f32 v49, 0, v228
v_sub_f32 v50, 0, v228
v_sub_f32 v51, 0, v228
v_sub_f32 v52, 0, v228
v_sub_f32 v53, 0, v228
v_sub_f32 v54, 0, v228
v_sub_f32 v55, 0, v228
v_sub_f32 v56, 0, v228
v_sub_f32 v57, 0, v228
v_sub_f32 v58, 0, v228
v_sub_f32 v59, 0, v228
v_sub_f32 v60, 0, v228
v_sub_f32 v61, 0, v228
v_sub_f32 v62, 0, v228
v_sub_f32 v63, 0, v228
v_mov_b32 v230, v229
s_nop 1
v_permlane32_swap_b32 v229, v230
v_max_f32 v229, v229, v230
v_sub_f32 v64, 0, v229
v_sub_f32 v65, 0, v229
v_sub_f32 v66, 0, v229
v_sub_f32 v67, 0, v229
v_sub_f32 v68, 0, v229
v_sub_f32 v69, 0, v229
v_sub_f32 v70, 0, v229
v_sub_f32 v71, 0, v229
v_sub_f32 v72, 0, v229
v_sub_f32 v73, 0, v229
v_sub_f32 v74, 0, v229
v_sub_f32 v75, 0, v229
v_sub_f32 v76, 0, v229
v_sub_f32 v77, 0, v229
v_sub_f32 v78, 0, v229
v_sub_f32 v79, 0, v229
v_add_f32 v192, v16, v64
v_add_f32 v193, v17, v65
v_add_f32 v194, v18, v66
v_add_f32 v195, v19, v67
v_add_f32 v196, v20, v68
v_add_f32 v197, v21, v69
v_add_f32 v198, v22, v70
v_add_f32 v199, v23, v71
v_add_f32 v200, v24, v72
v_add_f32 v201, v25, v73
v_add_f32 v202, v26, v74
v_add_f32 v203, v27, v75
v_add_f32 v204, v28, v76
v_add_f32 v205, v29, v77
v_add_f32 v206, v30, v78
v_add_f32 v207, v31, v79
v_add_f32 v16, v16, v48
v_add_f32 v17, v17, v49
v_add_f32 v18, v18, v50
v_add_f32 v19, v19, v51
v_add_f32 v20, v20, v52
v_add_f32 v21, v21, v53
v_add_f32 v22, v22, v54
v_add_f32 v23, v23, v55
v_add_f32 v24, v24, v56
v_add_f32 v25, v25, v57
v_add_f32 v26, v26, v58
v_add_f32 v27, v27, v59
v_add_f32 v28, v28, v60
v_add_f32 v29, v29, v61
v_add_f32 v30, v30, v62
v_add_f32 v31, v31, v63
s_nop 1
v_mfma_f32_32x32x16_bf16 v[80:95], a[0:3], v[8:11], v[16:31]
v_mfma_f32_32x32x16_bf16 v[96:111], a[4:7], v[12:15], v[192:207]
v_mfma_f32_32x32x16_bf16 v[112:127], a[8:11], v[8:11], v[48:63]
s_nop 9
v_exp_f32 v80, v80
v_exp_f32 v81, v81
v_exp_f32 v82, v82
v_exp_f32 v83, v83
v_exp_f32 v84, v84
v_exp_f32 v85, v85
v_exp_f32 v86, v86
v_exp_f32 v87, v87
v_cvt_pk_bf16_f32 v176, v80, v81
v_cvt_pk_bf16_f32 v177, v82, v83
v_cvt_pk_bf16_f32 v178, v84, v85
v_cvt_pk_bf16_f32 v179, v86, v87
s_nop 1
v_mfma_f32_32x32x16_bf16 v[144:159], a[72:75], v[176:179], 0
v_exp_f32 v88, v88
v_exp_f32 v89, v89
v_exp_f32 v90, v90
v_exp_f32 v91, v91
v_exp_f32 v92, v92
v_exp_f32 v93, v93
v_exp_f32 v94, v94
v_exp_f32 v95, v95
v_cvt_pk_bf16_f32 v180, v88, v89
v_cvt_pk_bf16_f32 v181, v90, v91
v_cvt_pk_bf16_f32 v182, v92, v93
v_cvt_pk_bf16_f32 v183, v94, v95
s_nop 1
v_mfma_f32_32x32x16_bf16 v[144:159], a[76:79], v[180:183], v[144:159]
s_add_u32 m0, s70, 0x0
s_nop 0
buffer_load_dwordx4 v220, s[16:19], s71 offen lds
v_mfma_f32_32x32x16_bf16 v[128:143], a[12:15], v[12:15], v[64:79]
v_exp_f32 v96, v96
v_exp_f32 v97, v97
v_exp_f32 v98, v98
v_exp_f32 v99, v99
v_exp_f32 v100, v100
v_exp_f32 v101, v101
v_exp_f32 v102, v102
v_exp_f32 v103, v103
v_cvt_pk_bf16_f32 v184, v96, v97
v_cvt_pk_bf16_f32 v185, v98, v99
v_cvt_pk_bf16_f32 v186, v100, v101
v_cvt_pk_bf16_f32 v187, v102, v103
s_nop 1
v_mfma_f32_32x32x16_bf16 v[160:175], a[144:147], v[184:187], 0
v_exp_f32 v104, v104
v_exp_f32 v105, v105
v_exp_f32 v106, v106
v_exp_f32 v107, v107
v_exp_f32 v108, v108
v_exp_f32 v109, v109
v_exp_f32 v110, v110
v_exp_f32 v111, v111
v_cvt_pk_bf16_f32 v188, v104, v105
v_cvt_pk_bf16_f32 v189, v106, v107
v_cvt_pk_bf16_f32 v190, v108, v109
v_cvt_pk_bf16_f32 v191, v110, v111
s_nop 1
v_mfma_f32_32x32x16_bf16 v[160:175], a[148:151], v[188:191], v[160:175]
s_add_u32 m0, s70, 0x400
s_nop 0
buffer_load_dwordx4 v221, s[16:19], s71 offen lds
s_cmp_eq_u32 s61, 0
s_cbranch_scc1 LC0
v_add_f32 v192, v32, v48
v_add_f32 v193, v33, v49
v_add_f32 v194, v34, v50
v_add_f32 v195, v35, v51
v_add_f32 v196, v36, v52
v_add_f32 v197, v37, v53
v_add_f32 v198, v38, v54
v_add_f32 v199, v39, v55
v_add_f32 v200, v40, v56
v_add_f32 v201, v41, v57
v_add_f32 v202, v42, v58
v_add_f32 v203, v43, v59
v_add_f32 v204, v44, v60
v_add_f32 v205, v45, v61
v_add_f32 v206, v46, v62
v_add_f32 v207, v47, v63
v_add_f32 v32, v32, v64
v_add_f32 v33, v33, v65
v_add_f32 v34, v34, v66
v_add_f32 v35, v35, v67
v_add_f32 v36, v36, v68
v_add_f32 v37, v37, v69
v_add_f32 v38, v38, v70
v_add_f32 v39, v39, v71
v_add_f32 v40, v40, v72
v_add_f32 v41, v41, v73
v_add_f32 v42, v42, v74
v_add_f32 v43, v43, v75
v_add_f32 v44, v44, v76
v_add_f32 v45, v45, v77
v_add_f32 v46, v46, v78
v_add_f32 v47, v47, v79
v_mfma_f32_32x32x16_bf16 v[80:95], a[16:19], v[8:11], v[48:63]
v_exp_f32 v112, v112
v_exp_f32 v113, v113
v_exp_f32 v114, v114
v_exp_f32 v115, v115
v_exp_f32 v116, v116
v_exp_f32 v117, v117
v_exp_f32 v118, v118
v_exp_f32 v119, v119
v_cvt_pk_bf16_f32 v176, v112, v113
v_cvt_pk_bf16_f32 v177, v114, v115
v_cvt_pk_bf16_f32 v178, v116, v117
v_cvt_pk_bf16_f32 v179, v118, v119
s_nop 1
v_mfma_f32_32x32x16_bf16 v[144:159], a[80:83], v[176:179], v[144:159]
v_exp_f32 v120, v120
v_exp_f32 v121, v121
v_exp_f32 v122, v122
v_exp_f32 v123, v123
v_exp_f32 v124, v124
v_exp_f32 v125, v125
v_exp_f32 v126, v126
v_exp_f32 v127, v127
v_cvt_pk_bf16_f32 v180, v120, v121
v_cvt_pk_bf16_f32 v181, v122, v123
v_cvt_pk_bf16_f32 v182, v124, v125
v_cvt_pk_bf16_f32 v183, v126, v127
s_nop 1
v_mfma_f32_32x32x16_bf16 v[144:159], a[84:87], v[180:183], v[144:159]
s_add_u32 m0, s70, 0x800
s_nop 0
buffer_load_dwordx4 v222, s[16:19], s71 offen lds
v_mfma_f32_32x32x16_bf16 v[96:111], a[20:23], v[12:15], v[64:79]
v_exp_f32 v128, v128
v_exp_f32 v129, v129
v_exp_f32 v130, v130
v_exp_f32 v131, v131
v_exp_f32 v132, v132
v_exp_f32 v133, v133
v_exp_f32 v134, v134
v_exp_f32 v135, v135
v_cvt_pk_bf16_f32 v184, v128, v129
v_cvt_pk_bf16_f32 v185, v130, v131
v_cvt_pk_bf16_f32 v186, v132, v133
v_cvt_pk_bf16_f32 v187, v134, v135
s_nop 1
v_mfma_f32_32x32x16_bf16 v[160:175], a[152:155], v[184:187], v[160:175]
v_exp_f32 v136, v136
v_exp_f32 v137, v137
v_exp_f32 v138, v138
v_exp_f32 v139, v139
v_exp_f32 v140, v140
v_exp_f32 v141, v141
v_exp_f32 v142, v142
v_exp_f32 v143, v143
v_cvt_pk_bf16_f32 v188, v136, v137
v_cvt_pk_bf16_f32 v189, v138, v139
v_cvt_pk_bf16_f32 v190, v140, v141
v_cvt_pk_bf16_f32 v191, v142, v143
s_nop 1
v_mfma_f32_32x32x16_bf16 v[160:175], a[156:159], v[188:191], v[160:175]
s_add_u32 m0, s70, 0xc00
s_nop 0
buffer_load_dwordx4 v223, s[16:19], s71 offen lds
s_cmp_eq_u32 s61, 1
s_cbranch_scc1 LC1
v_mfma_f32_32x32x16_bf16 v[112:127], a[24:27], v[8:11], v[48:63]
v_exp_f32 v80, v80
v_exp_f32 v81, v81
v_exp_f32 v82, v82
v_exp_f32 v83, v83
v_exp_f32 v84, v84
v_exp_f32 v85, v85
v_exp_f32 v86, v86
v_exp_f32 v87, v87
v_cvt_pk_bf16_f32 v176, v80, v81
v_cvt_pk_bf16_f32 v177, v82, v83
v_cvt_pk_bf16_f32 v178, v84, v85
v_cvt_pk_bf16_f32 v179, v86, v87
s_nop 1
v_mfma_f32_32x32x16_bf16 v[144:159], a[88:91], v[176:179], v[144:159]
v_exp_f32 v88, v88
v_exp_f32 v89, v89
v_exp_f32 v90, v90
v_exp_f32 v91, v91
v_exp_f32 v92, v92
v_exp_f32 v93, v93
v_exp_f32 v94, v94
v_exp_f32 v95, v95
v_cvt_pk_bf16_f32 v180, v88, v89
v_cvt_pk_bf16_f32 v181, v90, v91
v_cvt_pk_bf16_f32 v182, v92, v93
v_cvt_pk_bf16_f32 v183, v94, v95
s_nop 1
v_mfma_f32_32x32x16_bf16 v[144:159], a[92:95], v[180:183], v[144:159]
s_add_u32 m0, s70, 0x1000
s_nop 0
buffer_load_dwordx4 v224, s[16:19], s71 offen lds
v_mfma_f32_32x32x16_bf16 v[128:143], a[28:31], v[12:15], v[64:79]
v_exp_f32 v96, v96
v_exp_f32 v97, v97
v_exp_f32 v98, v98
v_exp_f32 v99, v99
v_exp_f32 v100, v100
v_exp_f32 v101, v101
v_exp_f32 v102, v102
v_exp_f32 v103, v103
v_cvt_pk_bf16_f32 v184, v96, v97
v_cvt_pk_bf16_f32 v185, v98, v99
v_cvt_pk_bf16_f32 v186, v100, v101
v_cvt_pk_bf16_f32 v187, v102, v103
s_nop 1
v_mfma_f32_32x32x16_bf16 v[160:175], a[160:163], v[184:187], v[160:175]
v_exp_f32 v104, v104
v_exp_f32 v105, v105
v_exp_f32 v106, v106
v_exp_f32 v107, v107
v_exp_f32 v108, v108
v_exp_f32 v109, v109
v_exp_f32 v110, v110
v_exp_f32 v111, v111
v_cvt_pk_bf16_f32 v188, v104, v105
v_cvt_pk_bf16_f32 v189, v106, v107
v_cvt_pk_bf16_f32 v190, v108, v109
v_cvt_pk_bf16_f32 v191, v110, v111
s_nop 1
v_mfma_f32_32x32x16_bf16 v[160:175], a[164:167], v[188:191], v[160:175]
s_add_u32 m0, s70, 0x1400
s_nop 0
buffer_load_dwordx4 v225, s[16:19], s71 offen lds
s_cmp_eq_u32 s61, 2
s_cbranch_scc1 LC2
v_mfma_f32_32x32x16_bf16 v[80:95], a[32:35], v[8:11], v[48:63]
v_exp_f32 v112, v112
v_exp_f32 v113, v113
v_exp_f32 v114, v114
v_exp_f32 v115, v115
v_exp_f32 v116, v116
v_exp_f32 v117, v117
v_exp_f32 v118, v118
v_exp_f32 v119, v119
v_cvt_pk_bf16_f32 v176, v112, v113
v_cvt_pk_bf16_f32 v177, v114, v115
v_cvt_pk_bf16_f32 v178, v116, v117
v_cvt_pk_bf16_f32 v179, v118, v119
s_nop 1
v_mfma_f32_32x32x16_bf16 v[144:159], a[96:99], v[176:179], v[144:159]
v_exp_f32 v120, v120
v_exp_f32 v121, v121
v_exp_f32 v122, v122
v_exp_f32 v123, v123
v_exp_f32 v124, v124
v_exp_f32 v125, v125
v_exp_f32 v126, v126
v_exp_f32 v127, v127
v_cvt_pk_bf16_f32 v180, v120, v121
v_cvt_pk_bf16_f32 v181, v122, v123
v_cvt_pk_bf16_f32 v182, v124, v125
v_cvt_pk_bf16_f32 v183, v126, v127
s_nop 1
v_mfma_f32_32x32x16_bf16 v[144:159], a[100:103], v[180:183], v[144:159]
s_add_u32 m0, s70, 0x1800
s_nop 0
buffer_load_dwordx4 v226, s[16:19], s71 offen lds
v_mfma_f32_32x32x16_bf16 v[96:111], a[36:39], v[12:15], v[64:79]
v_exp_f32 v128, v128
v_exp_f32 v129, v129
v_exp_f32 v130, v130
v_exp_f32 v131, v131
v_exp_f32 v132, v132
v_exp_f32 v133, v133
v_exp_f32 v134, v134
v_exp_f32 v135, v135
v_cvt_pk_bf16_f32 v184, v128, v129
v_cvt_pk_bf16_f32 v185, v130, v131
v_cvt_pk_bf16_f32 v186, v132, v133
v_cvt_pk_bf16_f32 v187, v134, v135
s_nop 1
v_mfma_f32_32x32x16_bf16 v[160:175], a[168:171], v[184:187], v[160:175]
v_exp_f32 v136, v136
v_exp_f32 v137, v137
v_exp_f32 v138, v138
v_exp_f32 v139, v139
v_exp_f32 v140, v140
v_exp_f32 v141, v141
v_exp_f32 v142, v142
v_exp_f32 v143, v143
v_cvt_pk_bf16_f32 v188, v136, v137
v_cvt_pk_bf16_f32 v189, v138, v139
v_cvt_pk_bf16_f32 v190, v140, v141
v_cvt_pk_bf16_f32 v191, v142, v143
s_nop 1
v_mfma_f32_32x32x16_bf16 v[160:175], a[172:175], v[188:191], v[160:175]
s_add_u32 m0, s70, 0x1c00
s_nop 0
buffer_load_dwordx4 v220, s[16:19], s72 offen lds
s_cmp_eq_u32 s61, 3
s_cbranch_scc1 LC3
v_mfma_f32_32x32x16_bf16 v[112:127], a[40:43], v[8:11], v[48:63]
v_exp_f32 v80, v80
v_exp_f32 v81, v81
v_exp_f32 v82, v82
v_exp_f32 v83, v83
v_exp_f32 v84, v84
v_exp_f32 v85, v85
v_exp_f32 v86, v86
v_exp_f32 v87, v87
v_cvt_pk_bf16_f32 v176, v80, v81
v_cvt_pk_bf16_f32 v177, v82, v83
v_cvt_pk_bf16_f32 v178, v84, v85
v_cvt_pk_bf16_f32 v179, v86, v87
s_nop 1
v_mfma_f32_32x32x16_bf16 v[144:159], a[104:107], v[176:179], v[144:159]
v_exp_f32 v88, v88
v_exp_f32 v89, v89
v_exp_f32 v90, v90
v_exp_f32 v91, v91
v_exp_f32 v92, v92
v_exp_f32 v93, v93
v_exp_f32 v94, v94
v_exp_f32 v95, v95
v_cvt_pk_bf16_f32 v180, v88, v89
v_cvt_pk_bf16_f32 v181, v90, v91
v_cvt_pk_bf16_f32 v182, v92, v93
v_cvt_pk_bf16_f32 v183, v94, v95
s_nop 1
v_mfma_f32_32x32x16_bf16 v[144:159], a[108:111], v[180:183], v[144:159]
s_add_u32 m0, s70, 0x2000
s_nop 0
buffer_load_dwordx4 v221, s[16:19], s72 offen lds
v_mfma_f32_32x32x16_bf16 v[128:143], a[44:47], v[12:15], v[64:79]
v_exp_f32 v96, v96
v_exp_f32 v97, v97
v_exp_f32 v98, v98
v_exp_f32 v99, v99
v_exp_f32 v100, v100
v_exp_f32 v101, v101
v_exp_f32 v102, v102
v_exp_f32 v103, v103
v_cvt_pk_bf16_f32 v184, v96, v97
v_cvt_pk_bf16_f32 v185, v98, v99
v_cvt_pk_bf16_f32 v186, v100, v101
v_cvt_pk_bf16_f32 v187, v102, v103
s_nop 1
v_mfma_f32_32x32x16_bf16 v[160:175], a[176:179], v[184:187], v[160:175]
v_exp_f32 v104, v104
v_exp_f32 v105, v105
v_exp_f32 v106, v106
v_exp_f32 v107, v107
v_exp_f32 v108, v108
v_exp_f32 v109, v109
v_exp_f32 v110, v110
v_exp_f32 v111, v111
v_cvt_pk_bf16_f32 v188, v104, v105
v_cvt_pk_bf16_f32 v189, v106, v107
v_cvt_pk_bf16_f32 v190, v108, v109
v_cvt_pk_bf16_f32 v191, v110, v111
s_nop 1
v_mfma_f32_32x32x16_bf16 v[160:175], a[180:183], v[188:191], v[160:175]
s_add_u32 m0, s70, 0x2400
s_nop 0
buffer_load_dwordx4 v222, s[16:19], s72 offen lds
s_cmp_eq_u32 s61, 4
s_cbranch_scc1 LC4
v_mfma_f32_32x32x16_bf16 v[80:95], a[48:51], v[8:11], v[48:63]
v_exp_f32 v112, v112
v_exp_f32 v113, v113
v_exp_f32 v114, v114
v_exp_f32 v115, v115
v_exp_f32 v116, v116
v_exp_f32 v117, v117
v_exp_f32 v118, v118
v_exp_f32 v119, v119
v_cvt_pk_bf16_f32 v176, v112, v113
v_cvt_pk_bf16_f32 v177, v114, v115
v_cvt_pk_bf16_f32 v178, v116, v117
v_cvt_pk_bf16_f32 v179, v118, v119
s_nop 1
v_mfma_f32_32x32x16_bf16 v[144:159], a[112:115], v[176:179], v[144:159]
v_exp_f32 v120, v120
v_exp_f32 v121, v121
v_exp_f32 v122, v122
v_exp_f32 v123, v123
v_exp_f32 v124, v124
v_exp_f32 v125, v125
v_exp_f32 v126, v126
v_exp_f32 v127, v127
v_cvt_pk_bf16_f32 v180, v120, v121
v_cvt_pk_bf16_f32 v181, v122, v123
v_cvt_pk_bf16_f32 v182, v124, v125
v_cvt_pk_bf16_f32 v183, v126, v127
s_nop 1
v_mfma_f32_32x32x16_bf16 v[144:159], a[116:119], v[180:183], v[144:159]
s_add_u32 m0, s70, 0x2800
s_nop 0
buffer_load_dwordx4 v223, s[16:19], s72 offen lds
v_mfma_f32_32x32x16_bf16 v[96:111], a[52:55], v[12:15], v[64:79]
v_exp_f32 v128, v128
v_exp_f32 v129, v129
v_exp_f32 v130, v130
v_exp_f32 v131, v131
v_exp_f32 v132, v132
v_exp_f32 v133, v133
v_exp_f32 v134, v134
v_exp_f32 v135, v135
v_cvt_pk_bf16_f32 v184, v128, v129
v_cvt_pk_bf16_f32 v185, v130, v131
v_cvt_pk_bf16_f32 v186, v132, v133
v_cvt_pk_bf16_f32 v187, v134, v135
s_nop 1
v_mfma_f32_32x32x16_bf16 v[160:175], a[184:187], v[184:187], v[160:175]
v_exp_f32 v136, v136
v_exp_f32 v137, v137
v_exp_f32 v138, v138
v_exp_f32 v139, v139
v_exp_f32 v140, v140
v_exp_f32 v141, v141
v_exp_f32 v142, v142
v_exp_f32 v143, v143
v_cvt_pk_bf16_f32 v188, v136, v137
v_cvt_pk_bf16_f32 v189, v138, v139
v_cvt_pk_bf16_f32 v190, v140, v141
v_cvt_pk_bf16_f32 v191, v142, v143
s_nop 1
v_mfma_f32_32x32x16_bf16 v[160:175], a[188:191], v[188:191], v[160:175]
s_add_u32 m0, s70, 0x2c00
s_nop 0
buffer_load_dwordx4 v224, s[16:19], s72 offen lds
s_cmp_eq_u32 s61, 5
s_cbranch_scc1 LC5
v_mfma_f32_32x32x16_bf16 v[112:127], a[56:59], v[8:11], v[48:63]
v_exp_f32 v80, v80
v_exp_f32 v81, v81
v_exp_f32 v82, v82
v_exp_f32 v83, v83
v_exp_f32 v84, v84
v_exp_f32 v85, v85
v_exp_f32 v86, v86
v_exp_f32 v87, v87
v_cvt_pk_bf16_f32 v176, v80, v81
v_cvt_pk_bf16_f32 v177, v82, v83
v_cvt_pk_bf16_f32 v178, v84, v85
v_cvt_pk_bf16_f32 v179, v86, v87
s_nop 1
v_mfma_f32_32x32x16_bf16 v[144:159], a[120:123], v[176:179], v[144:159]
v_exp_f32 v88, v88
v_exp_f32 v89, v89
v_exp_f32 v90, v90
v_exp_f32 v91, v91
v_exp_f32 v92, v92
v_exp_f32 v93, v93
v_exp_f32 v94, v94
v_exp_f32 v95, v95
v_cvt_pk_bf16_f32 v180, v88, v89
v_cvt_pk_bf16_f32 v181, v90, v91
v_cvt_pk_bf16_f32 v182, v92, v93
v_cvt_pk_bf16_f32 v183, v94, v95
s_nop 1
v_mfma_f32_32x32x16_bf16 v[144:159], a[124:127], v[180:183], v[144:159]
s_add_u32 m0, s70, 0x3000
s_nop 0
buffer_load_dwordx4 v225, s[16:19], s72 offen lds
v_mfma_f32_32x32x16_bf16 v[128:143], a[60:63], v[12:15], v[64:79]
v_exp_f32 v96, v96
v_exp_f32 v97, v97
v_exp_f32 v98, v98
v_exp_f32 v99, v99
v_exp_f32 v100, v100
v_exp_f32 v101, v101
v_exp_f32 v102, v102
v_exp_f32 v103, v103
v_cvt_pk_bf16_f32 v184, v96, v97
v_cvt_pk_bf16_f32 v185, v98, v99
v_cvt_pk_bf16_f32 v186, v100, v101
v_cvt_pk_bf16_f32 v187, v102, v103
s_nop 1
v_mfma_f32_32x32x16_bf16 v[160:175], a[192:195], v[184:187], v[160:175]
v_exp_f32 v104, v104
v_exp_f32 v105, v105
v_exp_f32 v106, v106
v_exp_f32 v107, v107
v_exp_f32 v108, v108
v_exp_f32 v109, v109
v_exp_f32 v110, v110
v_exp_f32 v111, v111
v_cvt_pk_bf16_f32 v188, v104, v105
v_cvt_pk_bf16_f32 v189, v106, v107
v_cvt_pk_bf16_f32 v190, v108, v109
v_cvt_pk_bf16_f32 v191, v110, v111
s_nop 1
v_mfma_f32_32x32x16_bf16 v[160:175], a[196:199], v[188:191], v[160:175]
s_add_u32 m0, s70, 0x3400
s_nop 0
buffer_load_dwordx4 v226, s[16:19], s72 offen lds
s_cmp_eq_u32 s61, 6
s_cbranch_scc1 LP2E
v_mfma_f32_32x32x16_bf16 v[80:95], a[64:67], v[8:11], v[192:207]
v_exp_f32 v112, v112
v_exp_f32 v113, v113
v_exp_f32 v114, v114
v_exp_f32 v115, v115
v_exp_f32 v116, v116
v_exp_f32 v117, v117
v_exp_f32 v118, v118
v_exp_f32 v119, v119
v_cvt_pk_bf16_f32 v176, v112, v113
v_cvt_pk_bf16_f32 v177, v114, v115
v_cvt_pk_bf16_f32 v178, v116, v117
v_cvt_pk_bf16_f32 v179, v118, v119
s_nop 1
v_mfma_f32_32x32x16_bf16 v[144:159], a[128:131], v[176:179], v[144:159]
v_exp_f32 v120, v120
v_exp_f32 v121, v121
v_exp_f32 v122, v122
v_exp_f32 v123, v123
v_exp_f32 v124, v124
v_exp_f32 v125, v125
v_exp_f32 v126, v126
v_exp_f32 v127, v127
v_cvt_pk_bf16_f32 v180, v120, v121
v_cvt_pk_bf16_f32 v181, v122, v123
v_cvt_pk_bf16_f32 v182, v124, v125
v_cvt_pk_bf16_f32 v183, v126, v127
s_nop 1
v_mfma_f32_32x32x16_bf16 v[144:159], a[132:135], v[180:183], v[144:159]
v_mfma_f32_32x32x16_bf16 v[96:111], a[68:71], v[12:15], v[32:47]
v_exp_f32 v128, v128
v_exp_f32 v129, v129
v_exp_f32 v130, v130
v_exp_f32 v131, v131
v_exp_f32 v132, v132
v_exp_f32 v133, v133
v_exp_f32 v134, v134
v_exp_f32 v135, v135
v_cvt_pk_bf16_f32 v184, v128, v129
v_cvt_pk_bf16_f32 v185, v130, v131
v_cvt_pk_bf16_f32 v186, v132, v133
v_cvt_pk_bf16_f32 v187, v134, v135
s_nop 1
v_mfma_f32_32x32x16_bf16 v[160:175], a[200:203], v[184:187], v[160:175]
v_exp_f32 v136, v136
v_exp_f32 v137, v137
v_exp_f32 v138, v138
v_exp_f32 v139, v139
v_exp_f32 v140, v140
v_exp_f32 v141, v141
v_exp_f32 v142, v142
v_exp_f32 v143, v143
v_cvt_pk_bf16_f32 v188, v136, v137
v_cvt_pk_bf16_f32 v189, v138, v139
v_cvt_pk_bf16_f32 v190, v140, v141
v_cvt_pk_bf16_f32 v191, v142, v143
s_nop 1
v_mfma_f32_32x32x16_bf16 v[160:175], a[204:207], v[188:191], v[160:175]
s_cmp_eq_u32 s61, 7
s_cbranch_scc1 LP2E
v_exp_f32 v80, v80
v_exp_f32 v81, v81
v_exp_f32 v82, v82
v_exp_f32 v83, v83
v_exp_f32 v84, v84
v_exp_f32 v85, v85
v_exp_f32 v86, v86
v_exp_f32 v87, v87
v_cvt_pk_bf16_f32 v176, v80, v81
v_cvt_pk_bf16_f32 v177, v82, v83
v_cvt_pk_bf16_f32 v178, v84, v85
v_cvt_pk_bf16_f32 v179, v86, v87
s_nop 1
v_mfma_f32_32x32x16_bf16 v[144:159], a[136:139], v[176:179], v[144:159]
v_exp_f32 v88, v88
v_exp_f32 v89, v89
v_exp_f32 v90, v90
v_exp_f32 v91, v91
v_exp_f32 v92, v92
v_exp_f32 v93, v93
v_exp_f32 v94, v94
v_exp_f32 v95, v95
v_cvt_pk_bf16_f32 v180, v88, v89
v_cvt_pk_bf16_f32 v181, v90, v91
v_cvt_pk_bf16_f32 v182, v92, v93
v_cvt_pk_bf16_f32 v183, v94, v95
s_nop 1
v_mfma_f32_32x32x16_bf16 v[144:159], a[140:143], v[180:183], v[144:159]
v_exp_f32 v96, v96
v_exp_f32 v97, v97
v_exp_f32 v98, v98
v_exp_f32 v99, v99
v_exp_f32 v100, v100
v_exp_f32 v101, v101
v_exp_f32 v102, v102
v_exp_f32 v103, v103
v_cvt_pk_bf16_f32 v184, v96, v97
v_cvt_pk_bf16_f32 v185, v98, v99
v_cvt_pk_bf16_f32 v186, v100, v101
v_cvt_pk_bf16_f32 v187, v102, v103
s_nop 1
v_mfma_f32_32x32x16_bf16 v[160:175], a[208:211], v[184:187], v[160:175]
v_exp_f32 v104, v104
v_exp_f32 v105, v105
v_exp_f32 v106, v106
v_exp_f32 v107, v107
v_exp_f32 v108, v108
v_exp_f32 v109, v109
v_exp_f32 v110, v110
v_exp_f32 v111, v111
v_cvt_pk_bf16_f32 v188, v104, v105
v_cvt_pk_bf16_f32 v189, v106, v107
v_cvt_pk_bf16_f32 v190, v108, v109
v_cvt_pk_bf16_f32 v191, v110, v111
s_nop 1
v_mfma_f32_32x32x16_bf16 v[160:175], a[212:215], v[188:191], v[160:175]
s_branch LP2E
LC0:
s_add_u32 m0, s70, 0x800
s_nop 0
buffer_load_dwordx4 v222, s[16:19], s71 offen lds
s_add_u32 m0, s70, 0xc00
s_nop 0
buffer_load_dwordx4 v223, s[16:19], s71 offen lds
LC1:
s_add_u32 m0, s70, 0x1000
s_nop 0
buffer_load_dwordx4 v224, s[16:19], s71 offen lds
s_add_u32 m0, s70, 0x1400
s_nop 0
buffer_load_dwordx4 v225, s[16:19], s71 offen lds
LC2:
s_add_u32 m0, s70, 0x1800
s_nop 0
buffer_load_dwordx4 v226, s[16:19], s71 offen lds
s_add_u32 m0, s70, 0x1c00
s_nop 0
buffer_load_dwordx4 v220, s[16:19], s72 offen lds
LC3:
s_add_u32 m0, s70, 0x2000
s_nop 0
buffer_load_dwordx4 v221, s[16:19], s72 offen lds
s_add_u32 m0, s70, 0x2400
s_nop 0
buffer_load_dwordx4 v222, s[16:19], s72 offen lds
LC4:
s_add_u32 m0, s70, 0x2800
s_nop 0
buffer_load_dwordx4 v223, s[16:19], s72 offen lds
s_add_u32 m0, s70, 0x2c00
s_nop 0
buffer_load_dwordx4 v224, s[16:19], s72 offen lds
LC5:
s_add_u32 m0, s70, 0x3000
s_nop 0
buffer_load_dwordx4 v225, s[16:19], s72 offen lds
s_add_u32 m0, s70, 0x3400
s_nop 0
buffer_load_dwordx4 v226, s[16:19], s72 offen lds
LP2E:
s_nop 11
s_lshl_b32 s56, s61, 4
s_add_u32 s56, s56, s50
s_lshl_b32 s56, s56, 11
s_add_u32 s56, s56, 0x700000
v_rcp_f32 v228, v152
s_nop 0
v_mul_f32 v144, v144, v228
v_mul_f32 v145, v145, v228
v_mul_f32 v146, v146, v228
v_mul_f32 v147, v147, v228
v_mul_f32 v148, v148, v228
v_mul_f32 v149, v149, v228
v_mul_f32 v150, v150, v228
v_mul_f32 v151, v151, v228
v_cvt_pk_bf16_f32 v176, v144, v145
v_cvt_pk_bf16_f32 v177, v146, v147
v_cvt_pk_bf16_f32 v178, v148, v149
v_cvt_pk_bf16_f32 v179, v150, v151
buffer_store_dwordx4 v[176:179], v1, s[24:27], s56 offen offset:0 sc1
v_rcp_f32 v229, v160
s_nop 0
v_mul_f32 v168, v168, v229
v_mul_f32 v169, v169, v229
v_mul_f32 v170, v170, v229
v_mul_f32 v171, v171, v229
v_mul_f32 v172, v172, v229
v_mul_f32 v173, v173, v229
v_mul_f32 v174, v174, v229
v_mul_f32 v175, v175, v229
v_cvt_pk_bf16_f32 v180, v168, v169
v_cvt_pk_bf16_f32 v181, v170, v171
v_cvt_pk_bf16_f32 v182, v172, v173
v_cvt_pk_bf16_f32 v183, v174, v175
buffer_store_dwordx4 v[180:183], v1, s[24:27], s56 offen offset:1024 sc1
s_waitcnt vmcnt(0)
s_lshl_b32 s60, s49, 4
s_add_u32 s60, s60, s50
s_lshl_b32 s60, s60, 2
s_add_u32 s60, s60, s51
s_lshl_b32 s60, s60, 6
s_add_u32 s60, s60, 0x30000
v_mov_b32 v3, s48
s_mov_b64 exec, 1
buffer_store_dword v3, off, s[24:27], s60 sc1
s_mov_b64 exec, -1
s_barrier
v_accvgpr_read_b32 v8, a224
v_accvgpr_read_b32 v9, a225
v_accvgpr_read_b32 v10, a226
v_accvgpr_read_b32 v11, a227
v_lshrrev_b32 v4, 5, v0
v_lshlrev_b32 v4, 2, v4
v_bfe_u32 v5, v0, 2, 2
v_add_u32 v4, v4, v5
v_lshlrev_b32 v4, 6, v4
v_bfe_u32 v5, v0, 4, 1
v_lshl_add_u32 v4, v5, 5, v4
v_and_b32 v5, 3, v0
v_lshl_add_u32 v4, v5, 3, v4
s_and_b32 s58, s51, 1
s_lshl_b32 s57, s58, 14
v_add_u32 v4, s57, v4
ds_read_b64_tr_b16 a[0:1], v4 offset:0
ds_read_b64_tr_b16 a[2:3], v4 offset:512
ds_read_b64_tr_b16 a[4:5], v4 offset:32768
ds_read_b64_tr_b16 a[6:7], v4 offset:33280
ds_read_b64_tr_b16 a[8:9], v4 offset:1024
ds_read_b64_tr_b16 a[10:11], v4 offset:1536
ds_read_b64_tr_b16 a[12:13], v4 offset:33792
ds_read_b64_tr_b16 a[14:15], v4 offset:34304
ds_read_b64_tr_b16 a[16:17], v4 offset:2048
ds_read_b64_tr_b16 a[18:19], v4 offset:2560
ds_read_b64_tr_b16 a[20:21], v4 offset:34816
ds_read_b64_tr_b16 a[22:23], v4 offset:35328
ds_read_b64_tr_b16 a[24:25], v4 offset:3072
ds_read_b64_tr_b16 a[26:27], v4 offset:3584
ds_read_b64_tr_b16 a[28:29], v4 offset:35840
ds_read_b64_tr_b16 a[30:31], v4 offset:36352
ds_read_b64_tr_b16 a[32:33], v4 offset:4096
ds_read_b64_tr_b16 a[34:35], v4 offset:4608
ds_read_b64_tr_b16 a[36:37], v4 offset:36864
ds_read_b64_tr_b16 a[38:39], v4 offset:37376
ds_read_b64_tr_b16 a[40:41], v4 offset:5120
ds_read_b64_tr_b16 a[42:43], v4 offset:5632
ds_read_b64_tr_b16 a[44:45], v4 offset:37888
ds_read_b64_tr_b16 a[46:47], v4 offset:38400
ds_read_b64_tr_b16 a[48:49], v4 offset:6144
ds_read_b64_tr_b16 a[50:51], v4 offset:6656
ds_read_b64_tr_b16 a[52:53], v4 offset:38912
ds_read_b64_tr_b16 a[54:55], v4 offset:39424
ds_read_b64_tr_b16 a[56:57], v4 offset:7168
ds_read_b64_tr_b16 a[58:59], v4 offset:7680
ds_read_b64_tr_b16 a[60:61], v4 offset:39936
ds_read_b64_tr_b16 a[62:63], v4 offset:40448
ds_read_b64_tr_b16 a[64:65], v4 offset:8192
ds_read_b64_tr_b16 a[66:67], v4 offset:8704
ds_read_b64_tr_b16 a[68:69], v4 offset:40960
ds_read_b64_tr_b16 a[70:71], v4 offset:41472
ds_read_b64_tr_b16 a[72:73], v4 offset:9216
ds_read_b64_tr_b16 a[74:75], v4 offset:9728
ds_read_b64_tr_b16 a[76:77], v4 offset:41984
ds_read_b64_tr_b16 a[78:79], v4 offset:42496
ds_read_b64_tr_b16 a[80:81], v4 offset:10240
ds_read_b64_tr_b16 a[82:83], v4 offset:10752
ds_read_b64_tr_b16 a[84:85], v4 offset:43008
ds_read_b64_tr_b16 a[86:87], v4 offset:43520
ds_read_b64_tr_b16 a[88:89], v4 offset:11264
ds_read_b64_tr_b16 a[90:91], v4 offset:11776
ds_read_b64_tr_b16 a[92:93], v4 offset:44032
ds_read_b64_tr_b16 a[94:95], v4 offset:44544
ds_read_b64_tr_b16 a[96:97], v4 offset:12288
ds_read_b64_tr_b16 a[98:99], v4 offset:12800
ds_read_b64_tr_b16 a[100:101], v4 offset:45056
ds_read_b64_tr_b16 a[102:103], v4 offset:45568
ds_read_b64_tr_b16 a[104:105], v4 offset:13312
ds_read_b64_tr_b16 a[106:107], v4 offset:13824
ds_read_b64_tr_b16 a[108:109], v4 offset:46080
ds_read_b64_tr_b16 a[110:111], v4 offset:46592
ds_read_b64_tr_b16 a[112:113], v4 offset:14336
ds_read_b64_tr_b16 a[114:115], v4 offset:14848
ds_read_b64_tr_b16 a[116:117], v4 offset:47104
ds_read_b64_tr_b16 a[118:119], v4 offset:47616
ds_read_b64_tr_b16 a[120:121], v4 offset:15360
ds_read_b64_tr_b16 a[122:123], v4 offset:15872
ds_read_b64_tr_b16 a[124:125], v4 offset:48128
ds_read_b64_tr_b16 a[126:127], v4 offset:48640
v_lshrrev_b32 v3, 4, v0
v_bfe_u32 v4, v0, 2, 2
v_lshl_add_u32 v4, v3, 2, v4
v_mul_u32_u24 v4, 224, v4
v_and_b32 v5, 3, v0
v_lshl_add_u32 v229, v5, 3, v4
v_add_u32 v227, 0x10000, v229
v_add_u32 v228, 0x1a800, v229
s_lshl_b32 s57, s51, 5
v_add_u32 v4, s57, v227
v_add_u32 v5, s57, v228
v_add_u32 v6, s57, v229
v_and_b32 v13, 1, v0
v_lshlrev_b32 v12, 10, v13
v_lshlrev_b32 v2, 3, v3
v_sub_u32 v12, v2, v12
v_add_u32 v12, 0x27000, v12
v_cmp_eq_u32 vcc, 1, v13
v_lshlrev_b32 v14, 16, v8
v_and_b32 v15, 0xffff0000, v8
v_cndmask_b32 v14, 0, v14, vcc
v_cndmask_b32 v15, 0, v15, vcc
v_accvgpr_write_b32 a248, v14
v_accvgpr_write_b32 a249, v15
v_lshlrev_b32 v14, 16, v9
v_and_b32 v15, 0xffff0000, v9
v_cndmask_b32 v14, 0, v14, vcc
v_cndmask_b32 v15, 0, v15, vcc
v_accvgpr_write_b32 a250, v14
v_accvgpr_write_b32 a251, v15
v_lshlrev_b32 v14, 16, v10
v_and_b32 v15, 0xffff0000, v10
v_cndmask_b32 v14, 0, v14, vcc
v_cndmask_b32 v15, 0, v15, vcc
v_accvgpr_write_b32 a252, v14
v_accvgpr_write_b32 a253, v15
v_lshlrev_b32 v14, 16, v11
v_and_b32 v15, 0xffff0000, v11
v_cndmask_b32 v14, 0, v14, vcc
v_cndmask_b32 v15, 0, v15, vcc
v_accvgpr_write_b32 a254, v14
v_accvgpr_write_b32 a255, v15
ds_read_b64 v[16:17], v12 offset:0
ds_read_b64 v[18:19], v12 offset:32
ds_read_b64_tr_b16 v[64:65], v4 offset:0
ds_read_b64_tr_b16 v[66:67], v4 offset:3584
ds_read_b64_tr_b16 v[68:69], v4 offset:128
ds_read_b64_tr_b16 v[70:71], v4 offset:3712
ds_read_b64 v[20:21], v12 offset:64
ds_read_b64 v[22:23], v12 offset:96
ds_read_b64_tr_b16 v[72:73], v4 offset:7168
ds_read_b64_tr_b16 v[74:75], v4 offset:10752
ds_read_b64_tr_b16 v[76:77], v4 offset:7296
ds_read_b64_tr_b16 v[78:79], v4 offset:10880
ds_read_b64 v[24:25], v12 offset:128
ds_read_b64 v[26:27], v12 offset:160
ds_read_b64_tr_b16 v[80:81], v4 offset:14336
ds_read_b64_tr_b16 v[82:83], v4 offset:17920
ds_read_b64_tr_b16 v[84:85], v4 offset:14464
ds_read_b64_tr_b16 v[86:87], v4 offset:18048
ds_read_b64 v[28:29], v12 offset:192
ds_read_b64 v[30:31], v12 offset:224
ds_read_b64_tr_b16 v[88:89], v4 offset:21504
ds_read_b64_tr_b16 v[90:91], v4 offset:25088
ds_read_b64_tr_b16 v[92:93], v4 offset:21632
ds_read_b64_tr_b16 v[94:95], v4 offset:25216
ds_read_b64 v[32:33], v12 offset:256
ds_read_b64 v[34:35], v12 offset:288
ds_read_b64_tr_b16 v[96:97], v4 offset:28672
ds_read_b64_tr_b16 v[98:99], v4 offset:32256
ds_read_b64_tr_b16 v[100:101], v4 offset:28800
ds_read_b64_tr_b16 v[102:103], v4 offset:32384
ds_read_b64 v[36:37], v12 offset:320
ds_read_b64 v[38:39], v12 offset:352
ds_read_b64_tr_b16 v[104:105], v4 offset:35840
ds_read_b64_tr_b16 v[106:107], v4 offset:39424
ds_read_b64_tr_b16 v[108:109], v4 offset:35968
ds_read_b64_tr_b16 v[110:111], v4 offset:39552
ds_read_b64 v[40:41], v12 offset:384
ds_read_b64 v[42:43], v12 offset:416
ds_read_b64_tr_b16 v[112:113], v5 offset:0
ds_read_b64_tr_b16 v[114:115], v5 offset:3584
ds_read_b64_tr_b16 v[116:117], v5 offset:128
ds_read_b64_tr_b16 v[118:119], v5 offset:3712
ds_read_b64 v[44:45], v12 offset:448
ds_read_b64 v[46:47], v12 offset:480
ds_read_b64_tr_b16 v[120:121], v5 offset:7168
ds_read_b64_tr_b16 v[122:123], v5 offset:10752
ds_read_b64_tr_b16 v[124:125], v5 offset:7296
ds_read_b64_tr_b16 v[126:127], v5 offset:10880
ds_read_b64 v[48:49], v12 offset:512
ds_read_b64 v[50:51], v12 offset:544
ds_read_b64_tr_b16 v[128:129], v5 offset:14336
ds_read_b64_tr_b16 v[130:131], v5 offset:17920
ds_read_b64_tr_b16 v[132:133], v5 offset:14464
ds_read_b64_tr_b16 v[134:135], v5 offset:18048
ds_read_b64 v[52:53], v12 offset:576
ds_read_b64 v[54:55], v12 offset:608
ds_read_b64_tr_b16 v[136:137], v5 offset:21504
ds_read_b64_tr_b16 v[138:139], v5 offset:25088
ds_read_b64_tr_b16 v[140:141], v5 offset:21632
ds_read_b64_tr_b16 v[142:143], v5 offset:25216
ds_read_b64 v[56:57], v12 offset:640
ds_read_b64 v[58:59], v12 offset:672
ds_read_b64_tr_b16 v[144:145], v5 offset:28672
ds_read_b64_tr_b16 v[146:147], v5 offset:32256
ds_read_b64_tr_b16 v[148:149], v5 offset:28800
ds_read_b64_tr_b16 v[150:151], v5 offset:32384
ds_read_b64 v[60:61], v12 offset:704
ds_read_b64 v[62:63], v12 offset:736
ds_read_b64_tr_b16 v[152:153], v5 offset:35840
ds_read_b64_tr_b16 v[154:155], v5 offset:39424
ds_read_b64_tr_b16 v[156:157], v5 offset:35968
ds_read_b64_tr_b16 v[158:159], v5 offset:39552
v_mfma_f32_16x16x32_bf16 a[248:251], v[64:67], v[16:19], a[248:251]
v_mfma_f32_16x16x32_bf16 a[252:255], v[68:71], v[16:19], a[252:255]
v_mfma_f32_16x16x32_bf16 a[248:251], v[72:75], v[20:23], a[248:251]
v_mfma_f32_16x16x32_bf16 a[252:255], v[76:79], v[20:23], a[252:255]
v_mfma_f32_16x16x32_bf16 a[248:251], v[80:83], v[24:27], a[248:251]
v_mfma_f32_16x16x32_bf16 a[252:255], v[84:87], v[24:27], a[252:255]
v_mfma_f32_16x16x32_bf16 a[248:251], v[88:91], v[28:31], a[248:251]
v_mfma_f32_16x16x32_bf16 a[252:255], v[92:95], v[28:31], a[252:255]
v_mfma_f32_16x16x32_bf16 a[248:251], v[96:99], v[32:35], a[248:251]
v_mfma_f32_16x16x32_bf16 a[252:255], v[100:103], v[32:35], a[252:255]
v_mfma_f32_16x16x32_bf16 a[248:251], v[104:107], v[36:39], a[248:251]
v_mfma_f32_16x16x32_bf16 a[252:255], v[108:111], v[36:39], a[252:255]
v_mfma_f32_16x16x32_bf16 a[248:251], v[112:115], v[40:43], a[248:251]
v_mfma_f32_16x16x32_bf16 a[252:255], v[116:119], v[40:43], a[252:255]
v_mfma_f32_16x16x32_bf16 a[248:251], v[120:123], v[44:47], a[248:251]
v_mfma_f32_16x16x32_bf16 a[252:255], v[124:127], v[44:47], a[252:255]
v_mfma_f32_16x16x32_bf16 a[248:251], v[128:131], v[48:51], a[248:251]
v_mfma_f32_16x16x32_bf16 a[252:255], v[132:135], v[48:51], a[252:255]
s_waitcnt lgkmcnt(14)
v_mfma_f32_16x16x32_bf16 a[248:251], v[136:139], v[52:55], a[248:251]
s_waitcnt lgkmcnt(12)
v_mfma_f32_16x16x32_bf16 a[252:255], v[140:143], v[52:55], a[252:255]
s_waitcnt lgkmcnt(8)
v_mfma_f32_16x16x32_bf16 a[248:251], v[144:147], v[56:59], a[248:251]
s_waitcnt lgkmcnt(6)
v_mfma_f32_16x16x32_bf16 a[252:255], v[148:151], v[56:59], a[252:255]
s_waitcnt lgkmcnt(2)
v_mfma_f32_16x16x32_bf16 a[248:251], v[152:155], v[60:63], a[248:251]
s_waitcnt lgkmcnt(0)
v_mfma_f32_16x16x32_bf16 a[252:255], v[156:159], v[60:63], a[252:255]
s_waitcnt lgkmcnt(0)
s_barrier
v_and_b32 v2, 7, v0
v_lshlrev_b32 v2, 8, v2
s_lshl_b32 s56, s49, 12
s_lshl_b32 s57, s58, 11
s_add_u32 s56, s56, s57
s_lshr_b32 s57, s50, 3
s_lshl_b32 s57, s57, 1
s_lshr_b32 s59, s51, 1
s_add_u32 s57, s57, s59
s_lshl_b32 s59, s57, 6
s_add_u32 s56, s56, s59
s_add_u32 s56, s56, 0x30000
v_add_u32 v2, s56, v2
s_lshl_b32 s64, s49, 17
s_lshl_b32 s59, s57, 15
s_add_u32 s64, s64, s59
s_lshl_b32 s59, s58, 14
s_add_u32 s64, s64, s59
s_add_u32 s64, s64, 0x700000
s_add_u32 s65, s64, 0x1000
s_add_u32 s66, s64, 0x2000
s_add_u32 s67, s64, 0x3000
s_mul_i32 s70, s51, 7168
s_mul_i32 s71, s50, 224
s_mul_i32 s56, s51, 0x1c000
s_add_u32 s71, s71, s56
s_add_u32 s71, s71, 0x150000
s_nop 1
Lp_7:
buffer_load_dword v3, v2, s[24:27], 0 offen sc1
s_waitcnt vmcnt(0)
v_cmp_ne_u32 vcc, s48, v3
s_cbranch_vccz Ld_8
s_cmp_eq_u32 s52, 0
s_cbranch_scc1 Ld_8
s_sub_u32 s52, s52, 1
s_sleep 2
s_branch Lp_7
Ld_8:
s_nop 0
buffer_load_dwordx4 v[16:19], v1, s[24:27], s64 offen offset:0 sc1
buffer_load_dwordx4 v[20:23], v1, s[24:27], s64 offen offset:1024 sc1
buffer_load_dwordx4 v[24:27], v1, s[24:27], s64 offen offset:2048 sc1
buffer_load_dwordx4 v[28:31], v1, s[24:27], s64 offen offset:3072 sc1
buffer_load_dwordx4 v[32:35], v1, s[24:27], s65 offen offset:0 sc1
buffer_load_dwordx4 v[36:39], v1, s[24:27], s65 offen offset:1024 sc1
buffer_load_dwordx4 v[40:43], v1, s[24:27], s65 offen offset:2048 sc1
buffer_load_dwordx4 v[44:47], v1, s[24:27], s65 offen offset:3072 sc1
buffer_load_dwordx4 v[48:51], v1, s[24:27], s66 offen offset:0 sc1
buffer_load_dwordx4 v[52:55], v1, s[24:27], s66 offen offset:1024 sc1
buffer_load_dwordx4 v[56:59], v1, s[24:27], s66 offen offset:2048 sc1
buffer_load_dwordx4 v[60:63], v1, s[24:27], s66 offen offset:3072 sc1
buffer_load_dwordx4 v[64:67], v1, s[24:27], s67 offen offset:0 sc1
buffer_load_dwordx4 v[68:71], v1, s[24:27], s67 offen offset:1024 sc1
buffer_load_dwordx4 v[72:75], v1, s[24:27], s67 offen offset:2048 sc1
buffer_load_dwordx4 v[76:79], v1, s[24:27], s67 offen offset:3072 sc1
v_lshrrev_b32 v2, 4, v0
v_lshlrev_b32 v2, 3, v2
v_add_u32 v2, s75, v2
v_add_u32 v2, 0x26000, v2
ds_read_b64 v[208:209], v2 offset:2048
ds_read_b64 v[210:211], v2 offset:2080
ds_read_b64 v[212:213], v2 offset:2112
ds_read_b64 v[214:215], v2 offset:2144
v_lshrrev_b32 v2, 4, v0
v_lshlrev_b32 v2, 3, v2
v_add_u32 v2, s75, v2
v_add_u32 v2, 0x26000, v2
ds_read_b64 v[112:113], v2 offset:4096
ds_read_b64 v[114:115], v2 offset:4128
ds_read_b64 v[116:117], v2 offset:4160
ds_read_b64 v[118:119], v2 offset:4192
v_and_b32 v2, 31, v0
v_lshrrev_b32 v3, 5, v0
v_and_b32 v14, 15, v0
v_xor_b32 v3, v3, v14
v_lshlrev_b32 v3, 4, v3
v_lshl_add_u32 v3, v2, 8, v3
v_add_u32 v3, s74, v3
v_xor_b32 v120, 0, v3
v_xor_b32 v121, 32, v3
v_xor_b32 v122, 64, v3
v_xor_b32 v123, 0x60, v3
v_xor_b32 v124, 0x80, v3
v_xor_b32 v125, 0xa0, v3
v_xor_b32 v126, 0xc0, v3
v_xor_b32 v127, 0xe0, v3
v_lshrrev_b32 v3, 4, v0
v_xor_b32 v3, v3, v14
v_lshlrev_b32 v3, 4, v3
v_lshl_add_u32 v3, v14, 8, v3
s_lshr_b32 s56, s51, 1
s_lshl_b32 s56, s56, 14
s_lshl_b32 s57, s58, 12
s_add_u32 s56, s56, s57
v_add_u32 v3, s56, v3
v_xor_b32 v128, 0, v3
v_xor_b32 v129, 64, v3
v_xor_b32 v130, 0x80, v3
v_xor_b32 v131, 0xc0, v3
s_waitcnt vmcnt(15)
v_mfma_f32_32x32x16_bf16 v[80:95], a[0:3], v[16:19], 0
v_mfma_f32_32x32x16_bf16 v[96:111], a[4:7], v[16:19], 0
s_waitcnt vmcnt(14)
v_mfma_f32_32x32x16_bf16 v[80:95], a[8:11], v[20:23], v[80:95]
v_mfma_f32_32x32x16_bf16 v[96:111], a[12:15], v[20:23], v[96:111]
s_waitcnt vmcnt(13)
v_mfma_f32_32x32x16_bf16 v[80:95], a[16:19], v[24:27], v[80:95]
s_add_u32 m0, s70, 0x0
s_nop 0
buffer_load_dwordx4 v220, s[16:19], s71 offen lds
v_mfma_f32_32x32x16_bf16 v[96:111], a[20:23], v[24:27], v[96:111]
s_waitcnt vmcnt(13)
v_mfma_f32_32x32x16_bf16 v[80:95], a[24:27], v[28:31], v[80:95]
v_mfma_f32_32x32x16_bf16 v[96:111], a[28:31], v[28:31], v[96:111]
s_waitcnt vmcnt(12)
v_mfma_f32_32x32x16_bf16 v[80:95], a[32:35], v[32:35], v[80:95]
s_add_u32 m0, s70, 0x400
s_nop 0
buffer_load_dwordx4 v221, s[16:19], s71 offen lds
v_mfma_f32_32x32x16_bf16 v[96:111], a[36:39], v[32:35], v[96:111]
s_waitcnt vmcnt(12)
v_mfma_f32_32x32x16_bf16 v[80:95], a[40:43], v[36:39], v[80:95]
v_mfma_f32_32x32x16_bf16 v[96:111], a[44:47], v[36:39], v[96:111]
s_waitcnt vmcnt(11)
v_mfma_f32_32x32x16_bf16 v[80:95], a[48:51], v[40:43], v[80:95]
s_add_u32 m0, s70, 0x800
s_nop 0
buffer_load_dwordx4 v222, s[16:19], s71 offen lds
v_mfma_f32_32x32x16_bf16 v[96:111], a[52:55], v[40:43], v[96:111]
s_waitcnt vmcnt(11)
v_mfma_f32_32x32x16_bf16 v[80:95], a[56:59], v[44:47], v[80:95]
v_mfma_f32_32x32x16_bf16 v[96:111], a[60:63], v[44:47], v[96:111]
s_waitcnt vmcnt(10)
v_mfma_f32_32x32x16_bf16 v[80:95], a[64:67], v[48:51], v[80:95]
s_add_u32 m0, s70, 0xc00
s_nop 0
buffer_load_dwordx4 v223, s[16:19], s71 offen lds
v_mfma_f32_32x32x16_bf16 v[96:111], a[68:71], v[48:51], v[96:111]
s_waitcnt vmcnt(10)
v_mfma_f32_32x32x16_bf16 v[80:95], a[72:75], v[52:55], v[80:95]
v_mfma_f32_32x32x16_bf16 v[96:111], a[76:79], v[52:55], v[96:111]
s_waitcnt vmcnt(9)
v_mfma_f32_32x32x16_bf16 v[80:95], a[80:83], v[56:59], v[80:95]
s_add_u32 m0, s70, 0x1000
s_nop 0
buffer_load_dwordx4 v224, s[16:19], s71 offen lds
v_mfma_f32_32x32x16_bf16 v[96:111], a[84:87], v[56:59], v[96:111]
s_waitcnt vmcnt(9)
v_mfma_f32_32x32x16_bf16 v[80:95], a[88:91], v[60:63], v[80:95]
v_mfma_f32_32x32x16_bf16 v[96:111], a[92:95], v[60:63], v[96:111]
s_waitcnt vmcnt(8)
v_mfma_f32_32x32x16_bf16 v[80:95], a[96:99], v[64:67], v[80:95]
s_add_u32 m0, s70, 0x1400
s_nop 0
buffer_load_dwordx4 v225, s[16:19], s71 offen lds
v_mfma_f32_32x32x16_bf16 v[96:111], a[100:103], v[64:67], v[96:111]
s_waitcnt vmcnt(8)
v_mfma_f32_32x32x16_bf16 v[80:95], a[104:107], v[68:71], v[80:95]
v_mfma_f32_32x32x16_bf16 v[96:111], a[108:111], v[68:71], v[96:111]
s_waitcnt vmcnt(7)
v_mfma_f32_32x32x16_bf16 v[80:95], a[112:115], v[72:75], v[80:95]
s_add_u32 m0, s70, 0x1800
s_nop 0
buffer_load_dwordx4 v226, s[16:19], s71 offen lds
v_mfma_f32_32x32x16_bf16 v[96:111], a[116:119], v[72:75], v[96:111]
s_waitcnt vmcnt(7)
v_mfma_f32_32x32x16_bf16 v[80:95], a[120:123], v[76:79], v[80:95]
v_mfma_f32_32x32x16_bf16 v[96:111], a[124:127], v[76:79], v[96:111]
s_nop 10
ds_write_b128 v120, v[80:83] offset:32768
ds_write_b128 v121, v[84:87] offset:32768
ds_write_b128 v122, v[88:91] offset:32768
ds_write_b128 v123, v[92:95] offset:32768
ds_write_b128 v124, v[96:99] offset:32768
ds_write_b128 v125, v[100:103] offset:32768
ds_write_b128 v126, v[104:107] offset:32768
ds_write_b128 v127, v[108:111] offset:32768
s_waitcnt vmcnt(0) lgkmcnt(0)
s_barrier
ds_read_b128 v[16:19], v128 offset:32768
ds_read_b128 v[32:35], v128 offset:40960
ds_read_b128 v[20:23], v129 offset:32768
ds_read_b128 v[36:39], v129 offset:40960
ds_read_b128 v[24:27], v130 offset:32768
ds_read_b128 v[40:43], v130 offset:40960
ds_read_b128 v[28:31], v131 offset:32768
ds_read_b128 v[44:47], v131 offset:40960
s_waitcnt lgkmcnt(6)
v_add_f32 v16, v16, v32
v_add_f32 v17, v17, v33
v_lshlrev_b32 v2, 16, v232
v_and_b32 v3, 0xffff0000, v232
v_lshlrev_b32 v8, 16, v208
v_and_b32 v9, 0xffff0000, v208
v_fma_f32 v2, v16, v8, v2
v_fma_f32 v3, v17, v9, v3
v_cvt_pk_bf16_f32 v10, v2, v3
v_lshlrev_b32 v240, 16, v10
v_and_b32 v241, 0xffff0000, v10
v_lshlrev_b32 v8, 16, v112
v_and_b32 v9, 0xffff0000, v112
v_mul_f32 v8, v8, v240
v_mul_f32 v9, v9, v241
v_cvt_pk_bf16_f32 v96, v8, v9
v_add_f32 v18, v18, v34
v_add_f32 v19, v19, v35
v_lshlrev_b32 v2, 16, v233
v_and_b32 v3, 0xffff0000, v233
v_lshlrev_b32 v8, 16, v209
v_and_b32 v9, 0xffff0000, v209
v_fma_f32 v2, v18, v8, v2
v_fma_f32 v3, v19, v9, v3
v_cvt_pk_bf16_f32 v10, v2, v3
v_lshlrev_b32 v242, 16, v10
v_and_b32 v243, 0xffff0000, v10
v_lshlrev_b32 v8, 16, v113
v_and_b32 v9, 0xffff0000, v113
v_mul_f32 v8, v8, v242
v_mul_f32 v9, v9, v243
v_cvt_pk_bf16_f32 v97, v8, v9
s_waitcnt lgkmcnt(4)
v_add_f32 v20, v20, v36
v_add_f32 v21, v21, v37
v_lshlrev_b32 v2, 16, v234
v_and_b32 v3, 0xffff0000, v234
v_lshlrev_b32 v8, 16, v210
v_and_b32 v9, 0xffff0000, v210
v_fma_f32 v2, v20, v8, v2
v_fma_f32 v3, v21, v9, v3
v_cvt_pk_bf16_f32 v10, v2, v3
v_lshlrev_b32 v244, 16, v10
v_and_b32 v245, 0xffff0000, v10
v_lshlrev_b32 v8, 16, v114
v_and_b32 v9, 0xffff0000, v114
v_mul_f32 v8, v8, v244
v_mul_f32 v9, v9, v245
v_cvt_pk_bf16_f32 v98, v8, v9
v_add_f32 v22, v22, v38
v_add_f32 v23, v23, v39
v_lshlrev_b32 v2, 16, v235
v_and_b32 v3, 0xffff0000, v235
v_lshlrev_b32 v8, 16, v211
v_and_b32 v9, 0xffff0000, v211
v_fma_f32 v2, v22, v8, v2
v_fma_f32 v3, v23, v9, v3
v_cvt_pk_bf16_f32 v10, v2, v3
v_lshlrev_b32 v246, 16, v10
v_and_b32 v247, 0xffff0000, v10
v_lshlrev_b32 v8, 16, v115
v_and_b32 v9, 0xffff0000, v115
v_mul_f32 v8, v8, v246
v_mul_f32 v9, v9, v247
v_cvt_pk_bf16_f32 v99, v8, v9
s_waitcnt lgkmcnt(2)
v_add_f32 v24, v24, v40
v_add_f32 v25, v25, v41
v_lshlrev_b32 v2, 16, v236
v_and_b32 v3, 0xffff0000, v236
v_lshlrev_b32 v8, 16, v212
v_and_b32 v9, 0xffff0000, v212
v_fma_f32 v2, v24, v8, v2
v_fma_f32 v3, v25, v9, v3
v_cvt_pk_bf16_f32 v10, v2, v3
v_lshlrev_b32 v248, 16, v10
v_and_b32 v249, 0xffff0000, v10
v_lshlrev_b32 v8, 16, v116
v_and_b32 v9, 0xffff0000, v116
v_mul_f32 v8, v8, v248
v_mul_f32 v9, v9, v249
v_cvt_pk_bf16_f32 v100, v8, v9
v_add_f32 v26, v26, v42
v_add_f32 v27, v27, v43
v_lshlrev_b32 v2, 16, v237
v_and_b32 v3, 0xffff0000, v237
v_lshlrev_b32 v8, 16, v213
v_and_b32 v9, 0xffff0000, v213
v_fma_f32 v2, v26, v8, v2
v_fma_f32 v3, v27, v9, v3
v_cvt_pk_bf16_f32 v10, v2, v3
v_lshlrev_b32 v250, 16, v10
v_and_b32 v251, 0xffff0000, v10
v_lshlrev_b32 v8, 16, v117
v_and_b32 v9, 0xffff0000, v117
v_mul_f32 v8, v8, v250
v_mul_f32 v9, v9, v251
v_cvt_pk_bf16_f32 v101, v8, v9
s_waitcnt lgkmcnt(0)
v_add_f32 v28, v28, v44
v_add_f32 v29, v29, v45
v_lshlrev_b32 v2, 16, v238
v_and_b32 v3, 0xffff0000, v238
v_lshlrev_b32 v8, 16, v214
v_and_b32 v9, 0xffff0000, v214
v_fma_f32 v2, v28, v8, v2
v_fma_f32 v3, v29, v9, v3
v_cvt_pk_bf16_f32 v10, v2, v3
v_lshlrev_b32 v252, 16, v10
v_and_b32 v253, 0xffff0000, v10
v_lshlrev_b32 v8, 16, v118
v_and_b32 v9, 0xffff0000, v118
v_mul_f32 v8, v8, v252
v_mul_f32 v9, v9, v253
v_cvt_pk_bf16_f32 v102, v8, v9
v_add_f32 v30, v30, v46
v_add_f32 v31, v31, v47
v_lshlrev_b32 v2, 16, v239
v_and_b32 v3, 0xffff0000, v239
v_lshlrev_b32 v8, 16, v215
v_and_b32 v9, 0xffff0000, v215
v_fma_f32 v2, v30, v8, v2
v_fma_f32 v3, v31, v9, v3
v_cvt_pk_bf16_f32 v10, v2, v3
v_lshlrev_b32 v254, 16, v10
v_and_b32 v255, 0xffff0000, v10
v_lshlrev_b32 v8, 16, v119
v_and_b32 v9, 0xffff0000, v119
v_mul_f32 v8, v8, v254
v_mul_f32 v9, v9, v255
v_cvt_pk_bf16_f32 v103, v8, v9
s_lshl_b32 s58, s76, 10
s_lshl_b32 s59, s75, 4
s_add_u32 s58, s58, s59
s_add_u32 s58, s58, 0x900000
buffer_store_dwordx4 v[96:99], v1, s[24:27], s58 offen offset:0 sc1
buffer_store_dwordx4 v[100:103], v1, s[24:27], s58 offen offset:1024 sc1
v_add_f32 v2, v240, v241
v_mul_f32 v3, v240, v240
v_fma_f32 v3, v241, v241, v3
v_add_f32 v2, v2, v242
v_fma_f32 v3, v242, v242, v3
v_add_f32 v2, v2, v243
v_fma_f32 v3, v243, v243, v3
v_add_f32 v2, v2, v244
v_fma_f32 v3, v244, v244, v3
v_add_f32 v2, v2, v245
v_fma_f32 v3, v245, v245, v3
v_add_f32 v2, v2, v246
v_fma_f32 v3, v246, v246, v3
v_add_f32 v2, v2, v247
v_fma_f32 v3, v247, v247, v3
v_add_f32 v2, v2, v248
v_fma_f32 v3, v248, v248, v3
v_add_f32 v2, v2, v249
v_fma_f32 v3, v249, v249, v3
v_add_f32 v2, v2, v250
v_fma_f32 v3, v250, v250, v3
v_add_f32 v2, v2, v251
v_fma_f32 v3, v251, v251, v3
v_add_f32 v2, v2, v252
v_fma_f32 v3, v252, v252, v3
v_add_f32 v2, v2, v253
v_fma_f32 v3, v253, v253, v3
v_add_f32 v2, v2, v254
v_fma_f32 v3, v254, v254, v3
v_add_f32 v2, v2, v255
v_fma_f32 v3, v255, v255, v3
v_mov_b32 v8, v2
s_nop 1
v_permlane16_swap_b32 v2, v8
v_add_f32 v2, v2, v8
v_mov_b32 v8, v2
s_nop 1
v_permlane32_swap_b32 v2, v8
v_add_f32 v2, v2, v8
v_mov_b32 v8, v3
s_nop 1
v_permlane16_swap_b32 v3, v8
v_add_f32 v3, v3, v8
v_mov_b32 v8, v3
s_nop 1
v_permlane32_swap_b32 v3, v8
v_add_f32 v3, v3, v8
s_lshl_b32 s58, s76, 6
s_lshr_b32 s59, s75, 4
s_add_u32 s58, s58, s59
s_add_u32 s58, s58, 0x80000
v_lshlrev_b32 v8, 6, v0
s_mov_b64 exec, 0xffff
buffer_store_dwordx2 v[2:3], v8, s[24:27], s58 offen sc1
s_mov_b64 exec, -1
s_waitcnt vmcnt(0)
s_lshl_b32 s60, s49, 4
s_add_u32 s60, s60, s50
s_lshl_b32 s60, s60, 2
s_add_u32 s60, s60, s51
s_lshl_b32 s60, s60, 6
s_add_u32 s60, s60, 0x40000
v_mov_b32 v9, s48
s_mov_b64 exec, 1
buffer_store_dword v9, off, s[24:27], s60 sc1
s_mov_b64 exec, -1
ds_read_b64 v[16:17], v12 offset:768
ds_read_b64 v[18:19], v12 offset:800
ds_read_b64_tr_b16 v[32:33], v6 offset:0
ds_read_b64_tr_b16 v[34:35], v6 offset:3584
ds_read_b64_tr_b16 v[36:37], v6 offset:128
ds_read_b64_tr_b16 v[38:39], v6 offset:3712
ds_read_b64 v[20:21], v12 offset:832
ds_read_b64 v[22:23], v12 offset:864
ds_read_b64_tr_b16 v[40:41], v6 offset:7168
ds_read_b64_tr_b16 v[42:43], v6 offset:10752
ds_read_b64_tr_b16 v[44:45], v6 offset:7296
ds_read_b64_tr_b16 v[46:47], v6 offset:10880
ds_read_b64 v[24:25], v12 offset:896
ds_read_b64 v[26:27], v12 offset:928
ds_read_b64_tr_b16 v[48:49], v6 offset:14336
ds_read_b64_tr_b16 v[50:51], v6 offset:17920
ds_read_b64_tr_b16 v[52:53], v6 offset:14464
ds_read_b64_tr_b16 v[54:55], v6 offset:18048
ds_read_b64 v[28:29], v12 offset:960
ds_read_b64 v[30:31], v12 offset:992
ds_read_b64_tr_b16 v[56:57], v6 offset:21504
ds_read_b64_tr_b16 v[58:59], v6 offset:25088
ds_read_b64_tr_b16 v[60:61], v6 offset:21632
ds_read_b64_tr_b16 v[62:63], v6 offset:25216
v_mfma_f32_16x16x32_bf16 a[248:251], v[32:35], v[16:19], a[248:251]
v_mfma_f32_16x16x32_bf16 a[252:255], v[36:39], v[16:19], a[252:255]
s_waitcnt lgkmcnt(14)
v_mfma_f32_16x16x32_bf16 a[248:251], v[40:43], v[20:23], a[248:251]
s_waitcnt lgkmcnt(12)
v_mfma_f32_16x16x32_bf16 a[252:255], v[44:47], v[20:23], a[252:255]
s_waitcnt lgkmcnt(8)
v_mfma_f32_16x16x32_bf16 a[248:251], v[48:51], v[24:27], a[248:251]
s_waitcnt lgkmcnt(6)
v_mfma_f32_16x16x32_bf16 a[252:255], v[52:55], v[24:27], a[252:255]
s_waitcnt lgkmcnt(2)
v_mfma_f32_16x16x32_bf16 a[248:251], v[56:59], v[28:31], a[248:251]
s_waitcnt lgkmcnt(0)
v_mfma_f32_16x16x32_bf16 a[252:255], v[60:63], v[28:31], a[252:255]
v_lshrrev_b32 v3, 4, v0
v_lshlrev_b32 v12, 9, v13
v_lshl_add_u32 v12, v3, 4, v12
s_lshl_b32 s57, s51, 6
s_add_u32 s57, s57, 0x27800
v_add_u32 v12, s57, v12
s_mov_b32 s62, 0x00030003
s_mov_b32 s63, 0x00030003
s_mov_b64 exec, s[62:63]
ds_write_b128 v12, a[248:251] offset:0
ds_write_b128 v12, a[252:255] offset:256
s_mov_b64 exec, -1
s_waitcnt lgkmcnt(0)
s_barrier
v_lshlrev_b32 v12, 4, v3
v_add_u32 v12, 0x27800, v12
ds_read_b128 v[144:147], v12 offset:0
ds_read_b128 v[172:175], v12 offset:512
ds_read_b128 v[148:151], v12 offset:64
ds_read_b128 v[176:179], v12 offset:576
ds_read_b128 v[152:155], v12 offset:128
ds_read_b128 v[180:183], v12 offset:640
ds_read_b128 v[156:159], v12 offset:192
ds_read_b128 v[184:187], v12 offset:704
ds_read_b128 v[160:163], v12 offset:256
ds_read_b128 v[188:191], v12 offset:768
ds_read_b128 v[164:167], v12 offset:320
ds_read_b128 v[192:195], v12 offset:832
ds_read_b128 v[168:171], v12 offset:384
ds_read_b128 v[196:199], v12 offset:896
v_bfe_u32 v2, v0, 1, 3
v_lshlrev_b32 v2, 8, v2
v_lshl_add_u32 v2, v13, 6, v2
s_lshl_b32 s56, s49, 12
s_lshr_b32 s57, s51, 1
s_lshl_b32 s57, s57, 11
s_add_u32 s56, s56, s57
s_and_b32 s57, s51, 1
s_lshl_b32 s57, s57, 7
s_add_u32 s56, s56, s57
s_add_u32 s56, s56, 0x40000
v_add_u32 v2, s56, v2
s_lshl_b32 s56, s61, 11
s_add_u32 s56, s56, 0x80000
s_lshl_b32 s64, s61, 15
s_add_u32 s64, s64, 0x900000
s_add_u32 s65, s64, 0x1000
s_add_u32 s66, s64, 0x2000
s_add_u32 s67, s64, 0x3000
s_add_u32 s68, s64, 0x4000
s_add_u32 s69, s64, 0x5000
s_add_u32 s70, s64, 0x6000
s_add_u32 s71, s64, 0x7000
v_and_b32 v4, 15, v0
v_lshlrev_b32 v4, 6, v4
ds_read_b64_tr_b16 v[72:73], v227 offset:0
ds_read_b64_tr_b16 v[74:75], v227 offset:3584
ds_read_b64_tr_b16 v[76:77], v227 offset:32
ds_read_b64_tr_b16 v[78:79], v227 offset:3616
ds_read_b64_tr_b16 v[80:81], v227 offset:64
ds_read_b64_tr_b16 v[82:83], v227 offset:3648
ds_read_b64_tr_b16 v[84:85], v227 offset:96
ds_read_b64_tr_b16 v[86:87], v227 offset:3680
ds_read_b64_tr_b16 v[88:89], v227 offset:128
ds_read_b64_tr_b16 v[90:91], v227 offset:3712
ds_read_b64_tr_b16 v[92:93], v227 offset:160
ds_read_b64_tr_b16 v[94:95], v227 offset:3744
ds_read_b64_tr_b16 v[96:97], v227 offset:192
ds_read_b64_tr_b16 v[98:99], v227 offset:3776
s_nop 1
Lp_9:
buffer_load_dword v3, v2, s[24:27], 0 offen sc1
s_waitcnt vmcnt(0)
v_cmp_ne_u32 vcc, s48, v3
s_cbranch_vccz Ld_10
s_cmp_eq_u32 s52, 0
s_cbranch_scc1 Ld_10
s_sub_u32 s52, s52, 1
s_sleep 2
s_branch Lp_9
Ld_10:
s_nop 0
buffer_load_dwordx4 v[200:203], v4, s[24:27], s56 offen offset:0 sc1
buffer_load_dwordx4 v[204:207], v4, s[24:27], s56 offen offset:16 sc1
buffer_load_dwordx4 v[208:211], v4, s[24:27], s56 offen offset:32 sc1
buffer_load_dwordx4 v[212:215], v4, s[24:27], s56 offen offset:48 sc1
buffer_load_dwordx4 v[128:131], v4, s[24:27], s56 offen offset:1024 sc1
buffer_load_dwordx4 v[132:135], v4, s[24:27], s56 offen offset:1040 sc1
buffer_load_dwordx4 v[136:139], v4, s[24:27], s56 offen offset:1056 sc1
buffer_load_dwordx4 v[140:143], v4, s[24:27], s56 offen offset:1072 sc1
buffer_load_dwordx4 a[0:3], v1, s[24:27], s64 offen offset:0 sc1
buffer_load_dwordx4 a[4:7], v1, s[24:27], s68 offen offset:0 sc1
buffer_load_dwordx4 a[8:11], v1, s[24:27], s64 offen offset:1024 sc1
buffer_load_dwordx4 a[12:15], v1, s[24:27], s68 offen offset:1024 sc1
buffer_load_dwordx4 a[16:19], v1, s[24:27], s64 offen offset:2048 sc1
buffer_load_dwordx4 a[20:23], v1, s[24:27], s68 offen offset:2048 sc1
buffer_load_dwordx4 a[24:27], v1, s[24:27], s64 offen offset:3072 sc1
buffer_load_dwordx4 a[28:31], v1, s[24:27], s68 offen offset:3072 sc1
buffer_load_dwordx4 a[32:35], v1, s[24:27], s65 offen offset:0 sc1
buffer_load_dwordx4 a[36:39], v1, s[24:27], s69 offen offset:0 sc1
buffer_load_dwordx4 a[40:43], v1, s[24:27], s65 offen offset:1024 sc1
buffer_load_dwordx4 a[44:47], v1, s[24:27], s69 offen offset:1024 sc1
buffer_load_dwordx4 a[48:51], v1, s[24:27], s65 offen offset:2048 sc1
buffer_load_dwordx4 a[52:55], v1, s[24:27], s69 offen offset:2048 sc1
s_waitcnt vmcnt(21)
v_add_f32 v8, v200, v202
v_add_f32 v9, v201, v203
s_waitcnt vmcnt(20)
v_add_f32 v8, v8, v204
v_add_f32 v9, v9, v205
v_add_f32 v8, v8, v206
v_add_f32 v9, v9, v207
s_waitcnt vmcnt(19)
v_add_f32 v8, v8, v208
v_add_f32 v9, v9, v209
v_add_f32 v8, v8, v210
v_add_f32 v9, v9, v211
s_waitcnt vmcnt(18)
v_add_f32 v8, v8, v212
v_add_f32 v9, v9, v213
v_add_f32 v8, v8, v214
v_add_f32 v9, v9, v215
v_mul_f32 v8, 0x3b000000, v8
v_mul_f32 v9, 0x3b000000, v9
v_fma_f32 v9, -v8, v8, v9
v_max_f32 v9, 0, v9
v_add_f32 v9, 0x3727c5ac, v9
v_sqrt_f32 v9, v9
v_sub_f32 v8, 0, v8
v_pk_mul_f32 v[16:17], v[8:9], v[144:145] op_sel_hi:[0,1]
v_pk_mul_f32 v[18:19], v[8:9], v[146:147] op_sel_hi:[0,1]
v_pk_mul_f32 v[20:21], v[8:9], v[148:149] op_sel_hi:[0,1]
v_pk_mul_f32 v[22:23], v[8:9], v[150:151] op_sel_hi:[0,1]
v_pk_mul_f32 v[24:25], v[8:9], v[152:153] op_sel_hi:[0,1]
v_pk_mul_f32 v[26:27], v[8:9], v[154:155] op_sel_hi:[0,1]
v_pk_mul_f32 v[28:29], v[8:9], v[156:157] op_sel_hi:[0,1]
v_pk_mul_f32 v[30:31], v[8:9], v[158:159] op_sel_hi:[0,1]
v_pk_mul_f32 v[32:33], v[8:9], v[160:161] op_sel_hi:[0,1]
v_pk_mul_f32 v[34:35], v[8:9], v[162:163] op_sel_hi:[0,1]
v_pk_mul_f32 v[36:37], v[8:9], v[164:165] op_sel_hi:[0,1]
v_pk_mul_f32 v[38:39], v[8:9], v[166:167] op_sel_hi:[0,1]
v_pk_mul_f32 v[40:41], v[8:9], v[168:169] op_sel_hi:[0,1]
v_pk_mul_f32 v[42:43], v[8:9], v[170:171] op_sel_hi:[0,1]
v_pk_fma_f32 v[16:17], v[8:9], v[172:173], v[16:17] op_sel:[1,0,0] op_sel_hi:[1,1,1]
v_pk_fma_f32 v[18:19], v[8:9], v[174:175], v[18:19] op_sel:[1,0,0] op_sel_hi:[1,1,1]
v_pk_fma_f32 v[20:21], v[8:9], v[176:177], v[20:21] op_sel:[1,0,0] op_sel_hi:[1,1,1]
v_pk_fma_f32 v[22:23], v[8:9], v[178:179], v[22:23] op_sel:[1,0,0] op_sel_hi:[1,1,1]
v_pk_fma_f32 v[24:25], v[8:9], v[180:181], v[24:25] op_sel:[1,0,0] op_sel_hi:[1,1,1]
v_pk_fma_f32 v[26:27], v[8:9], v[182:183], v[26:27] op_sel:[1,0,0] op_sel_hi:[1,1,1]
v_pk_fma_f32 v[28:29], v[8:9], v[184:185], v[28:29] op_sel:[1,0,0] op_sel_hi:[1,1,1]
v_pk_fma_f32 v[30:31], v[8:9], v[186:187], v[30:31] op_sel:[1,0,0] op_sel_hi:[1,1,1]
v_pk_fma_f32 v[32:33], v[8:9], v[188:189], v[32:33] op_sel:[1,0,0] op_sel_hi:[1,1,1]
v_pk_fma_f32 v[34:35], v[8:9], v[190:191], v[34:35] op_sel:[1,0,0] op_sel_hi:[1,1,1]
v_pk_fma_f32 v[36:37], v[8:9], v[192:193], v[36:37] op_sel:[1,0,0] op_sel_hi:[1,1,1]
v_pk_fma_f32 v[38:39], v[8:9], v[194:195], v[38:39] op_sel:[1,0,0] op_sel_hi:[1,1,1]
s_waitcnt lgkmcnt(14)
v_pk_fma_f32 v[40:41], v[8:9], v[196:197], v[40:41] op_sel:[1,0,0] op_sel_hi:[1,1,1]
v_pk_fma_f32 v[42:43], v[8:9], v[198:199], v[42:43] op_sel:[1,0,0] op_sel_hi:[1,1,1]
s_waitcnt vmcnt(17)
v_add_f32 v10, v128, v130
v_add_f32 v11, v129, v131
s_waitcnt vmcnt(16)
v_add_f32 v10, v10, v132
v_add_f32 v11, v11, v133
v_add_f32 v10, v10, v134
v_add_f32 v11, v11, v135
s_waitcnt vmcnt(15)
v_add_f32 v10, v10, v136
v_add_f32 v11, v11, v137
v_add_f32 v10, v10, v138
v_add_f32 v11, v11, v139
s_waitcnt vmcnt(14)
v_add_f32 v10, v10, v140
v_add_f32 v11, v11, v141
v_add_f32 v10, v10, v142
v_add_f32 v11, v11, v143
v_mul_f32 v10, 0x3b000000, v10
v_mul_f32 v11, 0x3b000000, v11
v_fma_f32 v11, -v10, v10, v11
v_max_f32 v11, 0, v11
v_add_f32 v11, 0x3727c5ac, v11
v_sqrt_f32 v11, v11
v_sub_f32 v10, 0, v10
v_pk_mul_f32 v[44:45], v[10:11], v[144:145] op_sel_hi:[0,1]
v_pk_mul_f32 v[46:47], v[10:11], v[146:147] op_sel_hi:[0,1]
v_pk_mul_f32 v[48:49], v[10:11], v[148:149] op_sel_hi:[0,1]
v_pk_mul_f32 v[50:51], v[10:11], v[150:151] op_sel_hi:[0,1]
v_pk_mul_f32 v[52:53], v[10:11], v[152:153] op_sel_hi:[0,1]
v_pk_mul_f32 v[54:55], v[10:11], v[154:155] op_sel_hi:[0,1]
v_pk_mul_f32 v[56:57], v[10:11], v[156:157] op_sel_hi:[0,1]
v_pk_mul_f32 v[58:59], v[10:11], v[158:159] op_sel_hi:[0,1]
v_pk_mul_f32 v[60:61], v[10:11], v[160:161] op_sel_hi:[0,1]
v_pk_mul_f32 v[62:63], v[10:11], v[162:163] op_sel_hi:[0,1]
v_pk_mul_f32 v[64:65], v[10:11], v[164:165] op_sel_hi:[0,1]
v_pk_mul_f32 v[66:67], v[10:11], v[166:167] op_sel_hi:[0,1]
v_pk_mul_f32 v[68:69], v[10:11], v[168:169] op_sel_hi:[0,1]
v_pk_mul_f32 v[70:71], v[10:11], v[170:171] op_sel_hi:[0,1]
v_pk_fma_f32 v[44:45], v[10:11], v[172:173], v[44:45] op_sel:[1,0,0] op_sel_hi:[1,1,1]
v_pk_fma_f32 v[46:47], v[10:11], v[174:175], v[46:47] op_sel:[1,0,0] op_sel_hi:[1,1,1]
v_pk_fma_f32 v[48:49], v[10:11], v[176:177], v[48:49] op_sel:[1,0,0] op_sel_hi:[1,1,1]
v_pk_fma_f32 v[50:51], v[10:11], v[178:179], v[50:51] op_sel:[1,0,0] op_sel_hi:[1,1,1]
v_pk_fma_f32 v[52:53], v[10:11], v[180:181], v[52:53] op_sel:[1,0,0] op_sel_hi:[1,1,1]
v_pk_fma_f32 v[54:55], v[10:11], v[182:183], v[54:55] op_sel:[1,0,0] op_sel_hi:[1,1,1]
v_pk_fma_f32 v[56:57], v[10:11], v[184:185], v[56:57] op_sel:[1,0,0] op_sel_hi:[1,1,1]
v_pk_fma_f32 v[58:59], v[10:11], v[186:187], v[58:59] op_sel:[1,0,0] op_sel_hi:[1,1,1]
v_pk_fma_f32 v[60:61], v[10:11], v[188:189], v[60:61] op_sel:[1,0,0] op_sel_hi:[1,1,1]
v_pk_fma_f32 v[62:63], v[10:11], v[190:191], v[62:63] op_sel:[1,0,0] op_sel_hi:[1,1,1]
v_pk_fma_f32 v[64:65], v[10:11], v[192:193], v[64:65] op_sel:[1,0,0] op_sel_hi:[1,1,1]
v_pk_fma_f32 v[66:67], v[10:11], v[194:195], v[66:67] op_sel:[1,0,0] op_sel_hi:[1,1,1]
v_pk_fma_f32 v[68:69], v[10:11], v[196:197], v[68:69] op_sel:[1,0,0] op_sel_hi:[1,1,1]
v_pk_fma_f32 v[70:71], v[10:11], v[198:199], v[70:71] op_sel:[1,0,0] op_sel_hi:[1,1,1]
s_waitcnt vmcnt(13)
s_waitcnt lgkmcnt(12)
v_mfma_f32_16x16x32_bf16 v[16:19], v[72:75], a[0:3], v[16:19]
ds_read_b64_tr_b16 v[100:101], v227 offset:7168
ds_read_b64_tr_b16 v[102:103], v227 offset:10752
s_waitcnt vmcnt(12)
v_mfma_f32_16x16x32_bf16 v[44:47], v[72:75], a[4:7], v[44:47]
ds_read_b64_tr_b16 v[104:105], v227 offset:7200
s_waitcnt lgkmcnt(13)
v_mfma_f32_16x16x32_bf16 v[20:23], v[76:79], a[0:3], v[20:23]
ds_read_b64_tr_b16 v[106:107], v227 offset:10784
v_mfma_f32_16x16x32_bf16 v[48:51], v[76:79], a[4:7], v[48:51]
buffer_load_dwordx4 a[56:59], v1, s[24:27], s65 offen offset:3072 sc1
s_waitcnt lgkmcnt(12)
v_mfma_f32_16x16x32_bf16 v[24:27], v[80:83], a[0:3], v[24:27]
ds_read_b64_tr_b16 v[108:109], v227 offset:7232
v_mfma_f32_16x16x32_bf16 v[52:55], v[80:83], a[4:7], v[52:55]
ds_read_b64_tr_b16 v[110:111], v227 offset:10816
s_waitcnt lgkmcnt(12)
v_mfma_f32_16x16x32_bf16 v[28:31], v[84:87], a[0:3], v[28:31]
ds_read_b64_tr_b16 v[112:113], v227 offset:7264
v_mfma_f32_16x16x32_bf16 v[56:59], v[84:87], a[4:7], v[56:59]
ds_read_b64_tr_b16 v[114:115], v227 offset:10848
ds_read_b64_tr_b16 v[116:117], v227 offset:7296
s_waitcnt lgkmcnt(13)
v_mfma_f32_16x16x32_bf16 v[32:35], v[88:91], a[0:3], v[32:35]
ds_read_b64_tr_b16 v[118:119], v227 offset:10880
v_mfma_f32_16x16x32_bf16 v[60:63], v[88:91], a[4:7], v[60:63]
buffer_load_dwordx4 a[60:63], v1, s[24:27], s69 offen offset:3072 sc1
s_waitcnt lgkmcnt(12)
v_mfma_f32_16x16x32_bf16 v[36:39], v[92:95], a[0:3], v[36:39]
ds_read_b64_tr_b16 v[120:121], v227 offset:7328
v_mfma_f32_16x16x32_bf16 v[64:67], v[92:95], a[4:7], v[64:67]
ds_read_b64_tr_b16 v[122:123], v227 offset:10912
s_waitcnt lgkmcnt(12)
v_mfma_f32_16x16x32_bf16 v[40:43], v[96:99], a[0:3], v[40:43]
ds_read_b64_tr_b16 v[124:125], v227 offset:7360
v_mfma_f32_16x16x32_bf16 v[68:71], v[96:99], a[4:7], v[68:71]
ds_read_b64_tr_b16 v[126:127], v227 offset:10944
s_waitcnt vmcnt(13)
s_waitcnt lgkmcnt(12)
v_mfma_f32_16x16x32_bf16 v[16:19], v[100:103], a[8:11], v[16:19]
ds_read_b64_tr_b16 v[72:73], v227 offset:14336
ds_read_b64_tr_b16 v[74:75], v227 offset:17920
s_waitcnt vmcnt(12)
v_mfma_f32_16x16x32_bf16 v[44:47], v[100:103], a[12:15], v[44:47]
ds_read_b64_tr_b16 v[76:77], v227 offset:14368
s_waitcnt lgkmcnt(13)
v_mfma_f32_16x16x32_bf16 v[20:23], v[104:107], a[8:11], v[20:23]
ds_read_b64_tr_b16 v[78:79], v227 offset:17952
v_mfma_f32_16x16x32_bf16 v[48:51], v[104:107], a[12:15], v[48:51]
buffer_load_dwordx4 a[64:67], v1, s[24:27], s66 offen offset:0 sc1
s_waitcnt lgkmcnt(12)
v_mfma_f32_16x16x32_bf16 v[24:27], v[108:111], a[8:11], v[24:27]
ds_read_b64_tr_b16 v[80:81], v227 offset:14400
v_mfma_f32_16x16x32_bf16 v[52:55], v[108:111], a[12:15], v[52:55]
ds_read_b64_tr_b16 v[82:83], v227 offset:17984
s_waitcnt lgkmcnt(12)
v_mfma_f32_16x16x32_bf16 v[28:31], v[112:115], a[8:11], v[28:31]
ds_read_b64_tr_b16 v[84:85], v227 offset:14432
v_mfma_f32_16x16x32_bf16 v[56:59], v[112:115], a[12:15], v[56:59]
ds_read_b64_tr_b16 v[86:87], v227 offset:18016
ds_read_b64_tr_b16 v[88:89], v227 offset:14464
s_waitcnt lgkmcnt(13)
v_mfma_f32_16x16x32_bf16 v[32:35], v[116:119], a[8:11], v[32:35]
ds_read_b64_tr_b16 v[90:91], v227 offset:18048
v_mfma_f32_16x16x32_bf16 v[60:63], v[116:119], a[12:15], v[60:63]
buffer_load_dwordx4 a[68:71], v1, s[24:27], s70 offen offset:0 sc1
s_waitcnt lgkmcnt(12)
v_mfma_f32_16x16x32_bf16 v[36:39], v[120:123], a[8:11], v[36:39]
ds_read_b64_tr_b16 v[92:93], v227 offset:14496
v_mfma_f32_16x16x32_bf16 v[64:67], v[120:123], a[12:15], v[64:67]
ds_read_b64_tr_b16 v[94:95], v227 offset:18080
s_waitcnt lgkmcnt(12)
v_mfma_f32_16x16x32_bf16 v[40:43], v[124:127], a[8:11], v[40:43]
ds_read_b64_tr_b16 v[96:97], v227 offset:14528
v_mfma_f32_16x16x32_bf16 v[68:71], v[124:127], a[12:15], v[68:71]
ds_read_b64_tr_b16 v[98:99], v227 offset:18112
s_waitcnt vmcnt(13)
s_waitcnt lgkmcnt(12)
v_mfma_f32_16x16x32_bf16 v[16:19], v[72:75], a[16:19], v[16:19]
ds_read_b64_tr_b16 v[100:101], v227 offset:21504
ds_read_b64_tr_b16 v[102:103], v227 offset:25088
s_waitcnt vmcnt(12)
v_mfma_f32_16x16x32_bf16 v[44:47], v[72:75], a[20:23], v[44:47]
ds_read_b64_tr_b16 v[104:105], v227 offset:21536
s_waitcnt lgkmcnt(13)
v_mfma_f32_16x16x32_bf16 v[20:23], v[76:79], a[16:19], v[20:23]
ds_read_b64_tr_b16 v[106:107], v227 offset:25120
v_mfma_f32_16x16x32_bf16 v[48:51], v[76:79], a[20:23], v[48:51]
buffer_load_dwordx4 a[72:75], v1, s[24:27], s66 offen offset:1024 sc1
s_waitcnt lgkmcnt(12)
v_mfma_f32_16x16x32_bf16 v[24:27], v[80:83], a[16:19], v[24:27]
ds_read_b64_tr_b16 v[108:109], v227 offset:21568
v_mfma_f32_16x16x32_bf16 v[52:55], v[80:83], a[20:23], v[52:55]
ds_read_b64_tr_b16 v[110:111], v227 offset:25152
s_waitcnt lgkmcnt(12)
v_mfma_f32_16x16x32_bf16 v[28:31], v[84:87], a[16:19], v[28:31]
ds_read_b64_tr_b16 v[112:113], v227 offset:21600
v_mfma_f32_16x16x32_bf16 v[56:59], v[84:87], a[20:23], v[56:59]
ds_read_b64_tr_b16 v[114:115], v227 offset:25184
ds_read_b64_tr_b16 v[116:117], v227 offset:21632
s_waitcnt lgkmcnt(13)
v_mfma_f32_16x16x32_bf16 v[32:35], v[88:91], a[16:19], v[32:35]
ds_read_b64_tr_b16 v[118:119], v227 offset:25216
v_mfma_f32_16x16x32_bf16 v[60:63], v[88:91], a[20:23], v[60:63]
buffer_load_dwordx4 a[76:79], v1, s[24:27], s70 offen offset:1024 sc1
s_waitcnt lgkmcnt(12)
v_mfma_f32_16x16x32_bf16 v[36:39], v[92:95], a[16:19], v[36:39]
ds_read_b64_tr_b16 v[120:121], v227 offset:21664
v_mfma_f32_16x16x32_bf16 v[64:67], v[92:95], a[20:23], v[64:67]
ds_read_b64_tr_b16 v[122:123], v227 offset:25248
s_waitcnt lgkmcnt(12)
v_mfma_f32_16x16x32_bf16 v[40:43], v[96:99], a[16:19], v[40:43]
ds_read_b64_tr_b16 v[124:125], v227 offset:21696
v_mfma_f32_16x16x32_bf16 v[68:71], v[96:99], a[20:23], v[68:71]
ds_read_b64_tr_b16 v[126:127], v227 offset:25280
s_waitcnt vmcnt(13)
s_waitcnt lgkmcnt(12)
v_mfma_f32_16x16x32_bf16 v[16:19], v[100:103], a[24:27], v[16:19]
ds_read_b64_tr_b16 v[72:73], v227 offset:28672
ds_read_b64_tr_b16 v[74:75], v227 offset:32256
s_waitcnt vmcnt(12)
v_mfma_f32_16x16x32_bf16 v[44:47], v[100:103], a[28:31], v[44:47]
ds_read_b64_tr_b16 v[76:77], v227 offset:28704
s_waitcnt lgkmcnt(13)
v_mfma_f32_16x16x32_bf16 v[20:23], v[104:107], a[24:27], v[20:23]
ds_read_b64_tr_b16 v[78:79], v227 offset:32288
v_mfma_f32_16x16x32_bf16 v[48:51], v[104:107], a[28:31], v[48:51]
buffer_load_dwordx4 a[80:83], v1, s[24:27], s66 offen offset:2048 sc1
s_waitcnt lgkmcnt(12)
v_mfma_f32_16x16x32_bf16 v[24:27], v[108:111], a[24:27], v[24:27]
ds_read_b64_tr_b16 v[80:81], v227 offset:28736
v_mfma_f32_16x16x32_bf16 v[52:55], v[108:111], a[28:31], v[52:55]
ds_read_b64_tr_b16 v[82:83], v227 offset:32320
s_waitcnt lgkmcnt(12)
v_mfma_f32_16x16x32_bf16 v[28:31], v[112:115], a[24:27], v[28:31]
ds_read_b64_tr_b16 v[84:85], v227 offset:28768
v_mfma_f32_16x16x32_bf16 v[56:59], v[112:115], a[28:31], v[56:59]
ds_read_b64_tr_b16 v[86:87], v227 offset:32352
ds_read_b64_tr_b16 v[88:89], v227 offset:28800
s_waitcnt lgkmcnt(13)
v_mfma_f32_16x16x32_bf16 v[32:35], v[116:119], a[24:27], v[32:35]
ds_read_b64_tr_b16 v[90:91], v227 offset:32384
v_mfma_f32_16x16x32_bf16 v[60:63], v[116:119], a[28:31], v[60:63]
buffer_load_dwordx4 a[84:87], v1, s[24:27], s70 offen offset:2048 sc1
s_waitcnt lgkmcnt(12)
v_mfma_f32_16x16x32_bf16 v[36:39], v[120:123], a[24:27], v[36:39]
ds_read_b64_tr_b16 v[92:93], v227 offset:28832
v_mfma_f32_16x16x32_bf16 v[64:67], v[120:123], a[28:31], v[64:67]
ds_read_b64_tr_b16 v[94:95], v227 offset:32416
s_waitcnt lgkmcnt(12)
v_mfma_f32_16x16x32_bf16 v[40:43], v[124:127], a[24:27], v[40:43]
ds_read_b64_tr_b16 v[96:97], v227 offset:28864
v_mfma_f32_16x16x32_bf16 v[68:71], v[124:127], a[28:31], v[68:71]
ds_read_b64_tr_b16 v[98:99], v227 offset:32448
s_waitcnt vmcnt(13)
s_waitcnt lgkmcnt(12)
v_mfma_f32_16x16x32_bf16 v[16:19], v[72:75], a[32:35], v[16:19]
ds_read_b64_tr_b16 v[100:101], v227 offset:35840
ds_read_b64_tr_b16 v[102:103], v227 offset:39424
s_waitcnt vmcnt(12)
v_mfma_f32_16x16x32_bf16 v[44:47], v[72:75], a[36:39], v[44:47]
ds_read_b64_tr_b16 v[104:105], v227 offset:35872
s_waitcnt lgkmcnt(13)
v_mfma_f32_16x16x32_bf16 v[20:23], v[76:79], a[32:35], v[20:23]
ds_read_b64_tr_b16 v[106:107], v227 offset:39456
v_mfma_f32_16x16x32_bf16 v[48:51], v[76:79], a[36:39], v[48:51]
buffer_load_dwordx4 a[88:91], v1, s[24:27], s66 offen offset:3072 sc1
s_waitcnt lgkmcnt(12)
v_mfma_f32_16x16x32_bf16 v[24:27], v[80:83], a[32:35], v[24:27]
ds_read_b64_tr_b16 v[108:109], v227 offset:35904
v_mfma_f32_16x16x32_bf16 v[52:55], v[80:83], a[36:39], v[52:55]
ds_read_b64_tr_b16 v[110:111], v227 offset:39488
s_waitcnt lgkmcnt(12)
v_mfma_f32_16x16x32_bf16 v[28:31], v[84:87], a[32:35], v[28:31]
ds_read_b64_tr_b16 v[112:113], v227 offset:35936
v_mfma_f32_16x16x32_bf16 v[56:59], v[84:87], a[36:39], v[56:59]
ds_read_b64_tr_b16 v[114:115], v227 offset:39520
ds_read_b64_tr_b16 v[116:117], v227 offset:35968
s_waitcnt lgkmcnt(13)
v_mfma_f32_16x16x32_bf16 v[32:35], v[88:91], a[32:35], v[32:35]
ds_read_b64_tr_b16 v[118:119], v227 offset:39552
v_mfma_f32_16x16x32_bf16 v[60:63], v[88:91], a[36:39], v[60:63]
buffer_load_dwordx4 a[92:95], v1, s[24:27], s70 offen offset:3072 sc1
s_waitcnt lgkmcnt(12)
v_mfma_f32_16x16x32_bf16 v[36:39], v[92:95], a[32:35], v[36:39]
ds_read_b64_tr_b16 v[120:121], v227 offset:36000
v_mfma_f32_16x16x32_bf16 v[64:67], v[92:95], a[36:39], v[64:67]
ds_read_b64_tr_b16 v[122:123], v227 offset:39584
s_waitcnt lgkmcnt(12)
v_mfma_f32_16x16x32_bf16 v[40:43], v[96:99], a[32:35], v[40:43]
ds_read_b64_tr_b16 v[124:125], v227 offset:36032
v_mfma_f32_16x16x32_bf16 v[68:71], v[96:99], a[36:39], v[68:71]
ds_read_b64_tr_b16 v[126:127], v227 offset:39616
s_waitcnt vmcnt(13)
s_waitcnt lgkmcnt(12)
v_mfma_f32_16x16x32_bf16 v[16:19], v[100:103], a[40:43], v[16:19]
ds_read_b64_tr_b16 v[72:73], v228 offset:0
ds_read_b64_tr_b16 v[74:75], v228 offset:3584
s_waitcnt vmcnt(12)
v_mfma_f32_16x16x32_bf16 v[44:47], v[100:103], a[44:47], v[44:47]
ds_read_b64_tr_b16 v[76:77], v228 offset:32
s_waitcnt lgkmcnt(13)
v_mfma_f32_16x16x32_bf16 v[20:23], v[104:107], a[40:43], v[20:23]
ds_read_b64_tr_b16 v[78:79], v228 offset:3616
v_mfma_f32_16x16x32_bf16 v[48:51], v[104:107], a[44:47], v[48:51]
buffer_load_dwordx4 a[96:99], v1, s[24:27], s67 offen offset:0 sc1
s_waitcnt lgkmcnt(12)
v_mfma_f32_16x16x32_bf16 v[24:27], v[108:111], a[40:43], v[24:27]
ds_read_b64_tr_b16 v[80:81], v228 offset:64
v_mfma_f32_16x16x32_bf16 v[52:55], v[108:111], a[44:47], v[52:55]
ds_read_b64_tr_b16 v[82:83], v228 offset:3648
s_waitcnt lgkmcnt(12)
v_mfma_f32_16x16x32_bf16 v[28:31], v[112:115], a[40:43], v[28:31]
ds_read_b64_tr_b16 v[84:85], v228 offset:96
v_mfma_f32_16x16x32_bf16 v[56:59], v[112:115], a[44:47], v[56:59]
ds_read_b64_tr_b16 v[86:87], v228 offset:3680
ds_read_b64_tr_b16 v[88:89], v228 offset:128
s_waitcnt lgkmcnt(13)
v_mfma_f32_16x16x32_bf16 v[32:35], v[116:119], a[40:43], v[32:35]
ds_read_b64_tr_b16 v[90:91], v228 offset:3712
v_mfma_f32_16x16x32_bf16 v[60:63], v[116:119], a[44:47], v[60:63]
buffer_load_dwordx4 a[100:103], v1, s[24:27], s71 offen offset:0 sc1
s_waitcnt lgkmcnt(12)
v_mfma_f32_16x16x32_bf16 v[36:39], v[120:123], a[40:43], v[36:39]
ds_read_b64_tr_b16 v[92:93], v228 offset:160
v_mfma_f32_16x16x32_bf16 v[64:67], v[120:123], a[44:47], v[64:67]
ds_read_b64_tr_b16 v[94:95], v228 offset:3744
s_waitcnt lgkmcnt(12)
v_mfma_f32_16x16x32_bf16 v[40:43], v[124:127], a[40:43], v[40:43]
ds_read_b64_tr_b16 v[96:97], v228 offset:192
v_mfma_f32_16x16x32_bf16 v[68:71], v[124:127], a[44:47], v[68:71]
ds_read_b64_tr_b16 v[98:99], v228 offset:3776
s_waitcnt vmcnt(13)
s_waitcnt lgkmcnt(12)
v_mfma_f32_16x16x32_bf16 v[16:19], v[72:75], a[48:51], v[16:19]
ds_read_b64_tr_b16 v[100:101], v228 offset:7168
ds_read_b64_tr_b16 v[102:103], v228 offset:10752
s_waitcnt vmcnt(12)
v_mfma_f32_16x16x32_bf16 v[44:47], v[72:75], a[52:55], v[44:47]
ds_read_b64_tr_b16 v[104:105], v228 offset:7200
s_waitcnt lgkmcnt(13)
v_mfma_f32_16x16x32_bf16 v[20:23], v[76:79], a[48:51], v[20:23]
ds_read_b64_tr_b16 v[106:107], v228 offset:10784
v_mfma_f32_16x16x32_bf16 v[48:51], v[76:79], a[52:55], v[48:51]
buffer_load_dwordx4 a[104:107], v1, s[24:27], s67 offen offset:1024 sc1
s_waitcnt lgkmcnt(12)
v_mfma_f32_16x16x32_bf16 v[24:27], v[80:83], a[48:51], v[24:27]
ds_read_b64_tr_b16 v[108:109], v228 offset:7232
v_mfma_f32_16x16x32_bf16 v[52:55], v[80:83], a[52:55], v[52:55]
ds_read_b64_tr_b16 v[110:111], v228 offset:10816
s_waitcnt lgkmcnt(12)
v_mfma_f32_16x16x32_bf16 v[28:31], v[84:87], a[48:51], v[28:31]
ds_read_b64_tr_b16 v[112:113], v228 offset:7264
v_mfma_f32_16x16x32_bf16 v[56:59], v[84:87], a[52:55], v[56:59]
ds_read_b64_tr_b16 v[114:115], v228 offset:10848
ds_read_b64_tr_b16 v[116:117], v228 offset:7296
s_waitcnt lgkmcnt(13)
v_mfma_f32_16x16x32_bf16 v[32:35], v[88:91], a[48:51], v[32:35]
ds_read_b64_tr_b16 v[118:119], v228 offset:10880
v_mfma_f32_16x16x32_bf16 v[60:63], v[88:91], a[52:55], v[60:63]
buffer_load_dwordx4 a[108:111], v1, s[24:27], s71 offen offset:1024 sc1
s_waitcnt lgkmcnt(12)
v_mfma_f32_16x16x32_bf16 v[36:39], v[92:95], a[48:51], v[36:39]
ds_read_b64_tr_b16 v[120:121], v228 offset:7328
v_mfma_f32_16x16x32_bf16 v[64:67], v[92:95], a[52:55], v[64:67]
ds_read_b64_tr_b16 v[122:123], v228 offset:10912
s_waitcnt lgkmcnt(12)
v_mfma_f32_16x16x32_bf16 v[40:43], v[96:99], a[48:51], v[40:43]
ds_read_b64_tr_b16 v[124:125], v228 offset:7360
v_mfma_f32_16x16x32_bf16 v[68:71], v[96:99], a[52:55], v[68:71]
ds_read_b64_tr_b16 v[126:127], v228 offset:10944
s_waitcnt vmcnt(13)
s_waitcnt lgkmcnt(12)
v_mfma_f32_16x16x32_bf16 v[16:19], v[100:103], a[56:59], v[16:19]
ds_read_b64_tr_b16 v[72:73], v228 offset:14336
ds_read_b64_tr_b16 v[74:75], v228 offset:17920
s_waitcnt vmcnt(12)
v_mfma_f32_16x16x32_bf16 v[44:47], v[100:103], a[60:63], v[44:47]
ds_read_b64_tr_b16 v[76:77], v228 offset:14368
s_waitcnt lgkmcnt(13)
v_mfma_f32_16x16x32_bf16 v[20:23], v[104:107], a[56:59], v[20:23]
ds_read_b64_tr_b16 v[78:79], v228 offset:17952
v_mfma_f32_16x16x32_bf16 v[48:51], v[104:107], a[60:63], v[48:51]
buffer_load_dwordx4 a[112:115], v1, s[24:27], s67 offen offset:2048 sc1
s_waitcnt lgkmcnt(12)
v_mfma_f32_16x16x32_bf16 v[24:27], v[108:111], a[56:59], v[24:27]
ds_read_b64_tr_b16 v[80:81], v228 offset:14400
v_mfma_f32_16x16x32_bf16 v[52:55], v[108:111], a[60:63], v[52:55]
ds_read_b64_tr_b16 v[82:83], v228 offset:17984
s_waitcnt lgkmcnt(12)
v_mfma_f32_16x16x32_bf16 v[28:31], v[112:115], a[56:59], v[28:31]
ds_read_b64_tr_b16 v[84:85], v228 offset:14432
v_mfma_f32_16x16x32_bf16 v[56:59], v[112:115], a[60:63], v[56:59]
ds_read_b64_tr_b16 v[86:87], v228 offset:18016
ds_read_b64_tr_b16 v[88:89], v228 offset:14464
s_waitcnt lgkmcnt(13)
v_mfma_f32_16x16x32_bf16 v[32:35], v[116:119], a[56:59], v[32:35]
ds_read_b64_tr_b16 v[90:91], v228 offset:18048
v_mfma_f32_16x16x32_bf16 v[60:63], v[116:119], a[60:63], v[60:63]
buffer_load_dwordx4 a[116:119], v1, s[24:27], s71 offen offset:2048 sc1
s_waitcnt lgkmcnt(12)
v_mfma_f32_16x16x32_bf16 v[36:39], v[120:123], a[56:59], v[36:39]
ds_read_b64_tr_b16 v[92:93], v228 offset:14496
v_mfma_f32_16x16x32_bf16 v[64:67], v[120:123], a[60:63], v[64:67]
ds_read_b64_tr_b16 v[94:95], v228 offset:18080
s_waitcnt lgkmcnt(12)
v_mfma_f32_16x16x32_bf16 v[40:43], v[124:127], a[56:59], v[40:43]
ds_read_b64_tr_b16 v[96:97], v228 offset:14528
v_mfma_f32_16x16x32_bf16 v[68:71], v[124:127], a[60:63], v[68:71]
ds_read_b64_tr_b16 v[98:99], v228 offset:18112
s_waitcnt vmcnt(13)
s_waitcnt lgkmcnt(12)
v_mfma_f32_16x16x32_bf16 v[16:19], v[72:75], a[64:67], v[16:19]
ds_read_b64_tr_b16 v[100:101], v228 offset:21504
ds_read_b64_tr_b16 v[102:103], v228 offset:25088
s_waitcnt vmcnt(12)
v_mfma_f32_16x16x32_bf16 v[44:47], v[72:75], a[68:71], v[44:47]
ds_read_b64_tr_b16 v[104:105], v228 offset:21536
s_waitcnt lgkmcnt(13)
v_mfma_f32_16x16x32_bf16 v[20:23], v[76:79], a[64:67], v[20:23]
ds_read_b64_tr_b16 v[106:107], v228 offset:25120
v_mfma_f32_16x16x32_bf16 v[48:51], v[76:79], a[68:71], v[48:51]
buffer_load_dwordx4 a[120:123], v1, s[24:27], s67 offen offset:3072 sc1
s_waitcnt lgkmcnt(12)
v_mfma_f32_16x16x32_bf16 v[24:27], v[80:83], a[64:67], v[24:27]
ds_read_b64_tr_b16 v[108:109], v228 offset:21568
v_mfma_f32_16x16x32_bf16 v[52:55], v[80:83], a[68:71], v[52:55]
ds_read_b64_tr_b16 v[110:111], v228 offset:25152
s_waitcnt lgkmcnt(12)
v_mfma_f32_16x16x32_bf16 v[28:31], v[84:87], a[64:67], v[28:31]
ds_read_b64_tr_b16 v[112:113], v228 offset:21600
v_mfma_f32_16x16x32_bf16 v[56:59], v[84:87], a[68:71], v[56:59]
ds_read_b64_tr_b16 v[114:115], v228 offset:25184
ds_read_b64_tr_b16 v[116:117], v228 offset:21632
s_waitcnt lgkmcnt(13)
v_mfma_f32_16x16x32_bf16 v[32:35], v[88:91], a[64:67], v[32:35]
ds_read_b64_tr_b16 v[118:119], v228 offset:25216
v_mfma_f32_16x16x32_bf16 v[60:63], v[88:91], a[68:71], v[60:63]
buffer_load_dwordx4 a[124:127], v1, s[24:27], s71 offen offset:3072 sc1
s_waitcnt lgkmcnt(12)
v_mfma_f32_16x16x32_bf16 v[36:39], v[92:95], a[64:67], v[36:39]
ds_read_b64_tr_b16 v[120:121], v228 offset:21664
v_mfma_f32_16x16x32_bf16 v[64:67], v[92:95], a[68:71], v[64:67]
ds_read_b64_tr_b16 v[122:123], v228 offset:25248
s_waitcnt lgkmcnt(12)
v_mfma_f32_16x16x32_bf16 v[40:43], v[96:99], a[64:67], v[40:43]
ds_read_b64_tr_b16 v[124:125], v228 offset:21696
v_mfma_f32_16x16x32_bf16 v[68:71], v[96:99], a[68:71], v[68:71]
ds_read_b64_tr_b16 v[126:127], v228 offset:25280
s_waitcnt vmcnt(13)
s_waitcnt lgkmcnt(12)
v_mfma_f32_16x16x32_bf16 v[16:19], v[100:103], a[72:75], v[16:19]
ds_read_b64_tr_b16 v[72:73], v228 offset:28672
s_waitcnt vmcnt(12)
v_mfma_f32_16x16x32_bf16 v[44:47], v[100:103], a[76:79], v[44:47]
ds_read_b64_tr_b16 v[74:75], v228 offset:32256
s_waitcnt lgkmcnt(12)
v_mfma_f32_16x16x32_bf16 v[20:23], v[104:107], a[72:75], v[20:23]
ds_read_b64_tr_b16 v[76:77], v228 offset:28704
v_mfma_f32_16x16x32_bf16 v[48:51], v[104:107], a[76:79], v[48:51]
ds_read_b64_tr_b16 v[78:79], v228 offset:32288
s_waitcnt lgkmcnt(12)
v_mfma_f32_16x16x32_bf16 v[24:27], v[108:111], a[72:75], v[24:27]
ds_read_b64_tr_b16 v[80:81], v228 offset:28736
v_mfma_f32_16x16x32_bf16 v[52:55], v[108:111], a[76:79], v[52:55]
ds_read_b64_tr_b16 v[82:83], v228 offset:32320
s_waitcnt lgkmcnt(12)
v_mfma_f32_16x16x32_bf16 v[28:31], v[112:115], a[72:75], v[28:31]
ds_read_b64_tr_b16 v[84:85], v228 offset:28768
v_mfma_f32_16x16x32_bf16 v[56:59], v[112:115], a[76:79], v[56:59]
ds_read_b64_tr_b16 v[86:87], v228 offset:32352
s_waitcnt lgkmcnt(12)
v_mfma_f32_16x16x32_bf16 v[32:35], v[116:119], a[72:75], v[32:35]
ds_read_b64_tr_b16 v[88:89], v228 offset:28800
v_mfma_f32_16x16x32_bf16 v[60:63], v[116:119], a[76:79], v[60:63]
ds_read_b64_tr_b16 v[90:91], v228 offset:32384
s_waitcnt lgkmcnt(12)
v_mfma_f32_16x16x32_bf16 v[36:39], v[120:123], a[72:75], v[36:39]
ds_read_b64_tr_b16 v[92:93], v228 offset:28832
v_mfma_f32_16x16x32_bf16 v[64:67], v[120:123], a[76:79], v[64:67]
ds_read_b64_tr_b16 v[94:95], v228 offset:32416
s_waitcnt lgkmcnt(12)
v_mfma_f32_16x16x32_bf16 v[40:43], v[124:127], a[72:75], v[40:43]
ds_read_b64_tr_b16 v[96:97], v228 offset:28864
v_mfma_f32_16x16x32_bf16 v[68:71], v[124:127], a[76:79], v[68:71]
ds_read_b64_tr_b16 v[98:99], v228 offset:32448
s_waitcnt vmcnt(11)
s_waitcnt lgkmcnt(12)
v_mfma_f32_16x16x32_bf16 v[16:19], v[72:75], a[80:83], v[16:19]
ds_read_b64_tr_b16 v[100:101], v228 offset:35840
s_waitcnt vmcnt(10)
v_mfma_f32_16x16x32_bf16 v[44:47], v[72:75], a[84:87], v[44:47]
ds_read_b64_tr_b16 v[102:103], v228 offset:39424
s_waitcnt lgkmcnt(12)
v_mfma_f32_16x16x32_bf16 v[20:23], v[76:79], a[80:83], v[20:23]
ds_read_b64_tr_b16 v[104:105], v228 offset:35872
v_mfma_f32_16x16x32_bf16 v[48:51], v[76:79], a[84:87], v[48:51]
ds_read_b64_tr_b16 v[106:107], v228 offset:39456
s_waitcnt lgkmcnt(12)
v_mfma_f32_16x16x32_bf16 v[24:27], v[80:83], a[80:83], v[24:27]
ds_read_b64_tr_b16 v[108:109], v228 offset:35904
v_mfma_f32_16x16x32_bf16 v[52:55], v[80:83], a[84:87], v[52:55]
ds_read_b64_tr_b16 v[110:111], v228 offset:39488
s_waitcnt lgkmcnt(12)
v_mfma_f32_16x16x32_bf16 v[28:31], v[84:87], a[80:83], v[28:31]
ds_read_b64_tr_b16 v[112:113], v228 offset:35936
v_mfma_f32_16x16x32_bf16 v[56:59], v[84:87], a[84:87], v[56:59]
ds_read_b64_tr_b16 v[114:115], v228 offset:39520
s_waitcnt lgkmcnt(12)
v_mfma_f32_16x16x32_bf16 v[32:35], v[88:91], a[80:83], v[32:35]
ds_read_b64_tr_b16 v[116:117], v228 offset:35968
v_mfma_f32_16x16x32_bf16 v[60:63], v[88:91], a[84:87], v[60:63]
ds_read_b64_tr_b16 v[118:119], v228 offset:39552
s_waitcnt lgkmcnt(12)
v_mfma_f32_16x16x32_bf16 v[36:39], v[92:95], a[80:83], v[36:39]
ds_read_b64_tr_b16 v[120:121], v228 offset:36000
v_mfma_f32_16x16x32_bf16 v[64:67], v[92:95], a[84:87], v[64:67]
ds_read_b64_tr_b16 v[122:123], v228 offset:39584
s_waitcnt lgkmcnt(12)
v_mfma_f32_16x16x32_bf16 v[40:43], v[96:99], a[80:83], v[40:43]
ds_read_b64_tr_b16 v[124:125], v228 offset:36032
v_mfma_f32_16x16x32_bf16 v[68:71], v[96:99], a[84:87], v[68:71]
ds_read_b64_tr_b16 v[126:127], v228 offset:39616
s_waitcnt vmcnt(9)
s_waitcnt lgkmcnt(12)
v_mfma_f32_16x16x32_bf16 v[16:19], v[100:103], a[88:91], v[16:19]
ds_read_b64_tr_b16 v[72:73], v229 offset:0
s_waitcnt vmcnt(8)
v_mfma_f32_16x16x32_bf16 v[44:47], v[100:103], a[92:95], v[44:47]
ds_read_b64_tr_b16 v[74:75], v229 offset:3584
s_waitcnt lgkmcnt(12)
v_mfma_f32_16x16x32_bf16 v[20:23], v[104:107], a[88:91], v[20:23]
ds_read_b64_tr_b16 v[76:77], v229 offset:32
v_mfma_f32_16x16x32_bf16 v[48:51], v[104:107], a[92:95], v[48:51]
ds_read_b64_tr_b16 v[78:79], v229 offset:3616
s_waitcnt lgkmcnt(12)
v_mfma_f32_16x16x32_bf16 v[24:27], v[108:111], a[88:91], v[24:27]
ds_read_b64_tr_b16 v[80:81], v229 offset:64
v_mfma_f32_16x16x32_bf16 v[52:55], v[108:111], a[92:95], v[52:55]
ds_read_b64_tr_b16 v[82:83], v229 offset:3648
s_waitcnt lgkmcnt(12)
v_mfma_f32_16x16x32_bf16 v[28:31], v[112:115], a[88:91], v[28:31]
ds_read_b64_tr_b16 v[84:85], v229 offset:96
v_mfma_f32_16x16x32_bf16 v[56:59], v[112:115], a[92:95], v[56:59]
ds_read_b64_tr_b16 v[86:87], v229 offset:3680
s_waitcnt lgkmcnt(12)
v_mfma_f32_16x16x32_bf16 v[32:35], v[116:119], a[88:91], v[32:35]
ds_read_b64_tr_b16 v[88:89], v229 offset:128
v_mfma_f32_16x16x32_bf16 v[60:63], v[116:119], a[92:95], v[60:63]
ds_read_b64_tr_b16 v[90:91], v229 offset:3712
s_waitcnt lgkmcnt(12)
v_mfma_f32_16x16x32_bf16 v[36:39], v[120:123], a[88:91], v[36:39]
ds_read_b64_tr_b16 v[92:93], v229 offset:160
v_mfma_f32_16x16x32_bf16 v[64:67], v[120:123], a[92:95], v[64:67]
ds_read_b64_tr_b16 v[94:95], v229 offset:3744
s_waitcnt lgkmcnt(12)
v_mfma_f32_16x16x32_bf16 v[40:43], v[124:127], a[88:91], v[40:43]
ds_read_b64_tr_b16 v[96:97], v229 offset:192
v_mfma_f32_16x16x32_bf16 v[68:71], v[124:127], a[92:95], v[68:71]
ds_read_b64_tr_b16 v[98:99], v229 offset:3776
s_waitcnt vmcnt(7)
s_waitcnt lgkmcnt(12)
v_mfma_f32_16x16x32_bf16 v[16:19], v[72:75], a[96:99], v[16:19]
ds_read_b64_tr_b16 v[100:101], v229 offset:7168
s_waitcnt vmcnt(6)
v_mfma_f32_16x16x32_bf16 v[44:47], v[72:75], a[100:103], v[44:47]
ds_read_b64_tr_b16 v[102:103], v229 offset:10752
s_waitcnt lgkmcnt(12)
v_mfma_f32_16x16x32_bf16 v[20:23], v[76:79], a[96:99], v[20:23]
ds_read_b64_tr_b16 v[104:105], v229 offset:7200
v_mfma_f32_16x16x32_bf16 v[48:51], v[76:79], a[100:103], v[48:51]
ds_read_b64_tr_b16 v[106:107], v229 offset:10784
s_waitcnt lgkmcnt(12)
v_mfma_f32_16x16x32_bf16 v[24:27], v[80:83], a[96:99], v[24:27]
ds_read_b64_tr_b16 v[108:109], v229 offset:7232
v_mfma_f32_16x16x32_bf16 v[52:55], v[80:83], a[100:103], v[52:55]
ds_read_b64_tr_b16 v[110:111], v229 offset:10816
s_waitcnt lgkmcnt(12)
v_mfma_f32_16x16x32_bf16 v[28:31], v[84:87], a[96:99], v[28:31]
ds_read_b64_tr_b16 v[112:113], v229 offset:7264
v_mfma_f32_16x16x32_bf16 v[56:59], v[84:87], a[100:103], v[56:59]
ds_read_b64_tr_b16 v[114:115], v229 offset:10848
s_waitcnt lgkmcnt(12)
v_mfma_f32_16x16x32_bf16 v[32:35], v[88:91], a[96:99], v[32:35]
ds_read_b64_tr_b16 v[116:117], v229 offset:7296
v_mfma_f32_16x16x32_bf16 v[60:63], v[88:91], a[100:103], v[60:63]
ds_read_b64_tr_b16 v[118:119], v229 offset:10880
s_waitcnt lgkmcnt(12)
v_mfma_f32_16x16x32_bf16 v[36:39], v[92:95], a[96:99], v[36:39]
ds_read_b64_tr_b16 v[120:121], v229 offset:7328
v_mfma_f32_16x16x32_bf16 v[64:67], v[92:95], a[100:103], v[64:67]
ds_read_b64_tr_b16 v[122:123], v229 offset:10912
s_waitcnt lgkmcnt(12)
v_mfma_f32_16x16x32_bf16 v[40:43], v[96:99], a[96:99], v[40:43]
ds_read_b64_tr_b16 v[124:125], v229 offset:7360
v_mfma_f32_16x16x32_bf16 v[68:71], v[96:99], a[100:103], v[68:71]
ds_read_b64_tr_b16 v[126:127], v229 offset:10944
s_waitcnt vmcnt(5)
s_waitcnt lgkmcnt(12)
v_mfma_f32_16x16x32_bf16 v[16:19], v[100:103], a[104:107], v[16:19]
ds_read_b64_tr_b16 v[72:73], v229 offset:14336
ds_read_b64_tr_b16 v[74:75], v229 offset:17920
s_waitcnt vmcnt(4)
v_mfma_f32_16x16x32_bf16 v[44:47], v[100:103], a[108:111], v[44:47]
ds_read_b64_tr_b16 v[76:77], v229 offset:14368
ds_read_b64_tr_b16 v[78:79], v229 offset:17952
s_waitcnt lgkmcnt(14)
v_mfma_f32_16x16x32_bf16 v[20:23], v[104:107], a[104:107], v[20:23]
ds_read_b64_tr_b16 v[80:81], v229 offset:14400
ds_read_b64_tr_b16 v[82:83], v229 offset:17984
v_mfma_f32_16x16x32_bf16 v[48:51], v[104:107], a[108:111], v[48:51]
ds_read_b64_tr_b16 v[84:85], v229 offset:14432
ds_read_b64_tr_b16 v[86:87], v229 offset:18016
v_mfma_f32_16x16x32_bf16 v[24:27], v[108:111], a[104:107], v[24:27]
ds_read_b64_tr_b16 v[88:89], v229 offset:14464
ds_read_b64_tr_b16 v[90:91], v229 offset:18048
v_mfma_f32_16x16x32_bf16 v[52:55], v[108:111], a[108:111], v[52:55]
ds_read_b64_tr_b16 v[92:93], v229 offset:14496
ds_read_b64_tr_b16 v[94:95], v229 offset:18080
v_mfma_f32_16x16x32_bf16 v[28:31], v[112:115], a[104:107], v[28:31]
ds_read_b64_tr_b16 v[96:97], v229 offset:14528
ds_read_b64_tr_b16 v[98:99], v229 offset:18112
v_mfma_f32_16x16x32_bf16 v[56:59], v[112:115], a[108:111], v[56:59]
ds_read_b64_tr_b16 v[196:197], v229 offset:21504
ds_read_b64_tr_b16 v[198:199], v229 offset:25088
v_mfma_f32_16x16x32_bf16 v[32:35], v[116:119], a[104:107], v[32:35]
ds_read_b64_tr_b16 v[200:201], v229 offset:21536
ds_read_b64_tr_b16 v[202:203], v229 offset:25120
v_mfma_f32_16x16x32_bf16 v[60:63], v[116:119], a[108:111], v[60:63]
ds_read_b64_tr_b16 v[204:205], v229 offset:21568
ds_read_b64_tr_b16 v[206:207], v229 offset:25152
v_mfma_f32_16x16x32_bf16 v[36:39], v[120:123], a[104:107], v[36:39]
ds_read_b64_tr_b16 v[208:209], v229 offset:21600
ds_read_b64_tr_b16 v[210:211], v229 offset:25184
v_mfma_f32_16x16x32_bf16 v[64:67], v[120:123], a[108:111], v[64:67]
ds_read_b64_tr_b16 v[212:213], v229 offset:21632
ds_read_b64_tr_b16 v[214:215], v229 offset:25216
v_mfma_f32_16x16x32_bf16 v[40:43], v[124:127], a[104:107], v[40:43]
ds_read_b64_tr_b16 v[216:217], v229 offset:21664
ds_read_b64_tr_b16 v[218:219], v229 offset:25248
v_mfma_f32_16x16x32_bf16 v[68:71], v[124:127], a[108:111], v[68:71]
ds_read_b64_tr_b16 v[220:221], v229 offset:21696
ds_read_b64_tr_b16 v[222:223], v229 offset:25280
s_lshr_b32 s56, s50, 1
s_mul_i32 s56, s56, 7168
s_mul_i32 s57, s61, 0x1c000
s_add_u32 s56, s56, s57
s_add_u32 s56, s56, 0xb00000
s_and_b32 s57, s50, 1
s_lshl_b32 s58, s57, 3
s_add_u32 s58, s58, s56
s_add_u32 s58, s58, 3072
s_lshl_b32 s57, s57, 12
s_add_u32 s56, s56, s57
s_add_u32 s59, s56, 0xe000
s_add_u32 s60, s58, 0xe000
s_waitcnt vmcnt(3)
v_mfma_f32_16x16x32_bf16 v[16:19], v[72:75], a[112:115], v[16:19]
v_mfma_f32_16x16x32_bf16 v[20:23], v[76:79], a[112:115], v[20:23]
v_mfma_f32_16x16x32_bf16 v[24:27], v[80:83], a[112:115], v[24:27]
v_mfma_f32_16x16x32_bf16 v[28:31], v[84:87], a[112:115], v[28:31]
v_mfma_f32_16x16x32_bf16 v[32:35], v[88:91], a[112:115], v[32:35]
v_mfma_f32_16x16x32_bf16 v[36:39], v[92:95], a[112:115], v[36:39]
s_waitcnt lgkmcnt(14)
v_mfma_f32_16x16x32_bf16 v[40:43], v[96:99], a[112:115], v[40:43]
s_waitcnt vmcnt(1)
s_waitcnt lgkmcnt(12)
v_mfma_f32_16x16x32_bf16 v[16:19], v[196:199], a[120:123], v[16:19]
s_waitcnt lgkmcnt(10)
v_mfma_f32_16x16x32_bf16 v[20:23], v[200:203], a[120:123], v[20:23]
s_waitcnt lgkmcnt(8)
v_mfma_f32_16x16x32_bf16 v[24:27], v[204:207], a[120:123], v[24:27]
s_waitcnt lgkmcnt(6)
v_mfma_f32_16x16x32_bf16 v[28:31], v[208:211], a[120:123], v[28:31]
s_waitcnt lgkmcnt(4)
v_mfma_f32_16x16x32_bf16 v[32:35], v[212:215], a[120:123], v[32:35]
s_waitcnt lgkmcnt(2)
v_mfma_f32_16x16x32_bf16 v[36:39], v[216:219], a[120:123], v[36:39]
s_waitcnt lgkmcnt(0)
v_mfma_f32_16x16x32_bf16 v[40:43], v[220:223], a[120:123], v[40:43]
v_mfma_f32_16x16x32_bf16 v[44:47], v[72:75], a[116:119], v[44:47]
v_mfma_f32_16x16x32_bf16 v[48:51], v[76:79], a[116:119], v[48:51]
v_mul_f32 v16, v16, |v16|
v_mul_f32 v17, v17, |v17|
v_mul_f32 v18, v18, |v18|
v_mul_f32 v19, v19, |v19|
v_cvt_pk_bf16_f32 v128, v16, v17
v_mfma_f32_16x16x32_bf16 v[52:55], v[80:83], a[116:119], v[52:55]
v_pk_max_i16 v128, v128, 0
v_cvt_pk_bf16_f32 v129, v18, v19
v_pk_max_i16 v129, v129, 0
v_mul_f32 v20, v20, |v20|
v_mul_f32 v21, v21, |v21|
v_mfma_f32_16x16x32_bf16 v[56:59], v[84:87], a[116:119], v[56:59]
v_mul_f32 v22, v22, |v22|
v_mul_f32 v23, v23, |v23|
v_cvt_pk_bf16_f32 v130, v20, v21
v_pk_max_i16 v130, v130, 0
v_mfma_f32_16x16x32_bf16 v[60:63], v[88:91], a[116:119], v[60:63]
v_cvt_pk_bf16_f32 v131, v22, v23
v_pk_max_i16 v131, v131, 0
buffer_store_dwordx4 v[128:131], v1, s[24:27], s56 offen offset:0 sc1
v_mul_f32 v24, v24, |v24|
v_mul_f32 v25, v25, |v25|
v_mfma_f32_16x16x32_bf16 v[64:67], v[92:95], a[116:119], v[64:67]
v_mul_f32 v26, v26, |v26|
v_mul_f32 v27, v27, |v27|
v_cvt_pk_bf16_f32 v132, v24, v25
v_pk_max_i16 v132, v132, 0
v_cvt_pk_bf16_f32 v133, v26, v27
v_mfma_f32_16x16x32_bf16 v[68:71], v[96:99], a[116:119], v[68:71]
v_pk_max_i16 v133, v133, 0
v_mul_f32 v28, v28, |v28|
v_mul_f32 v29, v29, |v29|
v_mul_f32 v30, v30, |v30|
s_waitcnt vmcnt(1)
v_mfma_f32_16x16x32_bf16 v[44:47], v[196:199], a[124:127], v[44:47]
v_mul_f32 v31, v31, |v31|
v_cvt_pk_bf16_f32 v134, v28, v29
v_pk_max_i16 v134, v134, 0
v_cvt_pk_bf16_f32 v135, v30, v31
v_pk_max_i16 v135, v135, 0
v_mfma_f32_16x16x32_bf16 v[48:51], v[200:203], a[124:127], v[48:51]
buffer_store_dwordx4 v[132:135], v1, s[24:27], s56 offen offset:1024 sc1
v_mul_f32 v32, v32, |v32|
v_mul_f32 v33, v33, |v33|
v_mul_f32 v34, v34, |v34|
v_mfma_f32_16x16x32_bf16 v[52:55], v[204:207], a[124:127], v[52:55]
v_mul_f32 v35, v35, |v35|
v_cvt_pk_bf16_f32 v136, v32, v33
v_pk_max_i16 v136, v136, 0
v_cvt_pk_bf16_f32 v137, v34, v35
v_pk_max_i16 v137, v137, 0
v_mfma_f32_16x16x32_bf16 v[56:59], v[208:211], a[124:127], v[56:59]
v_mul_f32 v36, v36, |v36|
v_mul_f32 v37, v37, |v37|
v_mul_f32 v38, v38, |v38|
v_mul_f32 v39, v39, |v39|
v_cvt_pk_bf16_f32 v138, v36, v37
v_mfma_f32_16x16x32_bf16 v[60:63], v[212:215], a[124:127], v[60:63]
v_pk_max_i16 v138, v138, 0
v_cvt_pk_bf16_f32 v139, v38, v39
v_pk_max_i16 v139, v139, 0
buffer_store_dwordx4 v[136:139], v1, s[24:27], s56 offen offset:2048 sc1
v_mfma_f32_16x16x32_bf16 v[64:67], v[216:219], a[124:127], v[64:67]
v_mul_f32 v40, v40, |v40|
v_mul_f32 v41, v41, |v41|
v_mul_f32 v42, v42, |v42|
v_mul_f32 v43, v43, |v43|
v_cvt_pk_bf16_f32 v140, v40, v41
v_mfma_f32_16x16x32_bf16 v[68:71], v[220:223], a[124:127], v[68:71]
v_pk_max_i16 v140, v140, 0
v_cvt_pk_bf16_f32 v141, v42, v43
v_pk_max_i16 v141, v141, 0
buffer_store_dwordx2 v[140:141], v1, s[24:27], s58 offen sc1
v_mul_f32 v44, v44, |v44|
v_mul_f32 v45, v45, |v45|
v_mul_f32 v46, v46, |v46|
v_mul_f32 v47, v47, |v47|
v_cvt_pk_bf16_f32 v144, v44, v45
v_pk_max_i16 v144, v144, 0
v_cvt_pk_bf16_f32 v145, v46, v47
v_pk_max_i16 v145, v145, 0
v_mul_f32 v48, v48, |v48|
v_mul_f32 v49, v49, |v49|
v_mul_f32 v50, v50, |v50|
v_mul_f32 v51, v51, |v51|
v_cvt_pk_bf16_f32 v146, v48, v49
v_pk_max_i16 v146, v146, 0
v_cvt_pk_bf16_f32 v147, v50, v51
v_pk_max_i16 v147, v147, 0
buffer_store_dwordx4 v[144:147], v1, s[24:27], s59 offen offset:0 sc1
v_mul_f32 v52, v52, |v52|
v_mul_f32 v53, v53, |v53|
v_mul_f32 v54, v54, |v54|
v_mul_f32 v55, v55, |v55|
v_cvt_pk_bf16_f32 v148, v52, v53
v_pk_max_i16 v148, v148, 0
v_cvt_pk_bf16_f32 v149, v54, v55
v_pk_max_i16 v149, v149, 0
v_mul_f32 v56, v56, |v56|
v_mul_f32 v57, v57, |v57|
v_mul_f32 v58, v58, |v58|
v_mul_f32 v59, v59, |v59|
v_cvt_pk_bf16_f32 v150, v56, v57
v_pk_max_i16 v150, v150, 0
v_cvt_pk_bf16_f32 v151, v58, v59
v_pk_max_i16 v151, v151, 0
buffer_store_dwordx4 v[148:151], v1, s[24:27], s59 offen offset:1024 sc1
v_mul_f32 v60, v60, |v60|
v_mul_f32 v61, v61, |v61|
v_mul_f32 v62, v62, |v62|
v_mul_f32 v63, v63, |v63|
v_cvt_pk_bf16_f32 v152, v60, v61
v_pk_max_i16 v152, v152, 0
v_cvt_pk_bf16_f32 v153, v62, v63
v_pk_max_i16 v153, v153, 0
v_mul_f32 v64, v64, |v64|
v_mul_f32 v65, v65, |v65|
v_mul_f32 v66, v66, |v66|
v_mul_f32 v67, v67, |v67|
v_cvt_pk_bf16_f32 v154, v64, v65
v_pk_max_i16 v154, v154, 0
v_cvt_pk_bf16_f32 v155, v66, v67
v_pk_max_i16 v155, v155, 0
buffer_store_dwordx4 v[152:155], v1, s[24:27], s59 offen offset:2048 sc1
v_mul_f32 v68, v68, |v68|
v_mul_f32 v69, v69, |v69|
v_mul_f32 v70, v70, |v70|
v_mul_f32 v71, v71, |v71|
v_cvt_pk_bf16_f32 v156, v68, v69
v_pk_max_i16 v156, v156, 0
v_cvt_pk_bf16_f32 v157, v70, v71
v_pk_max_i16 v157, v157, 0
buffer_store_dwordx2 v[156:157], v1, s[24:27], s60 offen sc1
v_lshrrev_b32 v2, 4, v0
v_lshlrev_b32 v2, 3, v2
v_add_u32 v2, s75, v2
v_add_u32 v2, 0x26000, v2
ds_read_b64 v[208:209], v2 offset:5120
ds_read_b64 v[210:211], v2 offset:5152
ds_read_b64 v[212:213], v2 offset:5184
ds_read_b64 v[214:215], v2 offset:5216
v_accvgpr_read_b32 v216, a228
v_accvgpr_read_b32 v217, a229
v_accvgpr_read_b32 v218, a230
v_accvgpr_read_b32 v219, a231
v_accvgpr_read_b32 v220, a232
v_accvgpr_read_b32 v221, a233
v_accvgpr_read_b32 v222, a234
v_accvgpr_read_b32 v223, a235
s_waitcnt vmcnt(0)
s_lshl_b32 s60, s49, 4
s_add_u32 s60, s60, s50
s_lshl_b32 s60, s60, 2
s_add_u32 s60, s60, s51
s_lshl_b32 s60, s60, 6
s_add_u32 s60, s60, 0x50000
v_mov_b32 v3, s48
s_mov_b64 exec, 1
buffer_store_dword v3, off, s[24:27], s60 sc1
s_mov_b64 exec, -1
s_waitcnt lgkmcnt(0)
s_barrier
v_lshrrev_b32 v2, 3, v0
v_and_b32 v3, 7, v0
v_and_b32 v4, 6, v2
v_xor_b32 v3, v3, v4
v_lshlrev_b32 v2, 10, v2
v_lshl_add_u32 v8, v3, 4, v2
s_mul_i32 s74, s51, 0x9800
s_mul_i32 s79, s51, 0x70000
s_add_u32 s79, s79, s75
s_add_u32 m0, s74, 0x0
s_nop 0
buffer_load_dwordx4 v8, s[20:23], s79 offen lds
s_add_u32 s79, s79, 0x2000
s_add_u32 m0, s74, 0x400
s_nop 0
buffer_load_dwordx4 v8, s[20:23], s79 offen lds
s_add_u32 s79, s79, 0x2000
s_add_u32 m0, s74, 0x800
s_nop 0
buffer_load_dwordx4 v8, s[20:23], s79 offen lds
s_add_u32 s79, s79, 0x2000
s_add_u32 m0, s74, 0xc00
s_nop 0
buffer_load_dwordx4 v8, s[20:23], s79 offen lds
s_add_u32 s79, s79, 0x2000
s_add_u32 m0, s74, 0x1000
s_nop 0
buffer_load_dwordx4 v8, s[20:23], s79 offen lds
s_add_u32 s79, s79, 0x2000
s_add_u32 m0, s74, 0x1400
s_nop 0
buffer_load_dwordx4 v8, s[20:23], s79 offen lds
s_add_u32 s79, s79, 0x2000
s_add_u32 m0, s74, 0x1800
s_nop 0
buffer_load_dwordx4 v8, s[20:23], s79 offen lds
s_add_u32 s79, s79, 0x2000
s_add_u32 m0, s74, 0x1c00
s_nop 0
buffer_load_dwordx4 v8, s[20:23], s79 offen lds
s_add_u32 s79, s79, 0x2000
s_add_u32 m0, s74, 0x2000
s_nop 0
buffer_load_dwordx4 v8, s[20:23], s79 offen lds
s_add_u32 s79, s79, 0x2000
s_add_u32 m0, s74, 0x2400
s_nop 0
buffer_load_dwordx4 v8, s[20:23], s79 offen lds
s_add_u32 s79, s79, 0x2000
s_add_u32 m0, s74, 0x2800
s_nop 0
buffer_load_dwordx4 v8, s[20:23], s79 offen lds
s_add_u32 s79, s79, 0x2000
s_add_u32 m0, s74, 0x2c00
s_nop 0
buffer_load_dwordx4 v8, s[20:23], s79 offen lds
s_add_u32 s79, s79, 0x2000
s_add_u32 m0, s74, 0x3000
s_nop 0
buffer_load_dwordx4 v8, s[20:23], s79 offen lds
s_add_u32 s79, s79, 0x2000
s_add_u32 m0, s74, 0x3400
s_nop 0
buffer_load_dwordx4 v8, s[20:23], s79 offen lds
s_add_u32 s79, s79, 0x2000
s_add_u32 m0, s74, 0x3800
s_nop 0
buffer_load_dwordx4 v8, s[20:23], s79 offen lds
s_add_u32 s79, s79, 0x2000
s_add_u32 m0, s74, 0x3c00
s_nop 0
buffer_load_dwordx4 v8, s[20:23], s79 offen lds
s_add_u32 s79, s79, 0x2000
s_add_u32 m0, s74, 0x4000
s_nop 0
buffer_load_dwordx4 v8, s[20:23], s79 offen lds
s_add_u32 s79, s79, 0x2000
s_add_u32 m0, s74, 0x4400
s_nop 0
buffer_load_dwordx4 v8, s[20:23], s79 offen lds
s_add_u32 s79, s79, 0x2000
s_add_u32 m0, s74, 0x4800
s_nop 0
buffer_load_dwordx4 v8, s[20:23], s79 offen lds
s_add_u32 s79, s79, 0x2000
s_add_u32 m0, s74, 0x4c00
s_nop 0
buffer_load_dwordx4 v8, s[20:23], s79 offen lds
s_add_u32 s79, s79, 0x2000
s_add_u32 m0, s74, 0x5000
s_nop 0
buffer_load_dwordx4 v8, s[20:23], s79 offen lds
s_add_u32 s79, s79, 0x2000
s_add_u32 m0, s74, 0x5400
s_nop 0
buffer_load_dwordx4 v8, s[20:23], s79 offen lds
s_add_u32 s79, s79, 0x2000
s_add_u32 m0, s74, 0x5800
s_nop 0
buffer_load_dwordx4 v8, s[20:23], s79 offen lds
s_add_u32 s79, s79, 0x2000
s_add_u32 m0, s74, 0x5c00
s_nop 0
buffer_load_dwordx4 v8, s[20:23], s79 offen lds
s_add_u32 s79, s79, 0x2000
s_add_u32 m0, s74, 0x6000
s_nop 0
buffer_load_dwordx4 v8, s[20:23], s79 offen lds
s_add_u32 s79, s79, 0x2000
s_add_u32 m0, s74, 0x6400
s_nop 0
buffer_load_dwordx4 v8, s[20:23], s79 offen lds
s_add_u32 s79, s79, 0x2000
s_add_u32 m0, s74, 0x6800
s_nop 0
buffer_load_dwordx4 v8, s[20:23], s79 offen lds
s_add_u32 s79, s79, 0x2000
s_add_u32 m0, s74, 0x6c00
s_nop 0
buffer_load_dwordx4 v8, s[20:23], s79 offen lds
s_add_u32 s79, s79, 0x2000
s_add_u32 m0, s74, 0x7000
s_nop 0
buffer_load_dwordx4 v8, s[20:23], s79 offen lds
s_add_u32 s79, s79, 0x2000
s_add_u32 m0, s74, 0x7400
s_nop 0
buffer_load_dwordx4 v8, s[20:23], s79 offen lds
s_add_u32 s79, s79, 0x2000
s_add_u32 m0, s74, 0x7800
s_nop 0
buffer_load_dwordx4 v8, s[20:23], s79 offen lds
s_add_u32 s79, s79, 0x2000
s_add_u32 m0, s74, 0x7c00
s_nop 0
buffer_load_dwordx4 v8, s[20:23], s79 offen lds
s_add_u32 s79, s79, 0x2000
s_add_u32 m0, s74, 0x8000
s_nop 0
buffer_load_dwordx4 v8, s[20:23], s79 offen lds
s_add_u32 s79, s79, 0x2000
s_add_u32 m0, s74, 0x8400
s_nop 0
buffer_load_dwordx4 v8, s[20:23], s79 offen lds
s_add_u32 s79, s79, 0x2000
s_add_u32 m0, s74, 0x8800
s_nop 0
buffer_load_dwordx4 v8, s[20:23], s79 offen lds
s_add_u32 s79, s79, 0x2000
s_add_u32 m0, s74, 0x8c00
s_nop 0
buffer_load_dwordx4 v8, s[20:23], s79 offen lds
s_add_u32 s79, s79, 0x2000
s_add_u32 m0, s74, 0x9000
s_nop 0
buffer_load_dwordx4 v8, s[20:23], s79 offen lds
s_add_u32 s79, s79, 0x2000
s_add_u32 m0, s74, 0x9400
s_nop 0
buffer_load_dwordx4 v8, s[20:23], s79 offen lds
s_add_u32 s79, s79, 0x2000
v_lshrrev_b32 v3, 4, v0
v_bfe_u32 v4, v0, 2, 2
v_lshl_add_u32 v4, v3, 2, v4
v_bfe_u32 v5, v4, 1, 2
v_lshlrev_b32 v5, 5, v5
v_lshl_add_u32 v5, v4, 7, v5
v_and_b32 v6, 3, v0
v_lshl_add_u32 v5, v6, 3, v5
v_add_u32 v5, s74, v5
v_xor_b32 v12, 0, v5
v_xor_b32 v13, 32, v5
v_xor_b32 v14, 64, v5
v_xor_b32 v15, 0x60, v5
v_bfe_u32 v2, v0, 1, 2
v_lshlrev_b32 v2, 8, v2
v_and_b32 v3, 1, v0
v_lshl_add_u32 v2, v3, 6, v2
s_lshl_b32 s56, s49, 12
s_lshl_b32 s57, s51, 10
s_add_u32 s56, s56, s57
s_lshr_b32 s57, s50, 3
s_lshl_b32 s57, s57, 7
s_add_u32 s56, s56, s57
s_add_u32 s56, s56, 0x50000
v_add_u32 v2, s56, v2
s_lshl_b32 s56, s49, 3
s_lshr_b32 s57, s50, 3
s_lshl_b32 s57, s57, 2
s_add_u32 s56, s56, s57
s_mul_i32 s56, s56, 0xe000
s_mul_i32 s57, s51, 0x3800
s_add_u32 s56, s56, s57
s_add_u32 s64, s56, 0xb00000
s_add_u32 s65, s64, 0x1000
s_add_u32 s66, s64, 0x2000
s_add_u32 s67, s64, 0x3000
v_add_u32 v192, 0, v1
v_add_u32 v193, 0xe000, v1
v_add_u32 v194, 0x1c000, v1
v_add_u32 v195, 0x2a000, v1
s_lshl_b32 s59, s76, 6
s_add_u32 s59, s59, 0x80000
v_and_b32 v4, 15, v0
v_lshlrev_b32 v4, 6, v4
s_lshl_b32 s62, s2, 2
s_add_u32 s62, s62, s51
s_cmp_lg_u32 s62, 0
s_cbranch_scc1 LEPX
v_lshlrev_b32 v16, 6, v0
s_mov_b32 s62, 0x20000
s_nop 3
Lp_11:
s_mov_b32 s63, s62
buffer_load_dword v20, v16, s[24:27], s63 offen sc1
s_add_u32 s63, s63, 4096
buffer_load_dword v21, v16, s[24:27], s63 offen sc1
s_add_u32 s63, s63, 4096
buffer_load_dword v22, v16, s[24:27], s63 offen sc1
s_add_u32 s63, s63, 4096
buffer_load_dword v23, v16, s[24:27], s63 offen sc1
s_add_u32 s63, s63, 4096
buffer_load_dword v24, v16, s[24:27], s63 offen sc1
s_add_u32 s63, s63, 4096
buffer_load_dword v25, v16, s[24:27], s63 offen sc1
s_add_u32 s63, s63, 4096
buffer_load_dword v26, v16, s[24:27], s63 offen sc1
s_add_u32 s63, s63, 4096
buffer_load_dword v27, v16, s[24:27], s63 offen sc1
s_add_u32 s63, s63, 4096
buffer_load_dword v28, v16, s[24:27], s63 offen sc1
s_add_u32 s63, s63, 4096
buffer_load_dword v29, v16, s[24:27], s63 offen sc1
s_add_u32 s63, s63, 4096
buffer_load_dword v30, v16, s[24:27], s63 offen sc1
s_add_u32 s63, s63, 4096
buffer_load_dword v31, v16, s[24:27], s63 offen sc1
s_add_u32 s63, s63, 4096
buffer_load_dword v32, v16, s[24:27], s63 offen sc1
s_add_u32 s63, s63, 4096
buffer_load_dword v33, v16, s[24:27], s63 offen sc1
s_add_u32 s63, s63, 4096
buffer_load_dword v34, v16, s[24:27], s63 offen sc1
s_add_u32 s63, s63, 4096
buffer_load_dword v35, v16, s[24:27], s63 offen sc1
s_add_u32 s63, s63, 4096
s_waitcnt vmcnt(0)
v_xor_b32 v17, s48, v20
v_xor_b32 v18, s48, v21
v_or_b32 v17, v17, v18
v_xor_b32 v18, s48, v22
v_or_b32 v17, v17, v18
v_xor_b32 v18, s48, v23
v_or_b32 v17, v17, v18
v_xor_b32 v18, s48, v24
v_or_b32 v17, v17, v18
v_xor_b32 v18, s48, v25
v_or_b32 v17, v17, v18
v_xor_b32 v18, s48, v26
v_or_b32 v17, v17, v18
v_xor_b32 v18, s48, v27
v_or_b32 v17, v17, v18
v_xor_b32 v18, s48, v28
v_or_b32 v17, v17, v18
v_xor_b32 v18, s48, v29
v_or_b32 v17, v17, v18
v_xor_b32 v18, s48, v30
v_or_b32 v17, v17, v18
v_xor_b32 v18, s48, v31
v_or_b32 v17, v17, v18
v_xor_b32 v18, s48, v32
v_or_b32 v17, v17, v18
v_xor_b32 v18, s48, v33
v_or_b32 v17, v17, v18
v_xor_b32 v18, s48, v34
v_or_b32 v17, v17, v18
v_xor_b32 v18, s48, v35
v_or_b32 v17, v17, v18
v_cmp_ne_u32 vcc, 0, v17
s_cbranch_vccz Ld_12
s_cmp_eq_u32 s52, 0
s_cbranch_scc1 Ld_12
s_sub_u32 s52, s52, 1
s_branch Lp_11
Ld_12:
s_nop 0
v_mov_b32 v17, s48
s_mov_b64 exec, 1
buffer_store_dword v17, off, s[24:27], 0 sc1
s_mov_b64 exec, -1
s_nop 1
LEPX:
Lp_13:
buffer_load_dword v3, v2, s[24:27], 0 offen sc1
s_waitcnt vmcnt(0)
v_cmp_ne_u32 vcc, s48, v3
s_cbranch_vccz Ld_14
s_cmp_eq_u32 s52, 0
s_cbranch_scc1 Ld_14
s_sub_u32 s52, s52, 1
s_sleep 2
s_branch Lp_13
Ld_14:
s_nop 0
ds_read_b64_tr_b16 v[80:81], v12 offset:0
ds_read_b64_tr_b16 v[82:83], v12 offset:2048
ds_read_b64_tr_b16 v[84:85], v13 offset:0
ds_read_b64_tr_b16 v[86:87], v13 offset:2048
ds_read_b64_tr_b16 v[88:89], v14 offset:0
ds_read_b64_tr_b16 v[90:91], v14 offset:2048
ds_read_b64_tr_b16 v[92:93], v15 offset:0
ds_read_b64_tr_b16 v[94:95], v15 offset:2048
ds_read_b64_tr_b16 v[96:97], v12 offset:4096
ds_read_b64_tr_b16 v[98:99], v12 offset:6144
ds_read_b64_tr_b16 v[100:101], v13 offset:4096
ds_read_b64_tr_b16 v[102:103], v13 offset:6144
ds_read_b64_tr_b16 v[104:105], v14 offset:4096
ds_read_b64_tr_b16 v[106:107], v14 offset:6144
ds_read_b64_tr_b16 v[108:109], v15 offset:4096
ds_read_b64_tr_b16 v[110:111], v15 offset:6144
buffer_load_dwordx4 a[0:3], v192, s[24:27], s64 offen offset:0 sc1
buffer_load_dwordx4 a[4:7], v193, s[24:27], s64 offen offset:0 sc1
buffer_load_dwordx4 a[8:11], v194, s[24:27], s64 offen offset:0 sc1
buffer_load_dwordx4 a[12:15], v195, s[24:27], s64 offen offset:0 sc1
buffer_load_dwordx4 a[16:19], v192, s[24:27], s64 offen offset:1024 sc1
buffer_load_dwordx4 a[20:23], v193, s[24:27], s64 offen offset:1024 sc1
buffer_load_dwordx4 a[24:27], v194, s[24:27], s64 offen offset:1024 sc1
buffer_load_dwordx4 a[28:31], v195, s[24:27], s64 offen offset:1024 sc1
buffer_load_dwordx4 a[32:35], v192, s[24:27], s64 offen offset:2048 sc1
buffer_load_dwordx4 a[36:39], v193, s[24:27], s64 offen offset:2048 sc1
buffer_load_dwordx4 a[40:43], v194, s[24:27], s64 offen offset:2048 sc1
buffer_load_dwordx4 a[44:47], v195, s[24:27], s64 offen offset:2048 sc1
buffer_load_dwordx4 a[48:51], v192, s[24:27], s64 offen offset:3072 sc1
buffer_load_dwordx4 a[52:55], v193, s[24:27], s64 offen offset:3072 sc1
buffer_load_dwordx4 a[56:59], v194, s[24:27], s64 offen offset:3072 sc1
buffer_load_dwordx4 a[60:63], v195, s[24:27], s64 offen offset:3072 sc1
buffer_load_dwordx4 a[64:67], v192, s[24:27], s65 offen offset:0 sc1
buffer_load_dwordx4 a[68:71], v193, s[24:27], s65 offen offset:0 sc1
buffer_load_dwordx4 a[72:75], v194, s[24:27], s65 offen offset:0 sc1
buffer_load_dwordx4 a[76:79], v195, s[24:27], s65 offen offset:0 sc1
buffer_load_dwordx4 a[80:83], v192, s[24:27], s65 offen offset:1024 sc1
buffer_load_dwordx4 a[84:87], v193, s[24:27], s65 offen offset:1024 sc1
buffer_load_dwordx4 a[88:91], v194, s[24:27], s65 offen offset:1024 sc1
buffer_load_dwordx4 a[92:95], v195, s[24:27], s65 offen offset:1024 sc1
s_waitcnt vmcnt(23)
s_waitcnt lgkmcnt(14)
v_mfma_f32_16x16x32_bf16 v[16:19], v[80:83], a[0:3], 0
buffer_load_dwordx4 a[96:99], v192, s[24:27], s65 offen offset:2048 sc1
s_waitcnt vmcnt(23)
v_mfma_f32_16x16x32_bf16 v[32:35], v[80:83], a[4:7], 0
ds_read_b64_tr_b16 v[112:113], v12 offset:8192
s_waitcnt vmcnt(22)
v_mfma_f32_16x16x32_bf16 v[48:51], v[80:83], a[8:11], 0
buffer_load_dwordx4 a[100:103], v193, s[24:27], s65 offen offset:2048 sc1
s_waitcnt vmcnt(22)
v_mfma_f32_16x16x32_bf16 v[64:67], v[80:83], a[12:15], 0
ds_read_b64_tr_b16 v[114:115], v12 offset:10240
s_waitcnt lgkmcnt(14)
v_mfma_f32_16x16x32_bf16 v[20:23], v[84:87], a[0:3], 0
buffer_load_dwordx4 a[104:107], v194, s[24:27], s65 offen offset:2048 sc1
v_mfma_f32_16x16x32_bf16 v[36:39], v[84:87], a[4:7], 0
v_mfma_f32_16x16x32_bf16 v[52:55], v[84:87], a[8:11], 0
ds_read_b64_tr_b16 v[116:117], v13 offset:8192
v_mfma_f32_16x16x32_bf16 v[68:71], v[84:87], a[12:15], 0
buffer_load_dwordx4 a[108:111], v195, s[24:27], s65 offen offset:2048 sc1
s_waitcnt lgkmcnt(13)
v_mfma_f32_16x16x32_bf16 v[24:27], v[88:91], a[0:3], 0
ds_read_b64_tr_b16 v[118:119], v13 offset:10240
v_mfma_f32_16x16x32_bf16 v[40:43], v[88:91], a[4:7], 0
buffer_load_dwordx4 a[112:115], v192, s[24:27], s65 offen offset:3072 sc1
v_mfma_f32_16x16x32_bf16 v[56:59], v[88:91], a[8:11], 0
v_mfma_f32_16x16x32_bf16 v[72:75], v[88:91], a[12:15], 0
ds_read_b64_tr_b16 v[120:121], v14 offset:8192
s_waitcnt lgkmcnt(13)
v_mfma_f32_16x16x32_bf16 v[28:31], v[92:95], a[0:3], 0
ds_read_b64_tr_b16 v[122:123], v14 offset:10240
v_mfma_f32_16x16x32_bf16 v[44:47], v[92:95], a[4:7], 0
ds_read_b64_tr_b16 v[124:125], v15 offset:8192
v_mfma_f32_16x16x32_bf16 v[60:63], v[92:95], a[8:11], 0
ds_read_b64_tr_b16 v[126:127], v15 offset:10240
v_mfma_f32_16x16x32_bf16 v[76:79], v[92:95], a[12:15], 0
s_waitcnt vmcnt(24)
s_waitcnt lgkmcnt(14)
v_mfma_f32_16x16x32_bf16 v[16:19], v[96:99], a[16:19], v[16:19]
buffer_load_dwordx4 a[116:119], v193, s[24:27], s65 offen offset:3072 sc1
s_waitcnt vmcnt(24)
v_mfma_f32_16x16x32_bf16 v[32:35], v[96:99], a[20:23], v[32:35]
ds_read_b64_tr_b16 v[80:81], v12 offset:12288
s_waitcnt vmcnt(23)
v_mfma_f32_16x16x32_bf16 v[48:51], v[96:99], a[24:27], v[48:51]
buffer_load_dwordx4 a[120:123], v194, s[24:27], s65 offen offset:3072 sc1
s_waitcnt vmcnt(23)
v_mfma_f32_16x16x32_bf16 v[64:67], v[96:99], a[28:31], v[64:67]
ds_read_b64_tr_b16 v[82:83], v12 offset:26624
s_waitcnt lgkmcnt(14)
v_mfma_f32_16x16x32_bf16 v[20:23], v[100:103], a[16:19], v[20:23]
buffer_load_dwordx4 a[124:127], v195, s[24:27], s65 offen offset:3072 sc1
v_mfma_f32_16x16x32_bf16 v[36:39], v[100:103], a[20:23], v[36:39]
v_mfma_f32_16x16x32_bf16 v[52:55], v[100:103], a[24:27], v[52:55]
ds_read_b64_tr_b16 v[84:85], v13 offset:12288
v_mfma_f32_16x16x32_bf16 v[68:71], v[100:103], a[28:31], v[68:71]
buffer_load_dwordx4 a[128:131], v192, s[24:27], s66 offen offset:0 sc1
s_waitcnt lgkmcnt(13)
v_mfma_f32_16x16x32_bf16 v[24:27], v[104:107], a[16:19], v[24:27]
ds_read_b64_tr_b16 v[86:87], v13 offset:26624
v_mfma_f32_16x16x32_bf16 v[40:43], v[104:107], a[20:23], v[40:43]
buffer_load_dwordx4 a[132:135], v193, s[24:27], s66 offen offset:0 sc1
v_mfma_f32_16x16x32_bf16 v[56:59], v[104:107], a[24:27], v[56:59]
v_mfma_f32_16x16x32_bf16 v[72:75], v[104:107], a[28:31], v[72:75]
ds_read_b64_tr_b16 v[88:89], v14 offset:12288
s_waitcnt lgkmcnt(13)
v_mfma_f32_16x16x32_bf16 v[28:31], v[108:111], a[16:19], v[28:31]
ds_read_b64_tr_b16 v[90:91], v14 offset:26624
v_mfma_f32_16x16x32_bf16 v[44:47], v[108:111], a[20:23], v[44:47]
ds_read_b64_tr_b16 v[92:93], v15 offset:12288
v_mfma_f32_16x16x32_bf16 v[60:63], v[108:111], a[24:27], v[60:63]
ds_read_b64_tr_b16 v[94:95], v15 offset:26624
v_mfma_f32_16x16x32_bf16 v[76:79], v[108:111], a[28:31], v[76:79]
s_waitcnt vmcnt(25)
s_waitcnt lgkmcnt(14)
v_mfma_f32_16x16x32_bf16 v[16:19], v[112:115], a[32:35], v[16:19]
buffer_load_dwordx4 a[136:139], v194, s[24:27], s66 offen offset:0 sc1
s_waitcnt vmcnt(25)
v_mfma_f32_16x16x32_bf16 v[32:35], v[112:115], a[36:39], v[32:35]
ds_read_b64_tr_b16 v[96:97], v12 offset:14336
s_waitcnt vmcnt(24)
v_mfma_f32_16x16x32_bf16 v[48:51], v[112:115], a[40:43], v[48:51]
buffer_load_dwordx4 a[140:143], v195, s[24:27], s66 offen offset:0 sc1
s_waitcnt vmcnt(24)
v_mfma_f32_16x16x32_bf16 v[64:67], v[112:115], a[44:47], v[64:67]
ds_read_b64_tr_b16 v[98:99], v12 offset:16384
s_waitcnt lgkmcnt(14)
v_mfma_f32_16x16x32_bf16 v[20:23], v[116:119], a[32:35], v[20:23]
buffer_load_dwordx4 a[144:147], v192, s[24:27], s66 offen offset:1024 sc1
v_mfma_f32_16x16x32_bf16 v[36:39], v[116:119], a[36:39], v[36:39]
v_mfma_f32_16x16x32_bf16 v[52:55], v[116:119], a[40:43], v[52:55]
ds_read_b64_tr_b16 v[100:101], v13 offset:14336
v_mfma_f32_16x16x32_bf16 v[68:71], v[116:119], a[44:47], v[68:71]
buffer_load_dwordx4 a[148:151], v193, s[24:27], s66 offen offset:1024 sc1
s_waitcnt lgkmcnt(13)
v_mfma_f32_16x16x32_bf16 v[24:27], v[120:123], a[32:35], v[24:27]
ds_read_b64_tr_b16 v[102:103], v13 offset:16384
v_mfma_f32_16x16x32_bf16 v[40:43], v[120:123], a[36:39], v[40:43]
buffer_load_dwordx4 a[152:155], v194, s[24:27], s66 offen offset:1024 sc1
v_mfma_f32_16x16x32_bf16 v[56:59], v[120:123], a[40:43], v[56:59]
v_mfma_f32_16x16x32_bf16 v[72:75], v[120:123], a[44:47], v[72:75]
ds_read_b64_tr_b16 v[104:105], v14 offset:14336
s_waitcnt lgkmcnt(13)
v_mfma_f32_16x16x32_bf16 v[28:31], v[124:127], a[32:35], v[28:31]
ds_read_b64_tr_b16 v[106:107], v14 offset:16384
v_mfma_f32_16x16x32_bf16 v[44:47], v[124:127], a[36:39], v[44:47]
ds_read_b64_tr_b16 v[108:109], v15 offset:14336
v_mfma_f32_16x16x32_bf16 v[60:63], v[124:127], a[40:43], v[60:63]
ds_read_b64_tr_b16 v[110:111], v15 offset:16384
v_mfma_f32_16x16x32_bf16 v[76:79], v[124:127], a[44:47], v[76:79]
s_waitcnt vmcnt(26)
s_waitcnt lgkmcnt(14)
v_mfma_f32_16x16x32_bf16 v[16:19], v[80:83], a[48:51], v[16:19]
buffer_load_dwordx4 a[156:159], v195, s[24:27], s66 offen offset:1024 sc1
s_waitcnt vmcnt(26)
v_mfma_f32_16x16x32_bf16 v[32:35], v[80:83], a[52:55], v[32:35]
ds_read_b64_tr_b16 v[112:113], v12 offset:18432
s_waitcnt vmcnt(25)
v_mfma_f32_16x16x32_bf16 v[48:51], v[80:83], a[56:59], v[48:51]
buffer_load_dwordx4 a[160:163], v192, s[24:27], s66 offen offset:2048 sc1
s_waitcnt vmcnt(25)
v_mfma_f32_16x16x32_bf16 v[64:67], v[80:83], a[60:63], v[64:67]
ds_read_b64_tr_b16 v[114:115], v12 offset:20480
s_waitcnt lgkmcnt(14)
v_mfma_f32_16x16x32_bf16 v[20:23], v[84:87], a[48:51], v[20:23]
buffer_load_dwordx4 a[164:167], v193, s[24:27], s66 offen offset:2048 sc1
v_mfma_f32_16x16x32_bf16 v[36:39], v[84:87], a[52:55], v[36:39]
v_mfma_f32_16x16x32_bf16 v[52:55], v[84:87], a[56:59], v[52:55]
ds_read_b64_tr_b16 v[116:117], v13 offset:18432
v_mfma_f32_16x16x32_bf16 v[68:71], v[84:87], a[60:63], v[68:71]
buffer_load_dwordx4 a[168:171], v194, s[24:27], s66 offen offset:2048 sc1
s_waitcnt lgkmcnt(13)
v_mfma_f32_16x16x32_bf16 v[24:27], v[88:91], a[48:51], v[24:27]
ds_read_b64_tr_b16 v[118:119], v13 offset:20480
v_mfma_f32_16x16x32_bf16 v[40:43], v[88:91], a[52:55], v[40:43]
buffer_load_dwordx4 a[172:175], v195, s[24:27], s66 offen offset:2048 sc1
v_mfma_f32_16x16x32_bf16 v[56:59], v[88:91], a[56:59], v[56:59]
v_mfma_f32_16x16x32_bf16 v[72:75], v[88:91], a[60:63], v[72:75]
ds_read_b64_tr_b16 v[120:121], v14 offset:18432
s_waitcnt lgkmcnt(13)
v_mfma_f32_16x16x32_bf16 v[28:31], v[92:95], a[48:51], v[28:31]
ds_read_b64_tr_b16 v[122:123], v14 offset:20480
v_mfma_f32_16x16x32_bf16 v[44:47], v[92:95], a[52:55], v[44:47]
ds_read_b64_tr_b16 v[124:125], v15 offset:18432
v_mfma_f32_16x16x32_bf16 v[60:63], v[92:95], a[56:59], v[60:63]
ds_read_b64_tr_b16 v[126:127], v15 offset:20480
v_mfma_f32_16x16x32_bf16 v[76:79], v[92:95], a[60:63], v[76:79]
s_waitcnt vmcnt(27)
s_waitcnt lgkmcnt(14)
v_mfma_f32_16x16x32_bf16 v[16:19], v[96:99], a[64:67], v[16:19]
buffer_load_dwordx4 a[176:179], v192, s[24:27], s66 offen offset:3072 sc1
s_waitcnt vmcnt(27)
v_mfma_f32_16x16x32_bf16 v[32:35], v[96:99], a[68:71], v[32:35]
ds_read_b64_tr_b16 v[80:81], v12 offset:22528
s_waitcnt vmcnt(26)
v_mfma_f32_16x16x32_bf16 v[48:51], v[96:99], a[72:75], v[48:51]
buffer_load_dwordx4 a[180:183], v193, s[24:27], s66 offen offset:3072 sc1
s_waitcnt vmcnt(26)
v_mfma_f32_16x16x32_bf16 v[64:67], v[96:99], a[76:79], v[64:67]
ds_read_b64_tr_b16 v[82:83], v12 offset:24576
s_waitcnt lgkmcnt(14)
v_mfma_f32_16x16x32_bf16 v[20:23], v[100:103], a[64:67], v[20:23]
buffer_load_dwordx4 a[184:187], v194, s[24:27], s66 offen offset:3072 sc1
v_mfma_f32_16x16x32_bf16 v[36:39], v[100:103], a[68:71], v[36:39]
v_mfma_f32_16x16x32_bf16 v[52:55], v[100:103], a[72:75], v[52:55]
ds_read_b64_tr_b16 v[84:85], v13 offset:22528
v_mfma_f32_16x16x32_bf16 v[68:71], v[100:103], a[76:79], v[68:71]
buffer_load_dwordx4 a[188:191], v195, s[24:27], s66 offen offset:3072 sc1
s_waitcnt lgkmcnt(13)
v_mfma_f32_16x16x32_bf16 v[24:27], v[104:107], a[64:67], v[24:27]
ds_read_b64_tr_b16 v[86:87], v13 offset:24576
v_mfma_f32_16x16x32_bf16 v[40:43], v[104:107], a[68:71], v[40:43]
buffer_load_dwordx4 a[192:195], v192, s[24:27], s67 offen offset:0 sc1
v_mfma_f32_16x16x32_bf16 v[56:59], v[104:107], a[72:75], v[56:59]
v_mfma_f32_16x16x32_bf16 v[72:75], v[104:107], a[76:79], v[72:75]
ds_read_b64_tr_b16 v[88:89], v14 offset:22528
s_waitcnt lgkmcnt(13)
v_mfma_f32_16x16x32_bf16 v[28:31], v[108:111], a[64:67], v[28:31]
ds_read_b64_tr_b16 v[90:91], v14 offset:24576
v_mfma_f32_16x16x32_bf16 v[44:47], v[108:111], a[68:71], v[44:47]
ds_read_b64_tr_b16 v[92:93], v15 offset:22528
v_mfma_f32_16x16x32_bf16 v[60:63], v[108:111], a[72:75], v[60:63]
ds_read_b64_tr_b16 v[94:95], v15 offset:24576
v_mfma_f32_16x16x32_bf16 v[76:79], v[108:111], a[76:79], v[76:79]
s_waitcnt vmcnt(28)
s_waitcnt lgkmcnt(14)
v_mfma_f32_16x16x32_bf16 v[16:19], v[112:115], a[80:83], v[16:19]
s_add_u32 m0, s74, 0x0
s_nop 0
buffer_load_dwordx4 v8, s[20:23], s79 offen lds
s_add_u32 s79, s79, 0x2000
s_waitcnt vmcnt(28)
v_mfma_f32_16x16x32_bf16 v[32:35], v[112:115], a[84:87], v[32:35]
ds_read_b64_tr_b16 v[96:97], v12 offset:28672
s_waitcnt vmcnt(27)
v_mfma_f32_16x16x32_bf16 v[48:51], v[112:115], a[88:91], v[48:51]
s_add_u32 m0, s74, 0x400
s_nop 0
buffer_load_dwordx4 v8, s[20:23], s79 offen lds
s_add_u32 s79, s79, 0x2000
s_waitcnt vmcnt(27)
v_mfma_f32_16x16x32_bf16 v[64:67], v[112:115], a[92:95], v[64:67]
ds_read_b64_tr_b16 v[98:99], v12 offset:30720
s_waitcnt lgkmcnt(14)
v_mfma_f32_16x16x32_bf16 v[20:23], v[116:119], a[80:83], v[20:23]
s_add_u32 m0, s74, 0x800
s_nop 0
buffer_load_dwordx4 v8, s[20:23], s79 offen lds
s_add_u32 s79, s79, 0x2000
v_mfma_f32_16x16x32_bf16 v[36:39], v[116:119], a[84:87], v[36:39]
ds_read_b64_tr_b16 v[100:101], v13 offset:28672
v_mfma_f32_16x16x32_bf16 v[52:55], v[116:119], a[88:91], v[52:55]
s_add_u32 m0, s74, 0xc00
s_nop 0
buffer_load_dwordx4 v8, s[20:23], s79 offen lds
s_add_u32 s79, s79, 0x2000
v_mfma_f32_16x16x32_bf16 v[68:71], v[116:119], a[92:95], v[68:71]
s_waitcnt lgkmcnt(13)
v_mfma_f32_16x16x32_bf16 v[24:27], v[120:123], a[80:83], v[24:27]
ds_read_b64_tr_b16 v[102:103], v13 offset:30720
v_mfma_f32_16x16x32_bf16 v[40:43], v[120:123], a[84:87], v[40:43]
s_add_u32 m0, s74, 0x1000
s_nop 0
buffer_load_dwordx4 v8, s[20:23], s79 offen lds
s_add_u32 s79, s79, 0x2000
v_mfma_f32_16x16x32_bf16 v[56:59], v[120:123], a[88:91], v[56:59]
ds_read_b64_tr_b16 v[104:105], v14 offset:28672
v_mfma_f32_16x16x32_bf16 v[72:75], v[120:123], a[92:95], v[72:75]
s_add_u32 m0, s74, 0x1400
s_nop 0
buffer_load_dwordx4 v8, s[20:23], s79 offen lds
s_add_u32 s79, s79, 0x2000
s_waitcnt lgkmcnt(13)
v_mfma_f32_16x16x32_bf16 v[28:31], v[124:127], a[80:83], v[28:31]
ds_read_b64_tr_b16 v[106:107], v14 offset:30720
v_mfma_f32_16x16x32_bf16 v[44:47], v[124:127], a[84:87], v[44:47]
ds_read_b64_tr_b16 v[108:109], v15 offset:28672
v_mfma_f32_16x16x32_bf16 v[60:63], v[124:127], a[88:91], v[60:63]
ds_read_b64_tr_b16 v[110:111], v15 offset:30720
v_mfma_f32_16x16x32_bf16 v[76:79], v[124:127], a[92:95], v[76:79]
s_waitcnt vmcnt(30)
s_waitcnt lgkmcnt(14)
v_mfma_f32_16x16x32_bf16 v[16:19], v[80:83], a[96:99], v[16:19]
s_add_u32 m0, s74, 0x1800
s_nop 0
buffer_load_dwordx4 v8, s[20:23], s79 offen lds
s_add_u32 s79, s79, 0x2000
s_waitcnt vmcnt(30)
v_mfma_f32_16x16x32_bf16 v[32:35], v[80:83], a[100:103], v[32:35]
ds_read_b64_tr_b16 v[112:113], v12 offset:32768
s_waitcnt vmcnt(29)
v_mfma_f32_16x16x32_bf16 v[48:51], v[80:83], a[104:107], v[48:51]
s_add_u32 m0, s74, 0x1c00
s_nop 0
buffer_load_dwordx4 v8, s[20:23], s79 offen lds
s_add_u32 s79, s79, 0x2000
s_waitcnt vmcnt(29)
v_mfma_f32_16x16x32_bf16 v[64:67], v[80:83], a[108:111], v[64:67]
ds_read_b64_tr_b16 v[114:115], v12 offset:34816
s_waitcnt lgkmcnt(14)
v_mfma_f32_16x16x32_bf16 v[20:23], v[84:87], a[96:99], v[20:23]
s_add_u32 m0, s74, 0x2000
s_nop 0
buffer_load_dwordx4 v8, s[20:23], s79 offen lds
s_add_u32 s79, s79, 0x2000
v_mfma_f32_16x16x32_bf16 v[36:39], v[84:87], a[100:103], v[36:39]
ds_read_b64_tr_b16 v[116:117], v13 offset:32768
v_mfma_f32_16x16x32_bf16 v[52:55], v[84:87], a[104:107], v[52:55]
s_add_u32 m0, s74, 0x2400
s_nop 0
buffer_load_dwordx4 v8, s[20:23], s79 offen lds
s_add_u32 s79, s79, 0x2000
v_mfma_f32_16x16x32_bf16 v[68:71], v[84:87], a[108:111], v[68:71]
s_waitcnt lgkmcnt(13)
v_mfma_f32_16x16x32_bf16 v[24:27], v[88:91], a[96:99], v[24:27]
ds_read_b64_tr_b16 v[118:119], v13 offset:34816
v_mfma_f32_16x16x32_bf16 v[40:43], v[88:91], a[100:103], v[40:43]
s_add_u32 m0, s74, 0x2800
s_nop 0
buffer_load_dwordx4 v8, s[20:23], s79 offen lds
s_add_u32 s79, s79, 0x2000
v_mfma_f32_16x16x32_bf16 v[56:59], v[88:91], a[104:107], v[56:59]
ds_read_b64_tr_b16 v[120:121], v14 offset:32768
v_mfma_f32_16x16x32_bf16 v[72:75], v[88:91], a[108:111], v[72:75]
s_add_u32 m0, s74, 0x2c00
s_nop 0
buffer_load_dwordx4 v8, s[20:23], s79 offen lds
s_add_u32 s79, s79, 0x2000
s_waitcnt lgkmcnt(13)
v_mfma_f32_16x16x32_bf16 v[28:31], v[92:95], a[96:99], v[28:31]
ds_read_b64_tr_b16 v[122:123], v14 offset:34816
v_mfma_f32_16x16x32_bf16 v[44:47], v[92:95], a[100:103], v[44:47]
ds_read_b64_tr_b16 v[124:125], v15 offset:32768
v_mfma_f32_16x16x32_bf16 v[60:63], v[92:95], a[104:107], v[60:63]
ds_read_b64_tr_b16 v[126:127], v15 offset:34816
v_mfma_f32_16x16x32_bf16 v[76:79], v[92:95], a[108:111], v[76:79]
s_waitcnt vmcnt(32)
s_waitcnt lgkmcnt(14)
v_mfma_f32_16x16x32_bf16 v[16:19], v[96:99], a[112:115], v[16:19]
ds_read_b64_tr_b16 v[80:81], v12 offset:36864
s_waitcnt vmcnt(31)
v_mfma_f32_16x16x32_bf16 v[32:35], v[96:99], a[116:119], v[32:35]
s_add_u32 m0, s74, 0x3000
s_nop 0
buffer_load_dwordx4 v8, s[20:23], s79 offen lds
s_add_u32 s79, s79, 0x2000
s_waitcnt vmcnt(31)
v_mfma_f32_16x16x32_bf16 v[48:51], v[96:99], a[120:123], v[48:51]
s_waitcnt vmcnt(11)
ds_read_b64_tr_b16 v[82:83], v12 offset:0
v_mfma_f32_16x16x32_bf16 v[64:67], v[96:99], a[124:127], v[64:67]
s_add_u32 m0, s74, 0x3400
s_nop 0
buffer_load_dwordx4 v8, s[20:23], s79 offen lds
s_add_u32 s79, s79, 0x2000
s_waitcnt lgkmcnt(14)
v_mfma_f32_16x16x32_bf16 v[20:23], v[100:103], a[112:115], v[20:23]
ds_read_b64_tr_b16 v[84:85], v13 offset:36864
v_mfma_f32_16x16x32_bf16 v[36:39], v[100:103], a[116:119], v[36:39]
s_add_u32 m0, s74, 0x3800
s_nop 0
buffer_load_dwordx4 v8, s[20:23], s79 offen lds
s_add_u32 s79, s79, 0x2000
v_mfma_f32_16x16x32_bf16 v[52:55], v[100:103], a[120:123], v[52:55]
ds_read_b64_tr_b16 v[86:87], v13 offset:0
v_mfma_f32_16x16x32_bf16 v[68:71], v[100:103], a[124:127], v[68:71]
s_waitcnt lgkmcnt(14)
v_mfma_f32_16x16x32_bf16 v[24:27], v[104:107], a[112:115], v[24:27]
s_add_u32 m0, s74, 0x3c00
s_nop 0
buffer_load_dwordx4 v8, s[20:23], s79 offen lds
s_add_u32 s79, s79, 0x2000
v_mfma_f32_16x16x32_bf16 v[40:43], v[104:107], a[116:119], v[40:43]
ds_read_b64_tr_b16 v[88:89], v14 offset:36864
v_mfma_f32_16x16x32_bf16 v[56:59], v[104:107], a[120:123], v[56:59]
s_add_u32 m0, s74, 0x4000
s_nop 0
buffer_load_dwordx4 v8, s[20:23], s79 offen lds
s_add_u32 s79, s79, 0x2000
v_mfma_f32_16x16x32_bf16 v[72:75], v[104:107], a[124:127], v[72:75]
ds_read_b64_tr_b16 v[90:91], v14 offset:0
s_waitcnt lgkmcnt(14)
v_mfma_f32_16x16x32_bf16 v[28:31], v[108:111], a[112:115], v[28:31]
s_add_u32 m0, s74, 0x4400
s_nop 0
buffer_load_dwordx4 v8, s[20:23], s79 offen lds
s_add_u32 s79, s79, 0x2000
v_mfma_f32_16x16x32_bf16 v[44:47], v[108:111], a[116:119], v[44:47]
ds_read_b64_tr_b16 v[92:93], v15 offset:36864
v_mfma_f32_16x16x32_bf16 v[60:63], v[108:111], a[120:123], v[60:63]
ds_read_b64_tr_b16 v[94:95], v15 offset:0
v_mfma_f32_16x16x32_bf16 v[76:79], v[108:111], a[124:127], v[76:79]
s_waitcnt lgkmcnt(14)
v_mfma_f32_16x16x32_bf16 v[16:19], v[112:115], a[128:131], v[16:19]
s_waitcnt vmcnt(14)
ds_read_b64_tr_b16 v[96:97], v12 offset:2048
v_mfma_f32_16x16x32_bf16 v[32:35], v[112:115], a[132:135], v[32:35]
buffer_load_dwordx4 a[196:199], v193, s[24:27], s67 offen offset:0 sc1
v_mfma_f32_16x16x32_bf16 v[48:51], v[112:115], a[136:139], v[48:51]
s_waitcnt vmcnt(1)
ds_read_b64_tr_b16 v[98:99], v12 offset:16384
v_mfma_f32_16x16x32_bf16 v[64:67], v[112:115], a[140:143], v[64:67]
buffer_load_dwordx4 a[200:203], v194, s[24:27], s67 offen offset:0 sc1
s_waitcnt lgkmcnt(14)
v_mfma_f32_16x16x32_bf16 v[20:23], v[116:119], a[128:131], v[20:23]
ds_read_b64_tr_b16 v[100:101], v13 offset:2048
v_mfma_f32_16x16x32_bf16 v[36:39], v[116:119], a[132:135], v[36:39]
v_mfma_f32_16x16x32_bf16 v[52:55], v[116:119], a[136:139], v[52:55]
buffer_load_dwordx4 a[204:207], v195, s[24:27], s67 offen offset:0 sc1
v_mfma_f32_16x16x32_bf16 v[68:71], v[116:119], a[140:143], v[68:71]
ds_read_b64_tr_b16 v[102:103], v13 offset:16384
s_waitcnt lgkmcnt(14)
v_mfma_f32_16x16x32_bf16 v[24:27], v[120:123], a[128:131], v[24:27]
buffer_load_dwordx4 a[208:211], v192, s[24:27], s67 offen offset:1024 sc1
v_mfma_f32_16x16x32_bf16 v[40:43], v[120:123], a[132:135], v[40:43]
ds_read_b64_tr_b16 v[104:105], v14 offset:2048
v_mfma_f32_16x16x32_bf16 v[56:59], v[120:123], a[136:139], v[56:59]
v_mfma_f32_16x16x32_bf16 v[72:75], v[120:123], a[140:143], v[72:75]
buffer_load_dwordx4 a[212:215], v193, s[24:27], s67 offen offset:1024 sc1
s_waitcnt lgkmcnt(13)
v_mfma_f32_16x16x32_bf16 v[28:31], v[124:127], a[128:131], v[28:31]
ds_read_b64_tr_b16 v[106:107], v14 offset:16384
v_mfma_f32_16x16x32_bf16 v[44:47], v[124:127], a[132:135], v[44:47]
ds_read_b64_tr_b16 v[108:109], v15 offset:2048
v_mfma_f32_16x16x32_bf16 v[60:63], v[124:127], a[136:139], v[60:63]
ds_read_b64_tr_b16 v[110:111], v15 offset:16384
v_mfma_f32_16x16x32_bf16 v[76:79], v[124:127], a[140:143], v[76:79]
s_waitcnt lgkmcnt(14)
v_mfma_f32_16x16x32_bf16 v[16:19], v[80:83], a[144:147], v[16:19]
ds_read_b64_tr_b16 v[112:113], v12 offset:4096
v_mfma_f32_16x16x32_bf16 v[32:35], v[80:83], a[148:151], v[32:35]
buffer_load_dwordx4 a[216:219], v194, s[24:27], s67 offen offset:1024 sc1
v_mfma_f32_16x16x32_bf16 v[48:51], v[80:83], a[152:155], v[48:51]
ds_read_b64_tr_b16 v[114:115], v12 offset:6144
v_mfma_f32_16x16x32_bf16 v[64:67], v[80:83], a[156:159], v[64:67]
buffer_load_dwordx4 a[220:223], v195, s[24:27], s67 offen offset:1024 sc1
s_waitcnt lgkmcnt(14)
v_mfma_f32_16x16x32_bf16 v[20:23], v[84:87], a[144:147], v[20:23]
ds_read_b64_tr_b16 v[116:117], v13 offset:4096
v_mfma_f32_16x16x32_bf16 v[36:39], v[84:87], a[148:151], v[36:39]
buffer_load_dwordx4 v[176:179], v4, s[24:27], s59 offen offset:0 sc1
v_mfma_f32_16x16x32_bf16 v[52:55], v[84:87], a[152:155], v[52:55]
ds_read_b64_tr_b16 v[118:119], v13 offset:6144
v_mfma_f32_16x16x32_bf16 v[68:71], v[84:87], a[156:159], v[68:71]
s_waitcnt lgkmcnt(14)
v_mfma_f32_16x16x32_bf16 v[24:27], v[88:91], a[144:147], v[24:27]
buffer_load_dwordx4 v[180:183], v4, s[24:27], s59 offen offset:16 sc1
v_mfma_f32_16x16x32_bf16 v[40:43], v[88:91], a[148:151], v[40:43]
ds_read_b64_tr_b16 v[120:121], v14 offset:4096
v_mfma_f32_16x16x32_bf16 v[56:59], v[88:91], a[152:155], v[56:59]
buffer_load_dwordx4 v[184:187], v4, s[24:27], s59 offen offset:32 sc1
v_mfma_f32_16x16x32_bf16 v[72:75], v[88:91], a[156:159], v[72:75]
ds_read_b64_tr_b16 v[122:123], v14 offset:6144
s_waitcnt lgkmcnt(14)
v_mfma_f32_16x16x32_bf16 v[28:31], v[92:95], a[144:147], v[28:31]
buffer_load_dwordx4 v[188:191], v4, s[24:27], s59 offen offset:48 sc1
v_mfma_f32_16x16x32_bf16 v[44:47], v[92:95], a[148:151], v[44:47]
ds_read_b64_tr_b16 v[124:125], v15 offset:4096
v_mfma_f32_16x16x32_bf16 v[60:63], v[92:95], a[152:155], v[60:63]
ds_read_b64_tr_b16 v[126:127], v15 offset:6144
v_mfma_f32_16x16x32_bf16 v[76:79], v[92:95], a[156:159], v[76:79]
s_waitcnt lgkmcnt(14)
v_mfma_f32_16x16x32_bf16 v[16:19], v[96:99], a[160:163], v[16:19]
ds_read_b64_tr_b16 v[80:81], v12 offset:8192
v_lshlrev_b32 v2, 16, v216
v_mfma_f32_16x16x32_bf16 v[32:35], v[96:99], a[164:167], v[32:35]
ds_read_b64_tr_b16 v[82:83], v12 offset:10240
v_and_b32 v3, 0xffff0000, v216
v_mfma_f32_16x16x32_bf16 v[48:51], v[96:99], a[168:171], v[48:51]
ds_read_b64_tr_b16 v[84:85], v13 offset:8192
v_lshlrev_b32 v144, 16, v208
v_mfma_f32_16x16x32_bf16 v[64:67], v[96:99], a[172:175], v[64:67]
ds_read_b64_tr_b16 v[86:87], v13 offset:10240
v_and_b32 v145, 0xffff0000, v208
v_mfma_f32_16x16x32_bf16 v[20:23], v[100:103], a[160:163], v[20:23]
ds_read_b64_tr_b16 v[88:89], v14 offset:8192
v_fma_f32 v240, v2, v144, v240
v_mfma_f32_16x16x32_bf16 v[36:39], v[100:103], a[164:167], v[36:39]
ds_read_b64_tr_b16 v[90:91], v14 offset:10240
v_fma_f32 v241, v3, v145, v241
v_mfma_f32_16x16x32_bf16 v[52:55], v[100:103], a[168:171], v[52:55]
ds_read_b64_tr_b16 v[92:93], v15 offset:8192
v_lshlrev_b32 v2, 16, v217
v_mfma_f32_16x16x32_bf16 v[68:71], v[100:103], a[172:175], v[68:71]
ds_read_b64_tr_b16 v[94:95], v15 offset:10240
v_and_b32 v3, 0xffff0000, v217
v_mfma_f32_16x16x32_bf16 v[24:27], v[104:107], a[160:163], v[24:27]
v_lshlrev_b32 v146, 16, v209
v_and_b32 v147, 0xffff0000, v209
v_mfma_f32_16x16x32_bf16 v[40:43], v[104:107], a[164:167], v[40:43]
v_fma_f32 v242, v2, v146, v242
v_fma_f32 v243, v3, v147, v243
v_mfma_f32_16x16x32_bf16 v[56:59], v[104:107], a[168:171], v[56:59]
v_lshlrev_b32 v2, 16, v218
v_and_b32 v3, 0xffff0000, v218
v_mfma_f32_16x16x32_bf16 v[72:75], v[104:107], a[172:175], v[72:75]
v_lshlrev_b32 v148, 16, v210
v_and_b32 v149, 0xffff0000, v210
v_mfma_f32_16x16x32_bf16 v[28:31], v[108:111], a[160:163], v[28:31]
v_fma_f32 v244, v2, v148, v244
v_fma_f32 v245, v3, v149, v245
v_mfma_f32_16x16x32_bf16 v[44:47], v[108:111], a[164:167], v[44:47]
v_lshlrev_b32 v2, 16, v219
v_and_b32 v3, 0xffff0000, v219
v_mfma_f32_16x16x32_bf16 v[60:63], v[108:111], a[168:171], v[60:63]
v_lshlrev_b32 v150, 16, v211
v_and_b32 v151, 0xffff0000, v211
v_mfma_f32_16x16x32_bf16 v[76:79], v[108:111], a[172:175], v[76:79]
v_fma_f32 v246, v2, v150, v246
v_fma_f32 v247, v3, v151, v247
s_waitcnt lgkmcnt(14)
v_mfma_f32_16x16x32_bf16 v[16:19], v[112:115], a[176:179], v[16:19]
ds_read_b64_tr_b16 v[96:97], v12 offset:12288
v_lshlrev_b32 v2, 16, v220
v_mfma_f32_16x16x32_bf16 v[32:35], v[112:115], a[180:183], v[32:35]
ds_read_b64_tr_b16 v[98:99], v12 offset:14336
v_and_b32 v3, 0xffff0000, v220
v_mfma_f32_16x16x32_bf16 v[48:51], v[112:115], a[184:187], v[48:51]
ds_read_b64_tr_b16 v[100:101], v13 offset:12288
v_lshlrev_b32 v152, 16, v212
v_mfma_f32_16x16x32_bf16 v[64:67], v[112:115], a[188:191], v[64:67]
ds_read_b64_tr_b16 v[102:103], v13 offset:14336
v_and_b32 v153, 0xffff0000, v212
v_mfma_f32_16x16x32_bf16 v[20:23], v[116:119], a[176:179], v[20:23]
ds_read_b64_tr_b16 v[104:105], v14 offset:12288
v_fma_f32 v248, v2, v152, v248
v_mfma_f32_16x16x32_bf16 v[36:39], v[116:119], a[180:183], v[36:39]
ds_read_b64_tr_b16 v[106:107], v14 offset:14336
v_fma_f32 v249, v3, v153, v249
v_mfma_f32_16x16x32_bf16 v[52:55], v[116:119], a[184:187], v[52:55]
ds_read_b64_tr_b16 v[108:109], v15 offset:12288
v_lshlrev_b32 v2, 16, v221
v_mfma_f32_16x16x32_bf16 v[68:71], v[116:119], a[188:191], v[68:71]
ds_read_b64_tr_b16 v[110:111], v15 offset:14336
v_and_b32 v3, 0xffff0000, v221
v_mfma_f32_16x16x32_bf16 v[24:27], v[120:123], a[176:179], v[24:27]
v_lshlrev_b32 v154, 16, v213
v_and_b32 v155, 0xffff0000, v213
v_mfma_f32_16x16x32_bf16 v[40:43], v[120:123], a[180:183], v[40:43]
v_fma_f32 v250, v2, v154, v250
v_fma_f32 v251, v3, v155, v251
v_mfma_f32_16x16x32_bf16 v[56:59], v[120:123], a[184:187], v[56:59]
v_lshlrev_b32 v2, 16, v222
v_and_b32 v3, 0xffff0000, v222
v_mfma_f32_16x16x32_bf16 v[72:75], v[120:123], a[188:191], v[72:75]
v_lshlrev_b32 v156, 16, v214
v_and_b32 v157, 0xffff0000, v214
v_mfma_f32_16x16x32_bf16 v[28:31], v[124:127], a[176:179], v[28:31]
v_fma_f32 v252, v2, v156, v252
v_fma_f32 v253, v3, v157, v253
v_mfma_f32_16x16x32_bf16 v[44:47], v[124:127], a[180:183], v[44:47]
v_lshlrev_b32 v2, 16, v223
v_and_b32 v3, 0xffff0000, v223
v_mfma_f32_16x16x32_bf16 v[60:63], v[124:127], a[184:187], v[60:63]
v_lshlrev_b32 v158, 16, v215
v_and_b32 v159, 0xffff0000, v215
v_mfma_f32_16x16x32_bf16 v[76:79], v[124:127], a[188:191], v[76:79]
v_fma_f32 v254, v2, v158, v254
v_fma_f32 v255, v3, v159, v255
s_waitcnt lgkmcnt(14)
v_mfma_f32_16x16x32_bf16 v[16:19], v[80:83], a[192:195], v[16:19]
v_and_b32 v2, 15, v0
v_lshrrev_b32 v3, 4, v0
s_waitcnt vmcnt(10)
v_mfma_f32_16x16x32_bf16 v[32:35], v[80:83], a[196:199], v[32:35]
v_xor_b32 v3, v3, v2
v_lshlrev_b32 v3, 4, v3
s_waitcnt vmcnt(9)
v_mfma_f32_16x16x32_bf16 v[48:51], v[80:83], a[200:203], v[48:51]
v_lshl_add_u32 v3, v2, 8, v3
v_add_u32 v10, s74, v3
s_waitcnt vmcnt(8)
v_mfma_f32_16x16x32_bf16 v[64:67], v[80:83], a[204:207], v[64:67]
v_xor_b32 v4, 0, v10
v_xor_b32 v5, 64, v10
s_waitcnt lgkmcnt(12)
v_mfma_f32_16x16x32_bf16 v[20:23], v[84:87], a[192:195], v[20:23]
v_xor_b32 v6, 0x80, v10
v_xor_b32 v7, 0xc0, v10
v_mfma_f32_16x16x32_bf16 v[36:39], v[84:87], a[196:199], v[36:39]
s_waitcnt vmcnt(3)
v_add_f32 v8, v176, v178
v_add_f32 v9, v177, v179
v_mfma_f32_16x16x32_bf16 v[52:55], v[84:87], a[200:203], v[52:55]
s_waitcnt vmcnt(2)
v_add_f32 v8, v8, v180
v_add_f32 v9, v9, v181
v_mfma_f32_16x16x32_bf16 v[68:71], v[84:87], a[204:207], v[68:71]
v_add_f32 v8, v8, v182
s_waitcnt lgkmcnt(10)
v_mfma_f32_16x16x32_bf16 v[24:27], v[88:91], a[192:195], v[24:27]
v_add_f32 v9, v9, v183
s_waitcnt vmcnt(1)
v_add_f32 v8, v8, v184
v_mfma_f32_16x16x32_bf16 v[40:43], v[88:91], a[196:199], v[40:43]
v_add_f32 v9, v9, v185
v_add_f32 v8, v8, v186
v_mfma_f32_16x16x32_bf16 v[56:59], v[88:91], a[200:203], v[56:59]
v_add_f32 v9, v9, v187
s_waitcnt vmcnt(0)
v_add_f32 v8, v8, v188
v_mfma_f32_16x16x32_bf16 v[72:75], v[88:91], a[204:207], v[72:75]
v_add_f32 v9, v9, v189
v_add_f32 v8, v8, v190
s_waitcnt lgkmcnt(8)
v_mfma_f32_16x16x32_bf16 v[28:31], v[92:95], a[192:195], v[28:31]
v_add_f32 v9, v9, v191
v_mul_f32 v8, 0x3b000000, v8
v_mfma_f32_16x16x32_bf16 v[44:47], v[92:95], a[196:199], v[44:47]
v_mul_f32 v9, 0x3b000000, v9
v_fma_f32 v9, -v8, v8, v9
v_mfma_f32_16x16x32_bf16 v[60:63], v[92:95], a[200:203], v[60:63]
v_max_f32 v9, 0, v9
v_add_f32 v9, 0x3727c5ac, v9
v_mfma_f32_16x16x32_bf16 v[76:79], v[92:95], a[204:207], v[76:79]
v_rcp_f32 v9, v9
s_waitcnt lgkmcnt(6)
v_mfma_f32_16x16x32_bf16 v[16:19], v[96:99], a[208:211], v[16:19]
s_lshl_b32 s56, s51, 12
v_add_u32 v3, s56, v3
v_mfma_f32_16x16x32_bf16 v[32:35], v[96:99], a[212:215], v[32:35]
v_xor_b32 v192, 0, v3
v_xor_b32 v193, 64, v3
v_mfma_f32_16x16x32_bf16 v[48:51], v[96:99], a[216:219], v[48:51]
v_xor_b32 v194, 0x80, v3
v_mfma_f32_16x16x32_bf16 v[64:67], v[96:99], a[220:223], v[64:67]
v_xor_b32 v195, 0xc0, v3
v_add_u32 v12, 0x13000, v192
s_waitcnt lgkmcnt(4)
v_mfma_f32_16x16x32_bf16 v[20:23], v[100:103], a[208:211], v[20:23]
v_add_u32 v13, 0x13000, v193
v_add_u32 v14, 0x13000, v194
v_mfma_f32_16x16x32_bf16 v[36:39], v[100:103], a[212:215], v[36:39]
v_add_u32 v15, 0x13000, v195
v_mfma_f32_16x16x32_bf16 v[52:55], v[100:103], a[216:219], v[52:55]
v_mul_f32 v144, v144, v9
v_mul_f32 v145, v145, v9
v_mfma_f32_16x16x32_bf16 v[68:71], v[100:103], a[220:223], v[68:71]
v_mul_f32 v146, v146, v9
s_waitcnt lgkmcnt(2)
v_mfma_f32_16x16x32_bf16 v[24:27], v[104:107], a[208:211], v[24:27]
v_mul_f32 v147, v147, v9
v_mul_f32 v148, v148, v9
v_mfma_f32_16x16x32_bf16 v[40:43], v[104:107], a[212:215], v[40:43]
v_mul_f32 v149, v149, v9
v_mul_f32 v150, v150, v9
v_mfma_f32_16x16x32_bf16 v[56:59], v[104:107], a[216:219], v[56:59]
v_mul_f32 v151, v151, v9
v_mfma_f32_16x16x32_bf16 v[72:75], v[104:107], a[220:223], v[72:75]
v_mul_f32 v152, v152, v9
v_mul_f32 v153, v153, v9
s_waitcnt lgkmcnt(0)
v_mfma_f32_16x16x32_bf16 v[28:31], v[108:111], a[208:211], v[28:31]
v_mul_f32 v154, v154, v9
v_mul_f32 v155, v155, v9
v_mfma_f32_16x16x32_bf16 v[44:47], v[108:111], a[212:215], v[44:47]
v_mul_f32 v156, v156, v9
v_mfma_f32_16x16x32_bf16 v[60:63], v[108:111], a[216:219], v[60:63]
v_mul_f32 v157, v157, v9
v_mul_f32 v158, v158, v9
v_mfma_f32_16x16x32_bf16 v[76:79], v[108:111], a[220:223], v[76:79]
v_mul_f32 v159, v159, v9
ds_write_b128 v4, v[16:19] offset:0
ds_write_b128 v4, v[32:35] offset:4096
ds_write_b128 v4, v[48:51] offset:8192
ds_write_b128 v4, v[64:67] offset:12288
ds_write_b128 v5, v[20:23] offset:0
ds_write_b128 v5, v[36:39] offset:4096
ds_write_b128 v5, v[52:55] offset:8192
ds_write_b128 v5, v[68:71] offset:12288
ds_write_b128 v6, v[24:27] offset:0
ds_write_b128 v6, v[40:43] offset:4096
ds_write_b128 v6, v[56:59] offset:8192
ds_write_b128 v6, v[72:75] offset:12288
ds_write_b128 v7, v[28:31] offset:0
ds_write_b128 v7, v[44:47] offset:4096
ds_write_b128 v7, v[60:63] offset:8192
ds_write_b128 v7, v[76:79] offset:12288
s_waitcnt lgkmcnt(0)
s_barrier
ds_read_b128 v[80:83], v192 offset:0
ds_read_b128 v[96:99], v192 offset:38912
ds_read_b128 v[112:115], v12 offset:0
ds_read_b128 v[128:131], v12 offset:38912
ds_read_b128 v[84:87], v193 offset:0
ds_read_b128 v[100:103], v193 offset:38912
ds_read_b128 v[116:119], v13 offset:0
ds_read_b128 v[132:135], v13 offset:38912
ds_read_b128 v[88:91], v194 offset:0
ds_read_b128 v[104:107], v194 offset:38912
ds_read_b128 v[120:123], v14 offset:0
ds_read_b128 v[136:139], v14 offset:38912
ds_read_b128 v[92:95], v195 offset:0
ds_read_b128 v[108:111], v195 offset:38912
ds_read_b128 v[124:127], v15 offset:0
ds_read_b128 v[140:143], v15 offset:38912
s_waitcnt lgkmcnt(14)
v_pk_add_f32 v[80:81], v[80:81], v[96:97]
s_waitcnt lgkmcnt(12)
v_pk_add_f32 v[112:113], v[112:113], v[128:129]
v_pk_add_f32 v[82:83], v[82:83], v[98:99]
v_pk_add_f32 v[114:115], v[114:115], v[130:131]
v_pk_add_f32 v[80:81], v[80:81], v[112:113]
v_pk_add_f32 v[82:83], v[82:83], v[114:115]
v_pk_fma_f32 v[80:81], v[80:81], v[144:145], v[240:241]
v_pk_fma_f32 v[82:83], v[82:83], v[146:147], v[242:243]
v_cvt_pk_bf16_f32 v16, v80, v81
v_cvt_pk_bf16_f32 v17, v82, v83
buffer_store_dwordx2 v[16:17], v231, s[28:31], s77 offen offset:0
s_waitcnt lgkmcnt(10)
v_pk_add_f32 v[84:85], v[84:85], v[100:101]
s_waitcnt lgkmcnt(8)
v_pk_add_f32 v[116:117], v[116:117], v[132:133]
v_pk_add_f32 v[86:87], v[86:87], v[102:103]
v_pk_add_f32 v[118:119], v[118:119], v[134:135]
v_pk_add_f32 v[84:85], v[84:85], v[116:117]
v_pk_add_f32 v[86:87], v[86:87], v[118:119]
v_pk_fma_f32 v[84:85], v[84:85], v[148:149], v[244:245]
v_pk_fma_f32 v[86:87], v[86:87], v[150:151], v[246:247]
v_cvt_pk_bf16_f32 v18, v84, v85
v_cvt_pk_bf16_f32 v19, v86, v87
buffer_store_dwordx2 v[18:19], v231, s[28:31], s77 offen offset:32
s_waitcnt lgkmcnt(6)
v_pk_add_f32 v[88:89], v[88:89], v[104:105]
s_waitcnt lgkmcnt(4)
v_pk_add_f32 v[120:121], v[120:121], v[136:137]
v_pk_add_f32 v[90:91], v[90:91], v[106:107]
v_pk_add_f32 v[122:123], v[122:123], v[138:139]
v_pk_add_f32 v[88:89], v[88:89], v[120:121]
v_pk_add_f32 v[90:91], v[90:91], v[122:123]
v_pk_fma_f32 v[88:89], v[88:89], v[152:153], v[248:249]
v_pk_fma_f32 v[90:91], v[90:91], v[154:155], v[250:251]
v_cvt_pk_bf16_f32 v20, v88, v89
v_cvt_pk_bf16_f32 v21, v90, v91
buffer_store_dwordx2 v[20:21], v231, s[28:31], s77 offen offset:64
s_waitcnt lgkmcnt(2)
v_pk_add_f32 v[92:93], v[92:93], v[108:109]
s_waitcnt lgkmcnt(0)
v_pk_add_f32 v[124:125], v[124:125], v[140:141]
v_pk_add_f32 v[94:95], v[94:95], v[110:111]
v_pk_add_f32 v[126:127], v[126:127], v[142:143]
v_pk_add_f32 v[92:93], v[92:93], v[124:125]
v_pk_add_f32 v[94:95], v[94:95], v[126:127]
v_pk_fma_f32 v[92:93], v[92:93], v[156:157], v[252:253]
v_pk_fma_f32 v[94:95], v[94:95], v[158:159], v[254:255]
v_cvt_pk_bf16_f32 v22, v92, v93
v_cvt_pk_bf16_f32 v23, v94, v95
buffer_store_dwordx2 v[22:23], v231, s[28:31], s77 offen offset:96
s_nop 3
LEND:
s_endpgm
.section .rodata,"a"
.p2align 6
.amdhsa_kernel adaLN_cond__sliding_block__dense_activation_squared_relu__prompt_kernel
  .amdhsa_next_free_vgpr 512
  .amdhsa_next_free_sgpr 102
  .amdhsa_accum_offset 256
  .amdhsa_group_segment_fixed_size 0
  .amdhsa_kernarg_size 104
  .amdhsa_user_sgpr_count 2
  .amdhsa_user_sgpr_kernarg_segment_ptr 1
  .amdhsa_system_sgpr_workgroup_id_x 1
.end_amdhsa_kernel
```
